```python
import torch

def _softmax(x, axis=-1):
    return torch.softmax(x, dim=axis)
def _gelu(x):
    return torch.nn.functional.gelu(x, approximate="tanh")
def _silu(x):
    return torch.nn.functional.silu(x)
def _sigmoid(x):
    return torch.sigmoid(x)
def _layernorm(x, axis=-1, eps=1e-5):
    m = x.mean(dim=axis, keepdim=True)
    v = x.var(dim=axis, keepdim=True, unbiased=False)
    return (x - m) / torch.sqrt(v + eps)
def _scatter_add(tgt, idx, src, axis=0):
    return tgt.clone().index_add_(axis, idx, src)
def _segment_sum(src, seg, n):
    out = torch.zeros((n,) + src.shape[1:], dtype=src.dtype)
    return out.index_add_(0, seg, src)
def _pad(x, pw):
    flat = tuple(v for pair in reversed(pw) for v in pair)
    return torch.nn.functional.pad(x, flat)

kernel_name = 'gated_mix__linear_attn_block__mixer_s_mlp__prompt'

def setup_inputs():

    _w = (lambda a: (lambda t: t.to(torch.bfloat16) if t.is_floating_point() else t)(torch.as_tensor(a)))
    def _A_setup():
        B, S, D = 1, 2048, 1024
        return {
            "x": _w((lambda *s: torch.randn(*s, dtype=torch.bfloat16) * 0.05)(B, S, D)),
            "wqkv": _w((lambda *s: torch.randn(*s, dtype=torch.bfloat16) * 3.2)(D, 3 * D)),
            "wo": _w((lambda *s: torch.randn(*s, dtype=torch.bfloat16) * 1.6)(D, D)),
        }
    _A_in = _A_setup()

    def _B_setup():
        B, S, D, F = 1, 2048, 1024, 3584
        return {
            "x":  _w((lambda *s: torch.randn(*s, dtype=torch.bfloat16) * 0.05)(B, S, D)),
            "w1": _w((lambda *s: torch.randn(*s, dtype=torch.bfloat16) * 3.2)(D, D) * (D ** -0.5)),
            "w2": _w((lambda *s: torch.randn(*s, dtype=torch.bfloat16) * 3.2)(D, D) * (D ** -0.5)),
            "w3": _w((lambda *s: torch.randn(*s, dtype=torch.bfloat16) * 3.2)(D, F) * (D ** -0.5)),
            "w4": _w((lambda *s: torch.randn(*s, dtype=torch.bfloat16) * 1.6)(F, D) * (F ** -0.5)),
        }
    _B_in = _B_setup()

    return {
        "A_x": _A_in["x"],
        "A_wqkv": _A_in["wqkv"],
        "A_wo": _A_in["wo"],
        "B_x": _B_in["x"],
        "B_w1": _B_in["w1"],
        "B_w2": _B_in["w2"],
        "B_w3": _B_in["w3"],
        "B_w4": _B_in["w4"],
        "gate_w": _w((lambda *s: torch.randn(*s, dtype=torch.bfloat16) * 0.05)(1024) * 16.0),
    }

def reference(A_x, A_wqkv, A_wo, B_x, B_w1, B_w2, B_w3, B_w4, gate_w):
    def _A_ref(x, wqkv, wo):
        B, S, D = x.shape
        H = 32; Dh = D // H
        qkv = (lambda x, *d: x.permute(*d))((x @ wqkv).reshape(B, S, 3, H, Dh), 2, 0, 3, 1, 4)
        q, k, v = qkv[0], qkv[1], qkv[2]
        phi = lambda t: torch.where(t > 0, t + 1, torch.exp(t)) + 1e-6
        pq, pk = phi(q), phi(k)
        kv = torch.einsum("bhsd,bhse->bhde", pk, v)
        z = torch.einsum("bhsd->bhd", pk)
        num = torch.einsum("bhqd,bhde->bhqe", pq, kv)
        den = torch.einsum("bhqd,bhd->bhq", pq, z)[..., None] + 1e-6
        o = num / den
        return (lambda x, *d: x.permute(*d))(o, 0, 2, 1, 3).reshape(B, S, D) @ wo

    def _B_ref(x, w1, w2, w3, w4):
        B, S, D = x.shape
        h = _gelu(_layernorm(x, axis=-1) @ w1)
        c = D // 4
        g0 = _pad(h[:, :, 0*c:1*c], ((0, 0), (1, 0), (0, 0)))[:, :S, :]
        g1 = _pad(h[:, :, 1*c:2*c], ((0, 0), (0, 1), (0, 0)))[:, 1:, :]
        g2 = _pad(h[:, :, 2*c:3*c], ((0, 0), (2, 0), (0, 0)))[:, :S, :]
        g3 = _pad(h[:, :, 3*c:   ], ((0, 0), (0, 2), (0, 0)))[:, 2:, :]
        hs = torch.concatenate([g0, g1, g2, g3], axis=-1) @ w2
        x1 = x + hs
        h2 = _gelu(_layernorm(x1, axis=-1) @ w3) @ w4
        return x1 + h2

    x = A_x
    g = _sigmoid((x * gate_w).sum(-1, keepdims=True))
    a = _A_ref(x, A_wqkv, A_wo)
    b = _B_ref(x, B_w1, B_w2, B_w3, B_w4)
    return g * a + (1 - g) * b
```

```asm
; @launch grid=(256,1,1) block=(512,1,1) lds=152128
.amdgcn_target "amdgcn-amd-amdhsa--gfx950"
.text
.globl gated_mix__linear_attn_block__mixer_s_mlp__prompt_kernel
.p2align 8
.type gated_mix__linear_attn_block__mixer_s_mlp__prompt_kernel,@function
gated_mix__linear_attn_block__mixer_s_mlp__prompt_kernel:
    s_cmp_ge_u32 s2, 256
    s_cbranch_scc1 L_gated_mix__linear_attn_block__mixer_s_mlp__prompt_kernel_end
    s_load_dwordx16 s[4:19], s[0:1], 0
    s_load_dwordx8 s[20:27], s[0:1], 64
    v_lshrrev_b32 v2, 6, v0
    v_and_b32 v1, 63, v0
    v_mov_b32 v121, 0
    s_and_b32 s79, s2, 7
    v_readfirstlane_b32 s60, v2
    s_lshr_b32 s80, s2, 3
    s_xor_b32 s79, s79, 4
    s_xor_b32 s2, s2, 4
    s_lshr_b32 s71, s79, 2
    s_xor_b32 s79, s79, s71
    s_xor_b32 s2, s2, s71
    s_and_b32 s71, s79, 3
    s_lshl_b32 s71, s71, 2
    s_and_b32 s72, s80, 3
    s_add_u32 s77, s71, s72
    s_cmp_lg_u32 s60, 1
    s_cbranch_scc1 L_cnd_1
    s_getpc_b64 s[56:57]
L_pc_2:
    s_add_u32 s56, s56, gated_mix__linear_attn_block__mixer_s_mlp__prompt_kernel-L_pc_2
    s_addc_u32 s57, s57, (gated_mix__linear_attn_block__mixer_s_mlp__prompt_kernel-L_pc_2)>>32
    s_mov_b32 s58, L_code_end-gated_mix__linear_attn_block__mixer_s_mlp__prompt_kernel
    s_mov_b32 s59, 0x20000
    v_lshlrev_b32 v2, 7, v1
    s_lshl_b32 s71, s80, 13
    buffer_load_dword v127, v2, s[56:59], s71 offen
L_cnd_1:
    s_lshl_b32 s61, s77, 7
    s_lshr_b32 s63, s80, 2
    s_lshr_b32 s76, s79, 2
    s_and_b32 s75, s60, 3
    s_and_b32 s71, s79, 1
    s_lshl_b32 s71, s71, 3
    s_and_b32 s72, s80, 7
    s_add_u32 s86, s71, s72
    s_cmp_eq_u32 s76, 0
    s_cselect_b32 s86, s77, s86
    s_lshl_b32 s61, s86, 7
    v_lshrrev_b32 v3, 3, v1
    v_and_b32 v4, 7, v1
    v_lshrrev_b32 v5, 4, v1
    v_xor_b32 v4, v4, v5
    s_lshl_b32 s71, s75, 5
    s_add_u32 s71, s71, s61
    v_add_u32 v3, s71, v3
    s_mov_b32 s72, 2048
    v_mul_lo_u32 v3, v3, s72
    v_mov_b32 v5, v4
    v_lshl_add_u32 v5, v5, 4, v3
    v_add_u32 v16, 0x0, v5
    v_xor_b32 v5, 4, v4
    v_lshl_add_u32 v5, v5, 4, v3
    v_add_u32 v17, 0x3c00, v5
    v_mov_b32 v5, v4
    v_lshl_add_u32 v5, v5, 4, v3
    v_add_u32 v18, 0x7800, v5
    v_xor_b32 v5, 4, v4
    v_lshl_add_u32 v5, v5, 4, v3
    v_add_u32 v19, 0xb400, v5
    s_lshl_b32 s61, s77, 7
    s_lshl_b32 s70, s75, 12
    s_lshl_b32 s84, s75, 13
    s_mov_b32 s68, 0
    s_mov_b32 s69, 0
    s_mov_b32 s30, 0x400000
    s_mov_b32 s31, 0x20000
    s_mov_b32 s35, 0x20000
    s_cmp_eq_u32 s76, 0
    s_cbranch_scc1 L_M
    s_mov_b32 s64, 6144
    s_and_b32 s71, s79, 2
    s_lshl_b32 s71, s71, 1
    s_lshr_b32 s72, s80, 3
    s_add_u32 s78, s71, s72
    s_lshl_b32 s71, s78, 7
    s_add_u32 s62, s71, 1024
    s_mov_b32 s65, 1024
    s_mov_b32 s66, 32
    s_add_u32 s78, s78, 4
    v_lshrrev_b32 v3, 5, v1
    v_and_b32 v4, 31, v1
    s_lshl_b32 s71, s75, 4
    v_add_u32 v6, s71, v3
    v_mul_lo_u32 v6, v6, s64
    v_or_b32 v5, 0, v3
    v_lshlrev_b32 v5, 2, v5
    v_xor_b32 v5, v5, v4
    v_bfe_u32 v7, v5, 2, 1
    v_mul_lo_u32 v7, v7, s65
    v_lshrrev_b32 v8, 3, v5
    v_mul_lo_u32 v8, v8, s66
    v_and_b32 v9, 3, v5
    v_lshlrev_b32 v9, 3, v9
    v_add3_u32 v7, v7, v8, v9
    v_add_u32 v7, s62, v7
    v_lshl_add_u32 v10, v7, 1, v6
    v_or_b32 v5, 2, v3
    v_lshlrev_b32 v5, 2, v5
    v_xor_b32 v5, v5, v4
    v_bfe_u32 v7, v5, 2, 1
    v_mul_lo_u32 v7, v7, s65
    v_lshrrev_b32 v8, 3, v5
    v_mul_lo_u32 v8, v8, s66
    v_and_b32 v9, 3, v5
    v_lshlrev_b32 v9, 3, v9
    v_add3_u32 v7, v7, v8, v9
    v_add_u32 v7, s62, v7
    v_lshl_add_u32 v11, v7, 1, v6
    s_mul_i32 s71, s64, 0
    s_sub_u32 s71, s71, 0
    v_add_u32 v20, s71, v10
    s_mul_i32 s71, s64, 2
    s_sub_u32 s71, s71, 1024
    v_add_u32 v21, s71, v11
    s_mul_i32 s71, s64, 4
    s_sub_u32 s71, s71, 2048
    v_add_u32 v22, s71, v10
    s_mul_i32 s71, s64, 6
    s_sub_u32 s71, s71, 3072
    v_add_u32 v23, s71, v11
    v_xor_b32 v10, 32, v10
    v_xor_b32 v11, 32, v11
    s_mul_i32 s71, s64, 8
    s_sub_u32 s71, s71, 0
    v_add_u32 v24, s71, v10
    s_mul_i32 s71, s64, 10
    s_sub_u32 s71, s71, 1024
    v_add_u32 v25, s71, v11
    s_mul_i32 s71, s64, 12
    s_sub_u32 s71, s71, 2048
    v_add_u32 v26, s71, v10
    s_mul_i32 s71, s64, 14
    s_sub_u32 s71, s71, 3072
    v_add_u32 v27, s71, v11
    s_mov_b32 s34, 0x600000
    s_waitcnt lgkmcnt(0)
    s_mov_b32 s28, s4
    s_mov_b32 s29, s5
    s_mov_b32 s32, s6
    s_mov_b32 s33, s7
    s_cmp_lt_u32 s60, 4
    s_cbranch_scc1 L_A0
    s_add_u32 m0, s70, 0
    s_nop 0
    buffer_load_dwordx4 v16, s[28:31], s68 offen offset:0 lds
    buffer_load_dwordx4 v17, s[28:31], s68 offen offset:1024 lds
    buffer_load_dwordx4 v18, s[28:31], s68 offen offset:2048 lds
    buffer_load_dwordx4 v19, s[28:31], s68 offen offset:3072 lds
    s_add_u32 m0, s84, 16384
    s_add_u32 s68, s68, 128
    buffer_load_dwordx4 v20, s[32:35], s69 offen offset:0 lds
    buffer_load_dwordx4 v21, s[32:35], s69 offen offset:1024 lds
    buffer_load_dwordx4 v22, s[32:35], s69 offen offset:2048 lds
    buffer_load_dwordx4 v23, s[32:35], s69 offen offset:3072 lds
    s_add_u32 m0, s84, 20480
    s_nop 0
    buffer_load_dwordx4 v24, s[32:35], s69 offen offset:0 lds
    buffer_load_dwordx4 v25, s[32:35], s69 offen offset:1024 lds
    buffer_load_dwordx4 v26, s[32:35], s69 offen offset:2048 lds
    buffer_load_dwordx4 v27, s[32:35], s69 offen offset:3072 lds
    s_add_u32 s69, s69, 393216
    s_add_u32 m0, s70, 49152
    s_nop 0
    buffer_load_dwordx4 v16, s[28:31], s68 offen offset:0 lds
    buffer_load_dwordx4 v17, s[28:31], s68 offen offset:1024 lds
    buffer_load_dwordx4 v18, s[28:31], s68 offen offset:2048 lds
    buffer_load_dwordx4 v19, s[28:31], s68 offen offset:3072 lds
    s_add_u32 m0, s84, 65536
    s_add_u32 s68, s68, 128
    buffer_load_dwordx4 v20, s[32:35], s69 offen offset:0 lds
    buffer_load_dwordx4 v21, s[32:35], s69 offen offset:1024 lds
    buffer_load_dwordx4 v22, s[32:35], s69 offen offset:2048 lds
    buffer_load_dwordx4 v23, s[32:35], s69 offen offset:3072 lds
    s_add_u32 m0, s84, 69632
    s_nop 0
    buffer_load_dwordx4 v24, s[32:35], s69 offen offset:0 lds
    buffer_load_dwordx4 v25, s[32:35], s69 offen offset:1024 lds
    buffer_load_dwordx4 v26, s[32:35], s69 offen offset:2048 lds
    buffer_load_dwordx4 v27, s[32:35], s69 offen offset:3072 lds
    s_add_u32 s69, s69, 393216
    s_branch L_A_loader
L_A0:
    s_setprio 2
    s_lshl_b32 s68, s76, 3
    s_add_u32 s68, s68, s63
    s_lshl_b32 s68, s68, 3
    s_add_u32 s68, s68, s61
    s_lshl_b32 s71, s60, 1
    s_add_u32 s68, s68, s71
    s_mov_b32 s48, s20
    s_mov_b32 s49, s21
    s_mov_b32 s50, 0x800
    s_mov_b32 s51, 0x20000
    s_mov_b32 s44, s4
    s_mov_b32 s45, s5
    s_mov_b32 s46, 0x400000
    s_mov_b32 s47, 0x20000
    v_lshlrev_b32 v2, 4, v1
    buffer_load_dwordx4 v[128:131], v2, s[48:51], 0 offen
    buffer_load_dwordx4 v[132:135], v2, s[48:51], 0 offen offset:1024
    s_lshl_b32 s71, s68, 11
    buffer_load_dwordx4 v[156:159], v2, s[44:47], s71 offen
    buffer_load_dwordx4 v[160:163], v2, s[44:47], s71 offen offset:1024
    s_add_u32 s71, s71, 2048
    buffer_load_dwordx4 v[164:167], v2, s[44:47], s71 offen
    buffer_load_dwordx4 v[168:171], v2, s[44:47], s71 offen offset:1024
    s_add_u32 s71, s71, 2048
    s_xor_b32 s71, s2, 255
    s_or_b32 s71, s71, s60
    s_cmp_lg_u32 s71, 0
    s_cbranch_scc1 L_noclr
    s_add_u32 s56, s26, 0x2700000
    s_addc_u32 s57, s27, 0
    s_mov_b32 s58, 0x8000
    s_mov_b32 s59, 0x20000
    v_lshlrev_b32 v2, 4, v1
    v_mov_b32 v4, 0
    v_mov_b32 v5, 0
    v_mov_b32 v6, 0
    v_mov_b32 v7, 0
    buffer_store_dwordx4 v[4:7], v2, s[56:59], 0 offen offset:0 sc1
    buffer_store_dwordx4 v[4:7], v2, s[56:59], 0 offen offset:1024 sc1
    buffer_store_dwordx4 v[4:7], v2, s[56:59], 0 offen offset:2048 sc1
    buffer_store_dwordx4 v[4:7], v2, s[56:59], 0 offen offset:3072 sc1
    v_add_u32 v2, 4096, v2
    buffer_store_dwordx4 v[4:7], v2, s[56:59], 0 offen offset:0 sc1
    buffer_store_dwordx4 v[4:7], v2, s[56:59], 0 offen offset:1024 sc1
    buffer_store_dwordx4 v[4:7], v2, s[56:59], 0 offen offset:2048 sc1
    buffer_store_dwordx4 v[4:7], v2, s[56:59], 0 offen offset:3072 sc1
    v_add_u32 v2, 4096, v2
    buffer_store_dwordx4 v[4:7], v2, s[56:59], 0 offen offset:0 sc1
    buffer_store_dwordx4 v[4:7], v2, s[56:59], 0 offen offset:1024 sc1
    buffer_store_dwordx4 v[4:7], v2, s[56:59], 0 offen offset:2048 sc1
    buffer_store_dwordx4 v[4:7], v2, s[56:59], 0 offen offset:3072 sc1
    v_add_u32 v2, 4096, v2
    buffer_store_dwordx4 v[4:7], v2, s[56:59], 0 offen offset:0 sc1
    buffer_store_dwordx4 v[4:7], v2, s[56:59], 0 offen offset:1024 sc1
    buffer_store_dwordx4 v[4:7], v2, s[56:59], 0 offen offset:2048 sc1
    buffer_store_dwordx4 v[4:7], v2, s[56:59], 0 offen offset:3072 sc1
    v_add_u32 v2, 4096, v2
    buffer_store_dwordx4 v[4:7], v2, s[56:59], 0 offen offset:0 sc1
    buffer_store_dwordx4 v[4:7], v2, s[56:59], 0 offen offset:1024 sc1
    buffer_store_dwordx4 v[4:7], v2, s[56:59], 0 offen offset:2048 sc1
    buffer_store_dwordx4 v[4:7], v2, s[56:59], 0 offen offset:3072 sc1
    v_add_u32 v2, 4096, v2
    buffer_store_dwordx4 v[4:7], v2, s[56:59], 0 offen offset:0 sc1
    buffer_store_dwordx4 v[4:7], v2, s[56:59], 0 offen offset:1024 sc1
    buffer_store_dwordx4 v[4:7], v2, s[56:59], 0 offen offset:2048 sc1
    buffer_store_dwordx4 v[4:7], v2, s[56:59], 0 offen offset:3072 sc1
    v_add_u32 v2, 4096, v2
    buffer_store_dwordx4 v[4:7], v2, s[56:59], 0 offen offset:0 sc1
    buffer_store_dwordx4 v[4:7], v2, s[56:59], 0 offen offset:1024 sc1
    buffer_store_dwordx4 v[4:7], v2, s[56:59], 0 offen offset:2048 sc1
    buffer_store_dwordx4 v[4:7], v2, s[56:59], 0 offen offset:3072 sc1
    v_add_u32 v2, 4096, v2
    buffer_store_dwordx4 v[4:7], v2, s[56:59], 0 offen offset:0 sc1
    buffer_store_dwordx4 v[4:7], v2, s[56:59], 0 offen offset:1024 sc1
    buffer_store_dwordx4 v[4:7], v2, s[56:59], 0 offen offset:2048 sc1
    buffer_store_dwordx4 v[4:7], v2, s[56:59], 0 offen offset:3072 sc1
    v_add_u32 v2, 4096, v2
    s_waitcnt vmcnt(0)
    s_mov_b32 s56, s24
    s_mov_b32 s57, s25
    s_mov_b32 s58, 0x100
    s_mov_b32 s59, 0x20000
    v_mov_b32 v2, 252
    v_mov_b32 v3, 1
    s_mov_b64 exec, 1
    buffer_store_dword v3, v2, s[56:59], 0 offen sc1
    s_mov_b64 exec, -1
L_noclr:
    s_add_u32 s40, s26, 0x2000000
    s_addc_u32 s41, s27, 0
    s_mov_b32 s42, 0x200000
    s_mov_b32 s43, 0x20000
    s_add_u32 s52, s26, 0x2200000
    s_addc_u32 s53, s27, 0
    s_mov_b32 s54, 0x10000
    s_mov_b32 s55, 0x20000
    v_and_b32 v2, 15, v1
    v_lshlrev_b32 v2, 7, v2
    v_bfe_u32 v3, v1, 1, 3
    v_lshrrev_b32 v16, 4, v1
    v_xor_b32 v3, v3, v16
    v_xor_b32 v17, 0, v3
    v_lshl_add_u32 v8, v17, 4, v2
    v_mov_b32 v4, v8
    v_xor_b32 v17, 4, v3
    v_lshl_add_u32 v9, v17, 4, v2
    v_mov_b32 v5, v9
    v_bfe_u32 v2, v1, 2, 2
    v_lshl_add_u32 v18, v16, 3, v2
    v_and_b32 v3, 1, v1
    v_lshlrev_b32 v3, 3, v3
    v_lshl_add_u32 v3, v18, 9, v3
    v_bfe_u32 v17, v1, 1, 1
    s_and_b32 s71, s60, 3
    s_lshl_b32 s71, s71, 3
    v_add_u32 v17, s71, v17
    v_lshlrev_b32 v2, 2, v2
    v_xor_b32 v17, v17, v2
    v_and_b32 v2, 1, v16
    v_lshlrev_b32 v2, 1, v2
    v_xor_b32 v17, v17, v2
    v_xor_b32 v19, 0, v17
    v_lshl_add_u32 v19, v19, 4, v3
    v_add_u32 v10, 16384, v19
    v_mov_b32 v6, v10
    v_xor_b32 v19, 2, v17
    v_lshl_add_u32 v19, v19, 4, v3
    v_add_u32 v11, 16384, v19
    v_mov_b32 v7, v11
    v_xor_b32 v19, 4, v17
    v_lshl_add_u32 v19, v19, 4, v3
    v_add_u32 v14, 16384, v19
    v_mov_b32 v12, v14
    v_xor_b32 v19, 6, v17
    v_lshl_add_u32 v19, v19, 4, v3
    v_add_u32 v15, 16384, v19
    v_mov_b32 v13, v15
    s_mov_b32 s70, 0
    s_cmp_lg_u32 s60, 0
    s_cbranch_scc1 L_pfw_4
    s_and_b32 s71, s79, 3
    s_mul_i32 s71, s71, 24
    s_add_u32 s71, s71, s80
    s_cmp_ge_u32 s80, 8
    s_cselect_b32 s72, 8, 0
    s_sub_u32 s71, s71, s72
    s_mul_i32 s71, s71, 24576
    s_min_u32 s71, s71, 0x200000
    s_sub_u32 s72, 0x200000, s71
    s_min_u32 s58, s72, 24576
    s_lshr_b32 s72, s80, 3
    s_cmp_eq_u32 s72, 1
    s_cselect_b32 s58, 0, s58
    s_add_u32 s56, s12, s71
    s_addc_u32 s57, s13, 0
    s_mov_b32 s59, 0x20000
    v_lshlrev_b32 v126, 7, v1
    s_mov_b32 s87, 8192
    s_mov_b32 s85, 0x0
    buffer_load_dword v127, v126, s[56:59], s85 offen
    s_add_u32 s85, s85, s87
    buffer_load_dword v127, v126, s[56:59], s85 offen
    s_add_u32 s85, s85, s87
    buffer_load_dword v127, v126, s[56:59], s85 offen
    s_add_u32 s85, s85, s87
    s_and_b32 s71, s79, 3
    s_mul_i32 s71, s71, 24
    s_add_u32 s71, s71, s80
    s_cmp_ge_u32 s80, 8
    s_cselect_b32 s72, 8, 0
    s_sub_u32 s71, s71, s72
    s_mul_i32 s71, s71, 24576
    s_min_u32 s71, s71, 0x200000
    s_sub_u32 s72, 0x200000, s71
    s_min_u32 s58, s72, 24576
    s_lshr_b32 s72, s80, 3
    s_cmp_eq_u32 s72, 1
    s_cselect_b32 s58, 0, s58
    s_add_u32 s56, s14, s71
    s_addc_u32 s57, s15, 0
    s_mov_b32 s59, 0x20000
    v_lshlrev_b32 v126, 7, v1
    s_mov_b32 s87, 8192
    s_mov_b32 s85, 0xffffe000
    s_branch L_pfd_3
L_pfw_4:
    s_cmp_lg_u32 s60, 1
    s_cbranch_scc1 L_pfw_5
    s_xor_b32 s77, s77, s86
    s_xor_b32 s86, s77, s86
    s_xor_b32 s77, s77, s86
    s_mov_b32 s56, s32
    s_mov_b32 s57, s33
    s_mov_b32 s58, s34
    s_mov_b32 s59, s35
    s_and_b32 s71, s77, 7
    s_mul_i32 s71, s71, 8
    v_lshrrev_b32 v2, 2, v1
    v_add_u32 v2, s71, v2
    v_mul_lo_u32 v2, v2, s64
    v_and_b32 v3, 1, v1
    v_lshl_add_u32 v2, v3, 7, v2
    s_movk_i32 s72, 256
    s_cmp_eq_u32 s65, 1024
    s_cselect_b32 s72, 2048, s72
    v_bfe_u32 v3, v1, 1, 1
    v_mul_lo_u32 v3, v3, s72
    v_add_u32 v2, v2, v3
    s_lshl_b32 s71, s62, 1
    v_add_u32 v2, s71, v2
    v_mov_b32 v3, 0x40000000
    v_cmp_gt_u32 vcc, 32, v1
    s_lshl_b32 s87, s64, 6
    s_mul_i32 s85, s87, 2
    v_cndmask_b32 v126, v3, v2, vcc
    v_add_u32 v2, 344064, v2
    v_cndmask_b32 v126, v2, v126, vcc
    s_lshl_b32 s87, s87, 1
    buffer_load_dword v127, v126, s[56:59], s85 offen
    s_add_u32 s85, s85, s87
    s_xor_b32 s77, s77, s86
    s_xor_b32 s86, s77, s86
    s_xor_b32 s77, s77, s86
    s_branch L_pfd_3
L_pfw_5:
    s_cmp_lg_u32 s60, 2
    s_cbranch_scc1 L_pfw_6
    s_and_b32 s71, s79, 3
    s_mul_i32 s71, s71, 24
    s_add_u32 s71, s71, s80
    s_cmp_ge_u32 s80, 8
    s_cselect_b32 s72, 8, 0
    s_sub_u32 s71, s71, s72
    s_mul_i32 s71, s71, 73728
    s_min_u32 s71, s71, 0x600000
    s_sub_u32 s72, 0x600000, s71
    s_min_u32 s58, s72, 73728
    s_lshr_b32 s72, s80, 3
    s_cmp_eq_u32 s72, 1
    s_cselect_b32 s58, 0, s58
    s_add_u32 s56, s6, s71
    s_addc_u32 s57, s7, 0
    s_mov_b32 s59, 0x20000
    v_lshlrev_b32 v126, 7, v1
    s_mov_b32 s87, 8192
    s_mov_b32 s85, 0xffffa000
    v_lshrrev_b32 v2, 4, v1
    v_mul_u32_u24 v2, 6144, v2
    v_and_b32 v3, 15, v1
    v_lshl_add_u32 v126, v3, 7, v2
    s_mov_b32 s87, 24576
    s_mov_b32 s85, 0xfffee000
    s_branch L_pfd_3
L_pfw_6:
    s_cmp_lg_u32 s60, 3
    s_cbranch_scc1 L_pfw_7
    v_mov_b32 v126, 0
    s_mov_b32 s56, s4
    s_mov_b32 s57, s5
    s_mov_b32 s58, 0x0
    s_mov_b32 s59, 0x20000
    s_mov_b32 s85, 0
    s_mov_b32 s87, 0
    s_branch L_pfd_3
L_pfw_7:
L_pfd_3:
    s_cmp_lg_u32 s60, 1
    s_cbranch_scc1 L_cnd_8
    s_waitcnt vmcnt(1)
L_cnd_8:
    s_cmp_lg_u32 s60, 2
    s_cbranch_scc1 L_cnd_9
    s_waitcnt vmcnt(0)
L_cnd_9:
    s_cmp_lg_u32 s60, 3
    s_cbranch_scc1 L_cnd_10
    s_waitcnt vmcnt(0)
L_cnd_10:
    v_mov_b32 v136, 0
    v_mov_b32 v137, 0
    v_mov_b32 v138, 0
    v_mov_b32 v139, 0
    v_mov_b32 v140, 0
    v_mov_b32 v141, 0
    v_mov_b32 v155, 0x3f803f80
    s_waitcnt vmcnt(3)
    v_dot2_f32_bf16 v136, v156, v128, v136
    v_dot2_f32_bf16 v138, v156, v155, v138
    v_dot2_f32_bf16 v140, v156, v156, v140
    v_dot2_f32_bf16 v137, v164, v128, v137
    v_dot2_f32_bf16 v139, v164, v155, v139
    v_dot2_f32_bf16 v141, v164, v164, v141
    v_dot2_f32_bf16 v136, v157, v129, v136
    v_dot2_f32_bf16 v138, v157, v155, v138
    v_dot2_f32_bf16 v140, v157, v157, v140
    v_dot2_f32_bf16 v137, v165, v129, v137
    v_dot2_f32_bf16 v139, v165, v155, v139
    v_dot2_f32_bf16 v141, v165, v165, v141
    v_dot2_f32_bf16 v136, v158, v130, v136
    v_dot2_f32_bf16 v138, v158, v155, v138
    v_dot2_f32_bf16 v140, v158, v158, v140
    v_dot2_f32_bf16 v137, v166, v130, v137
    v_dot2_f32_bf16 v139, v166, v155, v139
    v_dot2_f32_bf16 v141, v166, v166, v141
    v_dot2_f32_bf16 v136, v159, v131, v136
    v_dot2_f32_bf16 v138, v159, v155, v138
    v_dot2_f32_bf16 v140, v159, v159, v140
    v_dot2_f32_bf16 v137, v167, v131, v137
    v_dot2_f32_bf16 v139, v167, v155, v139
    v_dot2_f32_bf16 v141, v167, v167, v141
    v_dot2_f32_bf16 v136, v160, v132, v136
    v_dot2_f32_bf16 v138, v160, v155, v138
    v_dot2_f32_bf16 v140, v160, v160, v140
    v_dot2_f32_bf16 v137, v168, v132, v137
    v_dot2_f32_bf16 v139, v168, v155, v139
    v_dot2_f32_bf16 v141, v168, v168, v141
    v_dot2_f32_bf16 v136, v161, v133, v136
    v_dot2_f32_bf16 v138, v161, v155, v138
    v_dot2_f32_bf16 v140, v161, v161, v140
    v_dot2_f32_bf16 v137, v169, v133, v137
    v_dot2_f32_bf16 v139, v169, v155, v139
    v_dot2_f32_bf16 v141, v169, v169, v141
    v_dot2_f32_bf16 v136, v162, v134, v136
    v_dot2_f32_bf16 v138, v162, v155, v138
    v_dot2_f32_bf16 v140, v162, v162, v140
    v_dot2_f32_bf16 v137, v170, v134, v137
    v_dot2_f32_bf16 v139, v170, v155, v139
    v_dot2_f32_bf16 v141, v170, v170, v141
    v_dot2_f32_bf16 v136, v163, v135, v136
    v_dot2_f32_bf16 v138, v163, v155, v138
    v_dot2_f32_bf16 v140, v163, v163, v140
    v_dot2_f32_bf16 v137, v171, v135, v137
    v_dot2_f32_bf16 v139, v171, v155, v139
    v_dot2_f32_bf16 v141, v171, v171, v141
    s_nop 3
    ds_swizzle_b32 v142, v136 offset:0x41f
    ds_swizzle_b32 v143, v137 offset:0x41f
    ds_swizzle_b32 v144, v138 offset:0x41f
    ds_swizzle_b32 v145, v139 offset:0x41f
    ds_swizzle_b32 v146, v140 offset:0x41f
    ds_swizzle_b32 v147, v141 offset:0x41f
    s_waitcnt lgkmcnt(0)
    v_pk_add_f32 v[136:137], v[136:137], v[142:143]
    v_pk_add_f32 v[138:139], v[138:139], v[144:145]
    v_pk_add_f32 v[140:141], v[140:141], v[146:147]
    ds_swizzle_b32 v142, v136 offset:0x81f
    ds_swizzle_b32 v143, v137 offset:0x81f
    ds_swizzle_b32 v144, v138 offset:0x81f
    ds_swizzle_b32 v145, v139 offset:0x81f
    ds_swizzle_b32 v146, v140 offset:0x81f
    ds_swizzle_b32 v147, v141 offset:0x81f
    s_waitcnt lgkmcnt(0)
    v_pk_add_f32 v[136:137], v[136:137], v[142:143]
    v_pk_add_f32 v[138:139], v[138:139], v[144:145]
    v_pk_add_f32 v[140:141], v[140:141], v[146:147]
    ds_swizzle_b32 v142, v136 offset:0x101f
    ds_swizzle_b32 v143, v137 offset:0x101f
    ds_swizzle_b32 v144, v138 offset:0x101f
    ds_swizzle_b32 v145, v139 offset:0x101f
    ds_swizzle_b32 v146, v140 offset:0x101f
    ds_swizzle_b32 v147, v141 offset:0x101f
    s_waitcnt lgkmcnt(0)
    v_pk_add_f32 v[136:137], v[136:137], v[142:143]
    v_pk_add_f32 v[138:139], v[138:139], v[144:145]
    v_pk_add_f32 v[140:141], v[140:141], v[146:147]
    ds_swizzle_b32 v142, v136 offset:0x201f
    ds_swizzle_b32 v143, v137 offset:0x201f
    ds_swizzle_b32 v144, v138 offset:0x201f
    ds_swizzle_b32 v145, v139 offset:0x201f
    ds_swizzle_b32 v146, v140 offset:0x201f
    ds_swizzle_b32 v147, v141 offset:0x201f
    s_waitcnt lgkmcnt(0)
    v_pk_add_f32 v[136:137], v[136:137], v[142:143]
    v_pk_add_f32 v[138:139], v[138:139], v[144:145]
    v_pk_add_f32 v[140:141], v[140:141], v[146:147]
    ds_swizzle_b32 v142, v136 offset:0x401f
    ds_swizzle_b32 v143, v137 offset:0x401f
    ds_swizzle_b32 v144, v138 offset:0x401f
    ds_swizzle_b32 v145, v139 offset:0x401f
    ds_swizzle_b32 v146, v140 offset:0x401f
    ds_swizzle_b32 v147, v141 offset:0x401f
    s_waitcnt lgkmcnt(0)
    v_pk_add_f32 v[136:137], v[136:137], v[142:143]
    v_pk_add_f32 v[138:139], v[138:139], v[144:145]
    v_pk_add_f32 v[140:141], v[140:141], v[146:147]
    v_mov_b32 v142, v136
    v_mov_b32 v143, v137
    v_mov_b32 v144, v138
    v_mov_b32 v145, v139
    v_mov_b32 v146, v140
    v_mov_b32 v147, v141
    s_nop 1
    v_permlane32_swap_b32 v136, v142
    v_permlane32_swap_b32 v137, v143
    v_permlane32_swap_b32 v138, v144
    v_permlane32_swap_b32 v139, v145
    v_permlane32_swap_b32 v140, v146
    v_permlane32_swap_b32 v141, v147
    s_nop 1
    v_pk_add_f32 v[136:137], v[136:137], v[142:143]
    v_pk_add_f32 v[138:139], v[138:139], v[144:145]
    v_pk_add_f32 v[140:141], v[140:141], v[146:147]
    v_mov_b32 v148, v136
    v_mov_b32 v149, v138
    v_mov_b32 v150, v140
    v_cmp_eq_u32 vcc, 1, v1
    s_nop 1
    v_cndmask_b32 v148, v148, v137, vcc
    v_cndmask_b32 v149, v149, v139, vcc
    v_cndmask_b32 v150, v150, v141, vcc
    v_cvt_pk_bf16_f32 v148, v148, v148
    v_lshlrev_b32 v148, 16, v148
    v_mul_f32 v148, 0xbfb8aa3b, v148
    v_exp_f32 v148, v148
    v_mul_f32 v149, 0x3a800000, v149
    v_mul_f32 v150, 0x3a800000, v150
    v_add_f32 v148, 1.0, v148
    v_rcp_f32 v148, v148
    v_fma_f32 v150, -v149, v149, v150
    v_max_f32 v150, 0, v150
    v_cvt_pk_bf16_f32 v148, v148, v148
    v_lshlrev_b32 v148, 16, v148
    v_cvt_pk_bf16_f32 v149, v149, v149
    v_lshlrev_b32 v149, 16, v149
    v_cvt_pk_bf16_f32 v150, v150, v150
    v_lshlrev_b32 v150, 16, v150
    v_add_f32 v150, 0x3727c5ac, v150
    v_cvt_pk_bf16_f32 v150, v150, v150
    v_lshlrev_b32 v150, 16, v150
    v_sqrt_f32 v150, v150
    s_nop 0
    v_cvt_pk_bf16_f32 v150, v150, v150
    v_lshlrev_b32 v150, 16, v150
    v_rcp_f32 v152, v150
    s_nop 0
    v_sub_f32 v153, 0, v149
    s_add_u32 s48, s26, 0x2300000
    s_addc_u32 s49, s27, 0
    s_mov_b32 s50, 0x2000
    s_mov_b32 s51, 0x20000
    s_add_u32 s44, s26, 0x2680000
    s_addc_u32 s45, s27, 0
    s_mov_b32 s46, 0x4000
    s_mov_b32 s47, 0x20000
    v_add_u32 v3, s68, v1
    v_lshlrev_b32 v2, 3, v3
    v_lshlrev_b32 v3, 2, v3
    s_mov_b64 exec, 3
    buffer_store_dword v148, v3, s[48:51], 0 offen sc1
    buffer_store_dwordx2 v[152:153], v2, s[44:47], 0 offen sc1
    s_mov_b64 exec, -1
    s_nop 0
    s_branch L_A
L_M:
    s_lshl_b32 s62, s63, 7
    v_lshrrev_b32 v5, 4, v1
    s_lshl_b32 s71, s75, 4
    v_add_u32 v3, s71, v5
    s_mov_b32 s72, 2048
    v_mul_lo_u32 v3, v3, s72
    v_and_b32 v4, 15, v1
    v_lshlrev_b32 v5, 2, v5
    v_xor_b32 v4, v4, v5
    v_lshl_add_u32 v3, v4, 4, v3
    s_lshl_b32 s71, s62, 1
    v_add_u32 v3, s71, v3
    v_add_u32 v20, 0x0, v3
    v_add_u32 v21, 0x1c00, v3
    v_xor_b32 v3, 32, v3
    v_add_u32 v22, 0x3800, v3
    v_add_u32 v23, 0x5400, v3
    s_mov_b32 s34, 0x200000
    s_lshr_b32 s72, s63, 2
    s_add_u32 s72, s72, 1
    s_sub_u32 s73, 0, s72
    s_bitcmp0_b32 s63, 1
    s_cselect_b32 s66, s72, s73
    s_lshl_b32 s71, s66, 11
    v_subrev_u32 v28, s71, v16
    v_subrev_u32 v29, s71, v17
    v_subrev_u32 v30, s71, v18
    v_subrev_u32 v31, s71, v19
    s_waitcnt lgkmcnt(0)
    s_mov_b32 s28, s4
    s_mov_b32 s29, s5
    s_mov_b32 s32, s12
    s_mov_b32 s33, s13
    s_cmp_lt_u32 s60, 4
    s_cbranch_scc1 L_M0
    s_lshl_b32 s85, s63, 8
    s_add_u32 m0, s70, 0
    s_nop 0
    buffer_load_dwordx4 v28, s[28:31], s68 offen offset:0 lds
    buffer_load_dwordx4 v29, s[28:31], s68 offen offset:1024 lds
    buffer_load_dwordx4 v30, s[28:31], s68 offen offset:2048 lds
    buffer_load_dwordx4 v31, s[28:31], s68 offen offset:3072 lds
    s_add_u32 m0, s70, 16384
    s_add_u32 s68, s68, 128
    buffer_load_dwordx4 v20, s[32:35], s69 offen offset:0 lds
    buffer_load_dwordx4 v21, s[32:35], s69 offen offset:1024 lds
    buffer_load_dwordx4 v22, s[32:35], s69 offen offset:2048 lds
    buffer_load_dwordx4 v23, s[32:35], s69 offen offset:3072 lds
    s_add_u32 s69, s69, 131072
    s_add_u32 m0, s70, 32768
    s_nop 0
    buffer_load_dwordx4 v28, s[28:31], s68 offen offset:0 lds
    buffer_load_dwordx4 v29, s[28:31], s68 offen offset:1024 lds
    buffer_load_dwordx4 v30, s[28:31], s68 offen offset:2048 lds
    buffer_load_dwordx4 v31, s[28:31], s68 offen offset:3072 lds
    s_add_u32 m0, s70, 49152
    s_add_u32 s68, s68, 128
    buffer_load_dwordx4 v20, s[32:35], s69 offen offset:0 lds
    buffer_load_dwordx4 v21, s[32:35], s69 offen offset:1024 lds
    buffer_load_dwordx4 v22, s[32:35], s69 offen offset:2048 lds
    buffer_load_dwordx4 v23, s[32:35], s69 offen offset:3072 lds
    s_add_u32 s69, s69, 131072
    s_add_u32 m0, s70, 65536
    s_nop 0
    buffer_load_dwordx4 v28, s[28:31], s68 offen offset:0 lds
    buffer_load_dwordx4 v29, s[28:31], s68 offen offset:1024 lds
    buffer_load_dwordx4 v30, s[28:31], s68 offen offset:2048 lds
    buffer_load_dwordx4 v31, s[28:31], s68 offen offset:3072 lds
    s_add_u32 m0, s70, 81920
    s_add_u32 s68, s68, 128
    buffer_load_dwordx4 v20, s[32:35], s69 offen offset:0 lds
    buffer_load_dwordx4 v21, s[32:35], s69 offen offset:1024 lds
    buffer_load_dwordx4 v22, s[32:35], s69 offen offset:2048 lds
    buffer_load_dwordx4 v23, s[32:35], s69 offen offset:3072 lds
    s_add_u32 s69, s69, 131072
    s_branch L_M_loader
L_M0:
    s_setprio 2
    s_lshl_b32 s68, s76, 3
    s_add_u32 s68, s68, s63
    s_lshl_b32 s68, s68, 3
    s_add_u32 s68, s68, s61
    s_lshl_b32 s71, s60, 1
    s_add_u32 s68, s68, s71
    s_mov_b32 s48, s20
    s_mov_b32 s49, s21
    s_mov_b32 s50, 0x800
    s_mov_b32 s51, 0x20000
    s_mov_b32 s44, s4
    s_mov_b32 s45, s5
    s_mov_b32 s46, 0x400000
    s_mov_b32 s47, 0x20000
    v_lshlrev_b32 v2, 4, v1
    buffer_load_dwordx4 v[128:131], v2, s[48:51], 0 offen
    buffer_load_dwordx4 v[132:135], v2, s[48:51], 0 offen offset:1024
    s_lshl_b32 s71, s68, 11
    buffer_load_dwordx4 v[156:159], v2, s[44:47], s71 offen
    buffer_load_dwordx4 v[160:163], v2, s[44:47], s71 offen offset:1024
    s_add_u32 s71, s71, 2048
    buffer_load_dwordx4 v[164:167], v2, s[44:47], s71 offen
    buffer_load_dwordx4 v[168:171], v2, s[44:47], s71 offen offset:1024
    s_add_u32 s71, s71, 2048
    s_add_u32 s36, s26, 0x400000
    s_addc_u32 s37, s27, 0
    s_mov_b32 s38, 0x400000
    s_mov_b32 s39, 0x20000
    v_and_b32 v2, 15, v1
    s_lshr_b32 s71, s60, 1
    s_lshl_b32 s71, s71, 6
    v_add_u32 v2, s71, v2
    v_lshlrev_b32 v2, 7, v2
    v_bfe_u32 v3, v1, 1, 3
    v_lshrrev_b32 v16, 4, v1
    v_xor_b32 v3, v3, v16
    v_xor_b32 v17, 0, v3
    v_lshl_add_u32 v8, v17, 4, v2
    v_mov_b32 v4, v8
    v_xor_b32 v17, 4, v3
    v_lshl_add_u32 v9, v17, 4, v2
    v_mov_b32 v5, v9
    v_bfe_u32 v2, v1, 2, 2
    v_lshl_add_u32 v18, v16, 3, v2
    v_and_b32 v3, 1, v1
    v_lshlrev_b32 v3, 3, v3
    v_lshl_add_u32 v3, v18, 8, v3
    v_bfe_u32 v17, v1, 1, 1
    s_and_b32 s71, s60, 1
    s_lshl_b32 s71, s71, 3
    v_add_u32 v17, s71, v17
    v_lshlrev_b32 v2, 2, v2
    v_xor_b32 v17, v17, v2
    v_and_b32 v2, 1, v16
    v_lshlrev_b32 v2, 1, v2
    v_xor_b32 v17, v17, v2
    v_xor_b32 v19, 0, v17
    v_lshl_add_u32 v19, v19, 4, v3
    v_add_u32 v10, 16384, v19
    v_mov_b32 v6, v10
    v_xor_b32 v19, 2, v17
    v_lshl_add_u32 v19, v19, 4, v3
    v_add_u32 v11, 16384, v19
    v_mov_b32 v7, v11
    v_xor_b32 v19, 4, v17
    v_lshl_add_u32 v19, v19, 4, v3
    v_add_u32 v14, 16384, v19
    v_mov_b32 v12, v14
    v_xor_b32 v19, 6, v17
    v_lshl_add_u32 v19, v19, 4, v3
    v_add_u32 v15, 16384, v19
    v_mov_b32 v13, v15
    s_mov_b32 s70, 0
    v_mov_b32 v208, 0x3f803f80
    v_mov_b32 v209, 0x3f803f80
    v_mov_b32 v210, 0x3f803f80
    v_mov_b32 v211, 0x3f803f80
    v_mov_b32 v136, 0
    v_mov_b32 v137, 0
    v_mov_b32 v138, 0
    v_mov_b32 v139, 0
    v_mov_b32 v140, 0
    v_mov_b32 v141, 0
    v_mov_b32 v155, 0x3f803f80
    s_waitcnt vmcnt(0)
    v_dot2_f32_bf16 v136, v156, v128, v136
    v_dot2_f32_bf16 v138, v156, v155, v138
    v_dot2_f32_bf16 v140, v156, v156, v140
    v_dot2_f32_bf16 v137, v164, v128, v137
    v_dot2_f32_bf16 v139, v164, v155, v139
    v_dot2_f32_bf16 v141, v164, v164, v141
    v_dot2_f32_bf16 v136, v157, v129, v136
    v_dot2_f32_bf16 v138, v157, v155, v138
    v_dot2_f32_bf16 v140, v157, v157, v140
    v_dot2_f32_bf16 v137, v165, v129, v137
    v_dot2_f32_bf16 v139, v165, v155, v139
    v_dot2_f32_bf16 v141, v165, v165, v141
    v_dot2_f32_bf16 v136, v158, v130, v136
    v_dot2_f32_bf16 v138, v158, v155, v138
    v_dot2_f32_bf16 v140, v158, v158, v140
    v_dot2_f32_bf16 v137, v166, v130, v137
    v_dot2_f32_bf16 v139, v166, v155, v139
    v_dot2_f32_bf16 v141, v166, v166, v141
    v_dot2_f32_bf16 v136, v159, v131, v136
    v_dot2_f32_bf16 v138, v159, v155, v138
    v_dot2_f32_bf16 v140, v159, v159, v140
    v_dot2_f32_bf16 v137, v167, v131, v137
    v_dot2_f32_bf16 v139, v167, v155, v139
    v_dot2_f32_bf16 v141, v167, v167, v141
    v_dot2_f32_bf16 v136, v160, v132, v136
    v_dot2_f32_bf16 v138, v160, v155, v138
    v_dot2_f32_bf16 v140, v160, v160, v140
    v_dot2_f32_bf16 v137, v168, v132, v137
    v_dot2_f32_bf16 v139, v168, v155, v139
    v_dot2_f32_bf16 v141, v168, v168, v141
    v_dot2_f32_bf16 v136, v161, v133, v136
    v_dot2_f32_bf16 v138, v161, v155, v138
    v_dot2_f32_bf16 v140, v161, v161, v140
    v_dot2_f32_bf16 v137, v169, v133, v137
    v_dot2_f32_bf16 v139, v169, v155, v139
    v_dot2_f32_bf16 v141, v169, v169, v141
    v_dot2_f32_bf16 v136, v162, v134, v136
    v_dot2_f32_bf16 v138, v162, v155, v138
    v_dot2_f32_bf16 v140, v162, v162, v140
    v_dot2_f32_bf16 v137, v170, v134, v137
    v_dot2_f32_bf16 v139, v170, v155, v139
    v_dot2_f32_bf16 v141, v170, v170, v141
    v_dot2_f32_bf16 v136, v163, v135, v136
    v_dot2_f32_bf16 v138, v163, v155, v138
    v_dot2_f32_bf16 v140, v163, v163, v140
    v_dot2_f32_bf16 v137, v171, v135, v137
    v_dot2_f32_bf16 v139, v171, v155, v139
    v_dot2_f32_bf16 v141, v171, v171, v141
    s_nop 3
    ds_swizzle_b32 v142, v136 offset:0x41f
    ds_swizzle_b32 v143, v137 offset:0x41f
    ds_swizzle_b32 v144, v138 offset:0x41f
    ds_swizzle_b32 v145, v139 offset:0x41f
    ds_swizzle_b32 v146, v140 offset:0x41f
    ds_swizzle_b32 v147, v141 offset:0x41f
    s_waitcnt lgkmcnt(0)
    v_pk_add_f32 v[136:137], v[136:137], v[142:143]
    v_pk_add_f32 v[138:139], v[138:139], v[144:145]
    v_pk_add_f32 v[140:141], v[140:141], v[146:147]
    ds_swizzle_b32 v142, v136 offset:0x81f
    ds_swizzle_b32 v143, v137 offset:0x81f
    ds_swizzle_b32 v144, v138 offset:0x81f
    ds_swizzle_b32 v145, v139 offset:0x81f
    ds_swizzle_b32 v146, v140 offset:0x81f
    ds_swizzle_b32 v147, v141 offset:0x81f
    s_waitcnt lgkmcnt(0)
    v_pk_add_f32 v[136:137], v[136:137], v[142:143]
    v_pk_add_f32 v[138:139], v[138:139], v[144:145]
    v_pk_add_f32 v[140:141], v[140:141], v[146:147]
    ds_swizzle_b32 v142, v136 offset:0x101f
    ds_swizzle_b32 v143, v137 offset:0x101f
    ds_swizzle_b32 v144, v138 offset:0x101f
    ds_swizzle_b32 v145, v139 offset:0x101f
    ds_swizzle_b32 v146, v140 offset:0x101f
    ds_swizzle_b32 v147, v141 offset:0x101f
    s_waitcnt lgkmcnt(0)
    v_pk_add_f32 v[136:137], v[136:137], v[142:143]
    v_pk_add_f32 v[138:139], v[138:139], v[144:145]
    v_pk_add_f32 v[140:141], v[140:141], v[146:147]
    ds_swizzle_b32 v142, v136 offset:0x201f
    ds_swizzle_b32 v143, v137 offset:0x201f
    ds_swizzle_b32 v144, v138 offset:0x201f
    ds_swizzle_b32 v145, v139 offset:0x201f
    ds_swizzle_b32 v146, v140 offset:0x201f
    ds_swizzle_b32 v147, v141 offset:0x201f
    s_waitcnt lgkmcnt(0)
    v_pk_add_f32 v[136:137], v[136:137], v[142:143]
    v_pk_add_f32 v[138:139], v[138:139], v[144:145]
    v_pk_add_f32 v[140:141], v[140:141], v[146:147]
    ds_swizzle_b32 v142, v136 offset:0x401f
    ds_swizzle_b32 v143, v137 offset:0x401f
    ds_swizzle_b32 v144, v138 offset:0x401f
    ds_swizzle_b32 v145, v139 offset:0x401f
    ds_swizzle_b32 v146, v140 offset:0x401f
    ds_swizzle_b32 v147, v141 offset:0x401f
    s_waitcnt lgkmcnt(0)
    v_pk_add_f32 v[136:137], v[136:137], v[142:143]
    v_pk_add_f32 v[138:139], v[138:139], v[144:145]
    v_pk_add_f32 v[140:141], v[140:141], v[146:147]
    v_mov_b32 v142, v136
    v_mov_b32 v143, v137
    v_mov_b32 v144, v138
    v_mov_b32 v145, v139
    v_mov_b32 v146, v140
    v_mov_b32 v147, v141
    s_nop 1
    v_permlane32_swap_b32 v136, v142
    v_permlane32_swap_b32 v137, v143
    v_permlane32_swap_b32 v138, v144
    v_permlane32_swap_b32 v139, v145
    v_permlane32_swap_b32 v140, v146
    v_permlane32_swap_b32 v141, v147
    s_nop 1
    v_pk_add_f32 v[136:137], v[136:137], v[142:143]
    v_pk_add_f32 v[138:139], v[138:139], v[144:145]
    v_pk_add_f32 v[140:141], v[140:141], v[146:147]
    v_mov_b32 v148, v136
    v_mov_b32 v149, v138
    v_mov_b32 v150, v140
    v_cmp_eq_u32 vcc, 1, v1
    s_nop 1
    v_cndmask_b32 v148, v148, v137, vcc
    v_cndmask_b32 v149, v149, v139, vcc
    v_cndmask_b32 v150, v150, v141, vcc
    v_cvt_pk_bf16_f32 v148, v148, v148
    v_lshlrev_b32 v148, 16, v148
    v_mul_f32 v148, 0xbfb8aa3b, v148
    v_exp_f32 v148, v148
    v_mul_f32 v149, 0x3a800000, v149
    v_mul_f32 v150, 0x3a800000, v150
    v_add_f32 v148, 1.0, v148
    v_rcp_f32 v148, v148
    v_fma_f32 v150, -v149, v149, v150
    v_max_f32 v150, 0, v150
    v_cvt_pk_bf16_f32 v148, v148, v148
    v_lshlrev_b32 v148, 16, v148
    v_cvt_pk_bf16_f32 v149, v149, v149
    v_lshlrev_b32 v149, 16, v149
    v_cvt_pk_bf16_f32 v150, v150, v150
    v_lshlrev_b32 v150, 16, v150
    v_add_f32 v150, 0x3727c5ac, v150
    v_cvt_pk_bf16_f32 v150, v150, v150
    v_lshlrev_b32 v150, 16, v150
    v_sqrt_f32 v150, v150
    s_nop 0
    v_cvt_pk_bf16_f32 v150, v150, v150
    v_lshlrev_b32 v150, 16, v150
    v_rcp_f32 v152, v150
    s_nop 0
    v_sub_f32 v153, 0, v149
    s_add_u32 s48, s26, 0x2300000
    s_addc_u32 s49, s27, 0
    s_mov_b32 s50, 0x2000
    s_mov_b32 s51, 0x20000
    s_add_u32 s44, s26, 0x2680000
    s_addc_u32 s45, s27, 0
    s_mov_b32 s46, 0x4000
    s_mov_b32 s47, 0x20000
    v_add_u32 v3, s68, v1
    v_lshlrev_b32 v2, 3, v3
    v_lshlrev_b32 v3, 2, v3
    s_mov_b64 exec, 3
    buffer_store_dword v148, v3, s[48:51], 0 offen sc1
    buffer_store_dwordx2 v[152:153], v2, s[44:47], 0 offen sc1
    s_mov_b64 exec, -1
    s_nop 0
    s_lshr_b32 s65, s60, 1
    s_lshl_b32 s65, s65, 6
    v_xor_b32 v10, s65, v10
    v_xor_b32 v6, s65, v6
    v_xor_b32 v11, s65, v11
    v_xor_b32 v7, s65, v7
    v_xor_b32 v14, s65, v14
    v_xor_b32 v12, s65, v12
    v_xor_b32 v15, s65, v15
    v_xor_b32 v13, s65, v13
    s_lshl_b32 s71, s60, 11
    s_add_u32 s71, s71, 131072
    v_lshlrev_b32 v212, 4, v1
    v_add_u32 v212, s71, v212
    v_xor_b32 v213, 0x1000, v212
    s_barrier
    ds_read_b64_tr_b16 v[32:33], v6 offset:0
    ds_read_b64_tr_b16 v[34:35], v6 offset:1024
    ds_read_b128 v[16:19], v4 offset:0
    ds_read_b64_tr_b16 v[36:37], v7 offset:0
    ds_read_b64_tr_b16 v[38:39], v7 offset:1024
    ds_read_b128 v[20:23], v4 offset:2048
    ds_read_b64_tr_b16 v[40:41], v12 offset:0
    ds_read_b64_tr_b16 v[42:43], v12 offset:1024
    ds_read_b128 v[24:27], v4 offset:4096
    ds_read_b64_tr_b16 v[44:45], v13 offset:0
    ds_read_b64_tr_b16 v[46:47], v13 offset:1024
    ds_read_b128 v[28:31], v4 offset:6144
    s_waitcnt lgkmcnt(0)
    v_mfma_f32_16x16x32_bf16 v[128:131], v[32:35], v[16:19], 0
    ds_read_b64_tr_b16 v[64:65], v6 offset:8192
    ds_read_b64_tr_b16 v[66:67], v6 offset:9216
    v_mfma_f32_16x16x32_bf16 v[144:147], v[32:35], v[20:23], 0
    ds_read_b128 v[48:51], v5 offset:0
    ds_read_b64_tr_b16 v[68:69], v7 offset:8192
    v_mfma_f32_16x16x32_bf16 v[160:163], v[32:35], v[24:27], 0
    ds_read_b64_tr_b16 v[70:71], v7 offset:9216
    ds_read_b128 v[52:55], v5 offset:2048
    v_mfma_f32_16x16x32_bf16 v[176:179], v[32:35], v[28:31], 0
    ds_read_b64_tr_b16 v[72:73], v12 offset:8192
    ds_read_b64_tr_b16 v[74:75], v12 offset:9216
    v_mfma_f32_16x16x32_bf16 v[180:183], v[36:39], v[28:31], 0
    ds_read_b128 v[56:59], v5 offset:4096
    ds_read_b64_tr_b16 v[76:77], v13 offset:8192
    v_mfma_f32_16x16x32_bf16 v[164:167], v[36:39], v[24:27], 0
    ds_read_b64_tr_b16 v[78:79], v13 offset:9216
    ds_read_b128 v[60:63], v5 offset:6144
    v_mfma_f32_16x16x32_bf16 v[148:151], v[36:39], v[20:23], 0
    s_add_u32 s70, s70, 32768
    s_cmp_eq_u32 s70, 131072
    v_mfma_f32_16x16x32_bf16 v[132:135], v[36:39], v[16:19], 0
    s_cselect_b32 s70, 0, s70
    v_add_u32 v4, s70, v8
    v_mfma_f32_16x16x32_bf16 v[136:139], v[40:43], v[16:19], 0
    v_add_u32 v5, s70, v9
    v_add_u32 v6, s70, v10
    v_mfma_f32_16x16x32_bf16 v[152:155], v[40:43], v[20:23], 0
    v_add_u32 v7, s70, v11
    v_add_u32 v12, s70, v14
    v_mfma_f32_16x16x32_bf16 v[168:171], v[40:43], v[24:27], 0
    v_add_u32 v13, s70, v15
    v_mfma_f32_16x16x32_bf16 v[184:187], v[40:43], v[28:31], 0
    v_mfma_f32_16x16x32_bf16 v[188:191], v[44:47], v[28:31], 0
    v_mfma_f32_16x16x32_bf16 v[172:175], v[44:47], v[24:27], 0
    v_mfma_f32_16x16x32_bf16 v[156:159], v[44:47], v[20:23], 0
    v_mfma_f32_16x16x32_bf16 v[140:143], v[44:47], v[16:19], 0
    v_mfma_f32_16x16x32_bf16 v[192:195], v[32:35], v[208:211], 0
    v_mfma_f32_16x16x32_bf16 v[196:199], v[36:39], v[208:211], 0
    s_waitcnt lgkmcnt(0)
    v_mfma_f32_16x16x32_bf16 v[128:131], v[64:67], v[48:51], v[128:131]
    s_barrier
    v_mfma_f32_16x16x32_bf16 v[144:147], v[64:67], v[52:55], v[144:147]
    ds_read_b64_tr_b16 v[32:33], v6 offset:0
    ds_read_b64_tr_b16 v[34:35], v6 offset:1024
    v_mfma_f32_16x16x32_bf16 v[160:163], v[64:67], v[56:59], v[160:163]
    ds_read_b128 v[16:19], v4 offset:0
    ds_read_b64_tr_b16 v[36:37], v7 offset:0
    v_mfma_f32_16x16x32_bf16 v[176:179], v[64:67], v[60:63], v[176:179]
    ds_read_b64_tr_b16 v[38:39], v7 offset:1024
    ds_read_b128 v[20:23], v4 offset:2048
    v_mfma_f32_16x16x32_bf16 v[180:183], v[68:71], v[60:63], v[180:183]
    ds_read_b64_tr_b16 v[40:41], v12 offset:0
    ds_read_b64_tr_b16 v[42:43], v12 offset:1024
    v_mfma_f32_16x16x32_bf16 v[164:167], v[68:71], v[56:59], v[164:167]
    ds_read_b128 v[24:27], v4 offset:4096
    ds_read_b64_tr_b16 v[44:45], v13 offset:0
    v_mfma_f32_16x16x32_bf16 v[148:151], v[68:71], v[52:55], v[148:151]
    ds_read_b64_tr_b16 v[46:47], v13 offset:1024
    ds_read_b128 v[28:31], v4 offset:6144
    v_mfma_f32_16x16x32_bf16 v[132:135], v[68:71], v[48:51], v[132:135]
    v_mfma_f32_16x16x32_bf16 v[136:139], v[72:75], v[48:51], v[136:139]
    v_mfma_f32_16x16x32_bf16 v[152:155], v[72:75], v[52:55], v[152:155]
    v_mfma_f32_16x16x32_bf16 v[168:171], v[72:75], v[56:59], v[168:171]
    v_mfma_f32_16x16x32_bf16 v[184:187], v[72:75], v[60:63], v[184:187]
    v_mfma_f32_16x16x32_bf16 v[188:191], v[76:79], v[60:63], v[188:191]
    v_mfma_f32_16x16x32_bf16 v[172:175], v[76:79], v[56:59], v[172:175]
    v_mfma_f32_16x16x32_bf16 v[156:159], v[76:79], v[52:55], v[156:159]
    v_mfma_f32_16x16x32_bf16 v[140:143], v[76:79], v[48:51], v[140:143]
    v_mfma_f32_16x16x32_bf16 v[192:195], v[64:67], v[208:211], v[192:195]
    v_mfma_f32_16x16x32_bf16 v[196:199], v[68:71], v[208:211], v[196:199]
    s_cmp_lg_u32 s60, 0
    s_cbranch_scc1 L_w0_11
    s_mov_b32 s48, s24
    s_mov_b32 s49, s25
    s_mov_b32 s50, 0x100
    s_mov_b32 s51, 0x20000
    v_mov_b32 v121, 252
    v_mov_b32 v122, 0
    s_mov_b32 s71, 252
    v_mov_b32 v121, s71
    s_mov_b32 s71, 1
    v_writelane_b32 v122, s71, 0
    buffer_load_dword v123, v121, s[48:51], 0 offen sc1
L_w0_11:
    s_mov_b32 s81, 0
    s_mov_b32 s67, 1
L_sl_12:
    s_waitcnt lgkmcnt(0)
    v_mfma_f32_16x16x32_bf16 v[128:131], v[32:35], v[16:19], v[128:131]
    ds_read_b64_tr_b16 v[64:65], v6 offset:8192
    ds_read_b64_tr_b16 v[66:67], v6 offset:9216
    v_mfma_f32_16x16x32_bf16 v[144:147], v[32:35], v[20:23], v[144:147]
    ds_read_b128 v[48:51], v5 offset:0
    ds_read_b64_tr_b16 v[68:69], v7 offset:8192
    v_mfma_f32_16x16x32_bf16 v[160:163], v[32:35], v[24:27], v[160:163]
    ds_read_b64_tr_b16 v[70:71], v7 offset:9216
    ds_read_b128 v[52:55], v5 offset:2048
    v_mfma_f32_16x16x32_bf16 v[176:179], v[32:35], v[28:31], v[176:179]
    ds_read_b64_tr_b16 v[72:73], v12 offset:8192
    ds_read_b64_tr_b16 v[74:75], v12 offset:9216
    v_mfma_f32_16x16x32_bf16 v[180:183], v[36:39], v[28:31], v[180:183]
    ds_read_b128 v[56:59], v5 offset:4096
    ds_read_b64_tr_b16 v[76:77], v13 offset:8192
    v_mfma_f32_16x16x32_bf16 v[164:167], v[36:39], v[24:27], v[164:167]
    ds_read_b64_tr_b16 v[78:79], v13 offset:9216
    ds_read_b128 v[60:63], v5 offset:6144
    v_mfma_f32_16x16x32_bf16 v[148:151], v[36:39], v[20:23], v[148:151]
    s_add_u32 s70, s70, 32768
    s_cmp_eq_u32 s70, 131072
    v_mfma_f32_16x16x32_bf16 v[132:135], v[36:39], v[16:19], v[132:135]
    s_cselect_b32 s70, 0, s70
    v_add_u32 v4, s70, v8
    v_mfma_f32_16x16x32_bf16 v[136:139], v[40:43], v[16:19], v[136:139]
    v_add_u32 v5, s70, v9
    v_add_u32 v6, s70, v10
    v_mfma_f32_16x16x32_bf16 v[152:155], v[40:43], v[20:23], v[152:155]
    v_add_u32 v7, s70, v11
    v_add_u32 v12, s70, v14
    v_mfma_f32_16x16x32_bf16 v[168:171], v[40:43], v[24:27], v[168:171]
    v_add_u32 v13, s70, v15
    v_mfma_f32_16x16x32_bf16 v[184:187], v[40:43], v[28:31], v[184:187]
    v_mfma_f32_16x16x32_bf16 v[188:191], v[44:47], v[28:31], v[188:191]
    v_mfma_f32_16x16x32_bf16 v[172:175], v[44:47], v[24:27], v[172:175]
    v_mfma_f32_16x16x32_bf16 v[156:159], v[44:47], v[20:23], v[156:159]
    v_mfma_f32_16x16x32_bf16 v[140:143], v[44:47], v[16:19], v[140:143]
    v_mfma_f32_16x16x32_bf16 v[192:195], v[32:35], v[208:211], v[192:195]
    v_mfma_f32_16x16x32_bf16 v[196:199], v[36:39], v[208:211], v[196:199]
    s_waitcnt lgkmcnt(0)
    v_mfma_f32_16x16x32_bf16 v[128:131], v[64:67], v[48:51], v[128:131]
    s_barrier
    v_mfma_f32_16x16x32_bf16 v[144:147], v[64:67], v[52:55], v[144:147]
    ds_read_b64_tr_b16 v[32:33], v6 offset:0
    ds_read_b64_tr_b16 v[34:35], v6 offset:1024
    v_mfma_f32_16x16x32_bf16 v[160:163], v[64:67], v[56:59], v[160:163]
    ds_read_b128 v[16:19], v4 offset:0
    ds_read_b64_tr_b16 v[36:37], v7 offset:0
    v_mfma_f32_16x16x32_bf16 v[176:179], v[64:67], v[60:63], v[176:179]
    ds_read_b64_tr_b16 v[38:39], v7 offset:1024
    ds_read_b128 v[20:23], v4 offset:2048
    v_mfma_f32_16x16x32_bf16 v[180:183], v[68:71], v[60:63], v[180:183]
    ds_read_b64_tr_b16 v[40:41], v12 offset:0
    ds_read_b64_tr_b16 v[42:43], v12 offset:1024
    v_mfma_f32_16x16x32_bf16 v[164:167], v[68:71], v[56:59], v[164:167]
    ds_read_b128 v[24:27], v4 offset:4096
    ds_read_b64_tr_b16 v[44:45], v13 offset:0
    v_mfma_f32_16x16x32_bf16 v[148:151], v[68:71], v[52:55], v[148:151]
    ds_read_b64_tr_b16 v[46:47], v13 offset:1024
    ds_read_b128 v[28:31], v4 offset:6144
    v_mfma_f32_16x16x32_bf16 v[132:135], v[68:71], v[48:51], v[132:135]
    v_mfma_f32_16x16x32_bf16 v[136:139], v[72:75], v[48:51], v[136:139]
    v_mfma_f32_16x16x32_bf16 v[152:155], v[72:75], v[52:55], v[152:155]
    v_mfma_f32_16x16x32_bf16 v[168:171], v[72:75], v[56:59], v[168:171]
    v_mfma_f32_16x16x32_bf16 v[184:187], v[72:75], v[60:63], v[184:187]
    v_mfma_f32_16x16x32_bf16 v[188:191], v[76:79], v[60:63], v[188:191]
    v_mfma_f32_16x16x32_bf16 v[172:175], v[76:79], v[56:59], v[172:175]
    v_mfma_f32_16x16x32_bf16 v[156:159], v[76:79], v[52:55], v[156:159]
    v_mfma_f32_16x16x32_bf16 v[140:143], v[76:79], v[48:51], v[140:143]
    v_mfma_f32_16x16x32_bf16 v[192:195], v[64:67], v[208:211], v[192:195]
    v_mfma_f32_16x16x32_bf16 v[196:199], v[68:71], v[208:211], v[196:199]
    s_sub_u32 s67, s67, 1
    s_cmp_lg_u32 s67, 0
    s_cbranch_scc1 L_sl_12
    s_cmp_lg_u32 s81, 0
    s_cbranch_scc1 L_sn_13
    s_waitcnt vmcnt(0)
    s_mov_b32 s81, 1
    s_mov_b32 s67, 1
    s_branch L_sl_12
L_sn_13:
    s_cmp_lg_u32 s81, 1
    s_cbranch_scc1 L_sn_14
    s_cmp_lg_u32 s60, 0
    s_cbranch_scc1 L_w0_15
    s_waitcnt vmcnt(0)
    v_cmp_lt_u32 vcc, v123, v122
    s_nop 0
    s_cmp_eq_u64 vcc, 0
    s_cbranch_scc1 L_apolld_17
    s_mov_b32 s48, s24
    s_mov_b32 s49, s25
    s_mov_b32 s50, 0x100
    s_mov_b32 s51, 0x20000
    s_mov_b32 s72, 0x40000
L_apoll_16:
    buffer_load_dword v123, v121, s[48:51], 0 offen sc1
    s_waitcnt vmcnt(0)
    v_cmp_lt_u32 vcc, v123, v122
    s_sub_u32 s72, s72, 1
    s_cmp_eq_u32 s72, 0
    s_cbranch_scc1 L_apolld_17
    s_cmp_eq_u64 vcc, 0
    s_cbranch_scc1 L_apolld_17
    s_sleep 4
    s_branch L_apoll_16
L_apolld_17:
    s_add_u32 s48, s26, 0x2700000
    s_addc_u32 s49, s27, 0
    s_mov_b32 s50, 0x8000
    s_mov_b32 s51, 0x20000
    s_lshl_b32 s71, s77, 7
    s_add_u32 s71, s71, 14336
    v_mov_b32 v2, s71
    v_mov_b32 v3, 1
    s_mov_b64 exec, 1
    buffer_atomic_add v3, v2, s[48:51], 0 offen sc1
    s_mov_b64 exec, -1
L_w0_15:
    s_mov_b32 s81, 2
    s_mov_b32 s67, 7
    s_branch L_sl_12
L_sn_14:
    s_cmp_lg_u32 s81, 2
    s_cbranch_scc1 L_sn_18
    s_cmp_lg_u32 s60, 0
    s_cbranch_scc1 L_w0_19
    s_max_u32 s73, s77, 1
    s_sub_u32 s73, s73, 1
    s_min_u32 s74, s77, 14
    s_add_u32 s74, s74, 1
    s_add_u32 s48, s26, 0x2700000
    s_addc_u32 s49, s27, 0
    s_mov_b32 s50, 0x8000
    s_mov_b32 s51, 0x20000
    v_mov_b32 v121, 0
    v_mov_b32 v122, 0
    s_lshl_b32 s71, s77, 7
    s_add_u32 s71, s71, 14336
    v_mov_b32 v121, s71
    s_mov_b32 s71, 16
    v_writelane_b32 v122, s71, 0
    s_lshl_b32 s71, s73, 7
    s_add_u32 s71, s71, 14336
    v_writelane_b32 v121, s71, 1
    s_mov_b32 s71, 16
    v_writelane_b32 v122, s71, 1
    s_lshl_b32 s71, s74, 7
    s_add_u32 s71, s71, 14336
    v_writelane_b32 v121, s71, 2
    s_mov_b32 s71, 16
    v_writelane_b32 v122, s71, 2
    buffer_load_dword v123, v121, s[48:51], 0 offen sc1
L_w0_19:
    s_mov_b32 s81, 3
    s_mov_b32 s67, 2
    s_branch L_sl_12
L_sn_18:
    s_cmp_lg_u32 s81, 3
    s_cbranch_scc1 L_sn_20
    s_cmp_lg_u32 s60, 0
    s_cbranch_scc1 L_w0_21
    s_waitcnt vmcnt(0)
    v_cmp_lt_u32 vcc, v123, v122
    s_nop 0
    s_cmp_eq_u64 vcc, 0
    s_cbranch_scc1 L_apolld_23
    s_add_u32 s48, s26, 0x2700000
    s_addc_u32 s49, s27, 0
    s_mov_b32 s50, 0x8000
    s_mov_b32 s51, 0x20000
    s_mov_b32 s72, 0x40000
L_apoll_22:
    buffer_load_dword v123, v121, s[48:51], 0 offen sc1
    s_waitcnt vmcnt(0)
    v_cmp_lt_u32 vcc, v123, v122
    s_sub_u32 s72, s72, 1
    s_cmp_eq_u32 s72, 0
    s_cbranch_scc1 L_apolld_23
    s_cmp_eq_u64 vcc, 0
    s_cbranch_scc1 L_apolld_23
    s_sleep 4
    s_branch L_apoll_22
L_apolld_23:
L_w0_21:
    s_mov_b32 s81, 4
    s_mov_b32 s67, 4
    s_branch L_sl_12
L_sn_20:
    s_waitcnt vmcnt(0) lgkmcnt(0)
    s_lshr_b32 s71, s60, 1
    s_lshl_b32 s71, s71, 10
    s_add_u32 s71, s71, 150080
    v_and_b32 v2, 15, v1
    v_lshlrev_b32 v3, 4, v2
    v_add_u32 v3, s71, v3
    ds_read_b128 v[16:19], v3 offset:0
    ds_read_b128 v[20:23], v3 offset:256
    ds_read_b128 v[24:27], v3 offset:512
    ds_read_b128 v[28:31], v3 offset:768
    s_lshr_b32 s73, s60, 1
    s_lshl_b32 s73, s73, 6
    s_add_u32 s73, s73, s61
    s_and_b32 s74, s60, 1
    s_lshl_b32 s74, s74, 6
    s_add_u32 s74, s74, s62
    s_lshl_b32 s74, s74, 1
    s_lshr_b32 s71, s60, 1
    s_lshl_b32 s71, s71, 13
    s_and_b32 s72, s60, 1
    s_lshl_b32 s72, s72, 15
    s_add_u32 s71, s71, s72
    ds_write_b128 v212, v[192:195]
    ds_write_b128 v212, v[196:199] offset:1024
    s_waitcnt lgkmcnt(0)
    s_barrier
    ds_read_b128 v[200:203], v213
    ds_read_b128 v[204:207], v213 offset:1024
    v_lshrrev_b32 v10, 4, v1
    v_and_b32 v2, 15, v1
    v_lshrrev_b32 v3, 1, v2
    v_lshrrev_b32 v8, 1, v10
    v_xor_b32 v3, v3, v8
    v_and_b32 v8, 1, v10
    v_lshlrev_b32 v8, 3, v8
    v_lshl_add_u32 v8, v2, 7, v8
    v_add_u32 v8, s71, v8
    v_xor_b32 v4, 0, v3
    v_lshl_add_u32 v4, v4, 4, v8
    v_xor_b32 v5, 2, v3
    v_lshl_add_u32 v5, v5, 4, v8
    v_xor_b32 v6, 4, v3
    v_lshl_add_u32 v6, v6, 4, v8
    v_xor_b32 v7, 6, v3
    v_lshl_add_u32 v7, v7, 4, v8
    v_lshrrev_b32 v2, 3, v1
    v_and_b32 v3, 7, v1
    v_xor_b32 v8, v3, v10
    v_lshlrev_b32 v8, 4, v8
    v_lshl_add_u32 v8, v2, 7, v8
    v_add_u32 v8, s71, v8
    v_xor_b32 v9, 64, v8
    v_add_u32 v2, s73, v2
    v_lshlrev_b32 v2, 11, v2
    v_lshl_add_u32 v2, v3, 4, v2
    v_add_u32 v10, s74, v2
    v_xor_b32 v4, s65, v4
    v_xor_b32 v5, s65, v5
    v_xor_b32 v6, s65, v6
    v_xor_b32 v7, s65, v7
    s_waitcnt lgkmcnt(0)
    v_pk_fma_f32 v[128:129], v[192:193], v[16:17], v[128:129] op_sel:[0,0,0] op_sel_hi:[1,0,1]
    v_pk_fma_f32 v[130:131], v[194:195], v[16:17], v[130:131] op_sel:[0,0,0] op_sel_hi:[1,0,1]
    v_pk_fma_f32 v[132:133], v[196:197], v[16:17], v[132:133] op_sel:[0,0,0] op_sel_hi:[1,0,1]
    v_pk_fma_f32 v[134:135], v[198:199], v[16:17], v[134:135] op_sel:[0,0,0] op_sel_hi:[1,0,1]
    v_pk_fma_f32 v[136:137], v[200:201], v[16:17], v[136:137] op_sel:[0,0,0] op_sel_hi:[1,0,1]
    v_pk_fma_f32 v[138:139], v[202:203], v[16:17], v[138:139] op_sel:[0,0,0] op_sel_hi:[1,0,1]
    v_pk_fma_f32 v[140:141], v[204:205], v[16:17], v[140:141] op_sel:[0,0,0] op_sel_hi:[1,0,1]
    v_pk_fma_f32 v[142:143], v[206:207], v[16:17], v[142:143] op_sel:[0,0,0] op_sel_hi:[1,0,1]
    v_pk_mul_f32 v[64:65], v[128:129], v[128:129]
    v_pk_mul_f32 v[66:67], v[130:131], v[130:131]
    v_pk_mul_f32 v[68:69], v[132:133], v[132:133]
    v_pk_mul_f32 v[70:71], v[134:135], v[134:135]
    v_pk_mul_f32 v[72:73], v[136:137], v[136:137]
    v_pk_mul_f32 v[74:75], v[138:139], v[138:139]
    v_pk_mul_f32 v[76:77], v[140:141], v[140:141]
    v_pk_mul_f32 v[78:79], v[142:143], v[142:143]
    v_pk_fma_f32 v[64:65], v[64:65], v[16:17], v[18:19] op_sel:[0,1,0] op_sel_hi:[1,1,0]
    v_pk_fma_f32 v[66:67], v[66:67], v[16:17], v[18:19] op_sel:[0,1,0] op_sel_hi:[1,1,0]
    v_pk_fma_f32 v[68:69], v[68:69], v[16:17], v[18:19] op_sel:[0,1,0] op_sel_hi:[1,1,0]
    v_pk_fma_f32 v[70:71], v[70:71], v[16:17], v[18:19] op_sel:[0,1,0] op_sel_hi:[1,1,0]
    v_pk_fma_f32 v[72:73], v[72:73], v[16:17], v[18:19] op_sel:[0,1,0] op_sel_hi:[1,1,0]
    v_pk_fma_f32 v[74:75], v[74:75], v[16:17], v[18:19] op_sel:[0,1,0] op_sel_hi:[1,1,0]
    v_pk_fma_f32 v[76:77], v[76:77], v[16:17], v[18:19] op_sel:[0,1,0] op_sel_hi:[1,1,0]
    v_pk_fma_f32 v[78:79], v[78:79], v[16:17], v[18:19] op_sel:[0,1,0] op_sel_hi:[1,1,0]
    v_pk_mul_f32 v[64:65], v[64:65], v[128:129]
    v_pk_mul_f32 v[66:67], v[66:67], v[130:131]
    v_pk_mul_f32 v[68:69], v[68:69], v[132:133]
    v_pk_mul_f32 v[70:71], v[70:71], v[134:135]
    v_pk_mul_f32 v[72:73], v[72:73], v[136:137]
    v_pk_mul_f32 v[74:75], v[74:75], v[138:139]
    v_pk_mul_f32 v[76:77], v[76:77], v[140:141]
    v_pk_mul_f32 v[78:79], v[78:79], v[142:143]
    v_exp_f32 v64, v64
    v_exp_f32 v65, v65
    v_exp_f32 v66, v66
    v_exp_f32 v67, v67
    v_exp_f32 v68, v68
    v_exp_f32 v69, v69
    v_exp_f32 v70, v70
    v_exp_f32 v71, v71
    v_exp_f32 v72, v72
    v_exp_f32 v73, v73
    v_exp_f32 v74, v74
    v_exp_f32 v75, v75
    v_exp_f32 v76, v76
    v_exp_f32 v77, v77
    v_exp_f32 v78, v78
    v_exp_f32 v79, v79
    v_pk_fma_f32 v[64:65], v[64:65], v[18:19], v[18:19] op_sel:[0,1,1] op_sel_hi:[1,1,1]
    v_pk_fma_f32 v[66:67], v[66:67], v[18:19], v[18:19] op_sel:[0,1,1] op_sel_hi:[1,1,1]
    v_pk_fma_f32 v[68:69], v[68:69], v[18:19], v[18:19] op_sel:[0,1,1] op_sel_hi:[1,1,1]
    v_pk_fma_f32 v[70:71], v[70:71], v[18:19], v[18:19] op_sel:[0,1,1] op_sel_hi:[1,1,1]
    v_pk_fma_f32 v[72:73], v[72:73], v[18:19], v[18:19] op_sel:[0,1,1] op_sel_hi:[1,1,1]
    v_pk_fma_f32 v[74:75], v[74:75], v[18:19], v[18:19] op_sel:[0,1,1] op_sel_hi:[1,1,1]
    v_pk_fma_f32 v[76:77], v[76:77], v[18:19], v[18:19] op_sel:[0,1,1] op_sel_hi:[1,1,1]
    v_pk_fma_f32 v[78:79], v[78:79], v[18:19], v[18:19] op_sel:[0,1,1] op_sel_hi:[1,1,1]
    v_rcp_f32 v64, v64
    v_rcp_f32 v65, v65
    v_rcp_f32 v66, v66
    v_rcp_f32 v67, v67
    v_rcp_f32 v68, v68
    v_rcp_f32 v69, v69
    v_rcp_f32 v70, v70
    v_rcp_f32 v71, v71
    v_rcp_f32 v72, v72
    v_rcp_f32 v73, v73
    v_rcp_f32 v74, v74
    v_rcp_f32 v75, v75
    v_rcp_f32 v76, v76
    v_rcp_f32 v77, v77
    v_rcp_f32 v78, v78
    v_rcp_f32 v79, v79
    v_pk_mul_f32 v[128:129], v[128:129], v[64:65]
    v_pk_mul_f32 v[130:131], v[130:131], v[66:67]
    v_pk_mul_f32 v[132:133], v[132:133], v[68:69]
    v_pk_mul_f32 v[134:135], v[134:135], v[70:71]
    v_pk_mul_f32 v[136:137], v[136:137], v[72:73]
    v_pk_mul_f32 v[138:139], v[138:139], v[74:75]
    v_pk_mul_f32 v[140:141], v[140:141], v[76:77]
    v_pk_mul_f32 v[142:143], v[142:143], v[78:79]
    v_cvt_pk_bf16_f32 v96, v128, v129
    v_cvt_pk_bf16_f32 v97, v130, v131
    v_cvt_pk_bf16_f32 v98, v132, v133
    v_cvt_pk_bf16_f32 v99, v134, v135
    v_cvt_pk_bf16_f32 v100, v136, v137
    v_cvt_pk_bf16_f32 v101, v138, v139
    v_cvt_pk_bf16_f32 v102, v140, v141
    v_cvt_pk_bf16_f32 v103, v142, v143
    ds_write_b64 v4, v[96:97] offset:0
    ds_write_b64 v5, v[98:99] offset:0
    ds_write_b64 v6, v[100:101] offset:0
    ds_write_b64 v7, v[102:103] offset:0
    ds_read_b128 v[80:83], v8 offset:0
    ds_read_b128 v[84:87], v9 offset:1024
    v_pk_fma_f32 v[144:145], v[192:193], v[20:21], v[144:145] op_sel:[0,0,0] op_sel_hi:[1,0,1]
    v_pk_fma_f32 v[146:147], v[194:195], v[20:21], v[146:147] op_sel:[0,0,0] op_sel_hi:[1,0,1]
    v_pk_fma_f32 v[148:149], v[196:197], v[20:21], v[148:149] op_sel:[0,0,0] op_sel_hi:[1,0,1]
    v_pk_fma_f32 v[150:151], v[198:199], v[20:21], v[150:151] op_sel:[0,0,0] op_sel_hi:[1,0,1]
    v_pk_fma_f32 v[152:153], v[200:201], v[20:21], v[152:153] op_sel:[0,0,0] op_sel_hi:[1,0,1]
    v_pk_fma_f32 v[154:155], v[202:203], v[20:21], v[154:155] op_sel:[0,0,0] op_sel_hi:[1,0,1]
    v_pk_fma_f32 v[156:157], v[204:205], v[20:21], v[156:157] op_sel:[0,0,0] op_sel_hi:[1,0,1]
    v_pk_fma_f32 v[158:159], v[206:207], v[20:21], v[158:159] op_sel:[0,0,0] op_sel_hi:[1,0,1]
    v_pk_mul_f32 v[64:65], v[144:145], v[144:145]
    v_pk_mul_f32 v[66:67], v[146:147], v[146:147]
    v_pk_mul_f32 v[68:69], v[148:149], v[148:149]
    v_pk_mul_f32 v[70:71], v[150:151], v[150:151]
    v_pk_mul_f32 v[72:73], v[152:153], v[152:153]
    v_pk_mul_f32 v[74:75], v[154:155], v[154:155]
    v_pk_mul_f32 v[76:77], v[156:157], v[156:157]
    v_pk_mul_f32 v[78:79], v[158:159], v[158:159]
    s_waitcnt lgkmcnt(0)
    v_add_u32 v12, 0x0, v10
    v_add_u32 v13, 0x4000, v10
    buffer_store_dwordx4 v[80:83], v12, s[36:39], 0 offen sc1
    buffer_store_dwordx4 v[84:87], v13, s[36:39], 0 offen sc1
    v_pk_fma_f32 v[64:65], v[64:65], v[20:21], v[22:23] op_sel:[0,1,0] op_sel_hi:[1,1,0]
    v_pk_fma_f32 v[66:67], v[66:67], v[20:21], v[22:23] op_sel:[0,1,0] op_sel_hi:[1,1,0]
    v_pk_fma_f32 v[68:69], v[68:69], v[20:21], v[22:23] op_sel:[0,1,0] op_sel_hi:[1,1,0]
    v_pk_fma_f32 v[70:71], v[70:71], v[20:21], v[22:23] op_sel:[0,1,0] op_sel_hi:[1,1,0]
    v_pk_fma_f32 v[72:73], v[72:73], v[20:21], v[22:23] op_sel:[0,1,0] op_sel_hi:[1,1,0]
    v_pk_fma_f32 v[74:75], v[74:75], v[20:21], v[22:23] op_sel:[0,1,0] op_sel_hi:[1,1,0]
    v_pk_fma_f32 v[76:77], v[76:77], v[20:21], v[22:23] op_sel:[0,1,0] op_sel_hi:[1,1,0]
    v_pk_fma_f32 v[78:79], v[78:79], v[20:21], v[22:23] op_sel:[0,1,0] op_sel_hi:[1,1,0]
    v_pk_mul_f32 v[64:65], v[64:65], v[144:145]
    v_pk_mul_f32 v[66:67], v[66:67], v[146:147]
    v_pk_mul_f32 v[68:69], v[68:69], v[148:149]
    v_pk_mul_f32 v[70:71], v[70:71], v[150:151]
    v_pk_mul_f32 v[72:73], v[72:73], v[152:153]
    v_pk_mul_f32 v[74:75], v[74:75], v[154:155]
    v_pk_mul_f32 v[76:77], v[76:77], v[156:157]
    v_pk_mul_f32 v[78:79], v[78:79], v[158:159]
    v_exp_f32 v64, v64
    v_exp_f32 v65, v65
    v_exp_f32 v66, v66
    v_exp_f32 v67, v67
    v_exp_f32 v68, v68
    v_exp_f32 v69, v69
    v_exp_f32 v70, v70
    v_exp_f32 v71, v71
    v_exp_f32 v72, v72
    v_exp_f32 v73, v73
    v_exp_f32 v74, v74
    v_exp_f32 v75, v75
    v_exp_f32 v76, v76
    v_exp_f32 v77, v77
    v_exp_f32 v78, v78
    v_exp_f32 v79, v79
    v_pk_fma_f32 v[64:65], v[64:65], v[22:23], v[22:23] op_sel:[0,1,1] op_sel_hi:[1,1,1]
    v_pk_fma_f32 v[66:67], v[66:67], v[22:23], v[22:23] op_sel:[0,1,1] op_sel_hi:[1,1,1]
    v_pk_fma_f32 v[68:69], v[68:69], v[22:23], v[22:23] op_sel:[0,1,1] op_sel_hi:[1,1,1]
    v_pk_fma_f32 v[70:71], v[70:71], v[22:23], v[22:23] op_sel:[0,1,1] op_sel_hi:[1,1,1]
    v_pk_fma_f32 v[72:73], v[72:73], v[22:23], v[22:23] op_sel:[0,1,1] op_sel_hi:[1,1,1]
    v_pk_fma_f32 v[74:75], v[74:75], v[22:23], v[22:23] op_sel:[0,1,1] op_sel_hi:[1,1,1]
    v_pk_fma_f32 v[76:77], v[76:77], v[22:23], v[22:23] op_sel:[0,1,1] op_sel_hi:[1,1,1]
    v_pk_fma_f32 v[78:79], v[78:79], v[22:23], v[22:23] op_sel:[0,1,1] op_sel_hi:[1,1,1]
    v_rcp_f32 v64, v64
    v_rcp_f32 v65, v65
    v_rcp_f32 v66, v66
    v_rcp_f32 v67, v67
    v_rcp_f32 v68, v68
    v_rcp_f32 v69, v69
    v_rcp_f32 v70, v70
    v_rcp_f32 v71, v71
    v_rcp_f32 v72, v72
    v_rcp_f32 v73, v73
    v_rcp_f32 v74, v74
    v_rcp_f32 v75, v75
    v_rcp_f32 v76, v76
    v_rcp_f32 v77, v77
    v_rcp_f32 v78, v78
    v_rcp_f32 v79, v79
    v_pk_mul_f32 v[144:145], v[144:145], v[64:65]
    v_pk_mul_f32 v[146:147], v[146:147], v[66:67]
    v_pk_mul_f32 v[148:149], v[148:149], v[68:69]
    v_pk_mul_f32 v[150:151], v[150:151], v[70:71]
    v_pk_mul_f32 v[152:153], v[152:153], v[72:73]
    v_pk_mul_f32 v[154:155], v[154:155], v[74:75]
    v_pk_mul_f32 v[156:157], v[156:157], v[76:77]
    v_pk_mul_f32 v[158:159], v[158:159], v[78:79]
    v_cvt_pk_bf16_f32 v104, v144, v145
    v_cvt_pk_bf16_f32 v105, v146, v147
    v_cvt_pk_bf16_f32 v106, v148, v149
    v_cvt_pk_bf16_f32 v107, v150, v151
    v_cvt_pk_bf16_f32 v108, v152, v153
    v_cvt_pk_bf16_f32 v109, v154, v155
    v_cvt_pk_bf16_f32 v110, v156, v157
    v_cvt_pk_bf16_f32 v111, v158, v159
    ds_write_b64 v4, v[104:105] offset:2048
    ds_write_b64 v5, v[106:107] offset:2048
    ds_write_b64 v6, v[108:109] offset:2048
    ds_write_b64 v7, v[110:111] offset:2048
    ds_read_b128 v[88:91], v8 offset:2048
    ds_read_b128 v[92:95], v9 offset:3072
    v_pk_fma_f32 v[160:161], v[192:193], v[24:25], v[160:161] op_sel:[0,0,0] op_sel_hi:[1,0,1]
    v_pk_fma_f32 v[162:163], v[194:195], v[24:25], v[162:163] op_sel:[0,0,0] op_sel_hi:[1,0,1]
    v_pk_fma_f32 v[164:165], v[196:197], v[24:25], v[164:165] op_sel:[0,0,0] op_sel_hi:[1,0,1]
    v_pk_fma_f32 v[166:167], v[198:199], v[24:25], v[166:167] op_sel:[0,0,0] op_sel_hi:[1,0,1]
    v_pk_fma_f32 v[168:169], v[200:201], v[24:25], v[168:169] op_sel:[0,0,0] op_sel_hi:[1,0,1]
    v_pk_fma_f32 v[170:171], v[202:203], v[24:25], v[170:171] op_sel:[0,0,0] op_sel_hi:[1,0,1]
    v_pk_fma_f32 v[172:173], v[204:205], v[24:25], v[172:173] op_sel:[0,0,0] op_sel_hi:[1,0,1]
    v_pk_fma_f32 v[174:175], v[206:207], v[24:25], v[174:175] op_sel:[0,0,0] op_sel_hi:[1,0,1]
    v_pk_mul_f32 v[64:65], v[160:161], v[160:161]
    v_pk_mul_f32 v[66:67], v[162:163], v[162:163]
    v_pk_mul_f32 v[68:69], v[164:165], v[164:165]
    v_pk_mul_f32 v[70:71], v[166:167], v[166:167]
    v_pk_mul_f32 v[72:73], v[168:169], v[168:169]
    v_pk_mul_f32 v[74:75], v[170:171], v[170:171]
    v_pk_mul_f32 v[76:77], v[172:173], v[172:173]
    v_pk_mul_f32 v[78:79], v[174:175], v[174:175]
    s_waitcnt lgkmcnt(0)
    v_add_u32 v14, 0x8000, v10
    v_add_u32 v15, 0xc000, v10
    buffer_store_dwordx4 v[88:91], v14, s[36:39], 0 offen sc1
    buffer_store_dwordx4 v[92:95], v15, s[36:39], 0 offen sc1
    v_pk_fma_f32 v[64:65], v[64:65], v[24:25], v[26:27] op_sel:[0,1,0] op_sel_hi:[1,1,0]
    v_pk_fma_f32 v[66:67], v[66:67], v[24:25], v[26:27] op_sel:[0,1,0] op_sel_hi:[1,1,0]
    v_pk_fma_f32 v[68:69], v[68:69], v[24:25], v[26:27] op_sel:[0,1,0] op_sel_hi:[1,1,0]
    v_pk_fma_f32 v[70:71], v[70:71], v[24:25], v[26:27] op_sel:[0,1,0] op_sel_hi:[1,1,0]
    v_pk_fma_f32 v[72:73], v[72:73], v[24:25], v[26:27] op_sel:[0,1,0] op_sel_hi:[1,1,0]
    v_pk_fma_f32 v[74:75], v[74:75], v[24:25], v[26:27] op_sel:[0,1,0] op_sel_hi:[1,1,0]
    v_pk_fma_f32 v[76:77], v[76:77], v[24:25], v[26:27] op_sel:[0,1,0] op_sel_hi:[1,1,0]
    v_pk_fma_f32 v[78:79], v[78:79], v[24:25], v[26:27] op_sel:[0,1,0] op_sel_hi:[1,1,0]
    v_pk_mul_f32 v[64:65], v[64:65], v[160:161]
    v_pk_mul_f32 v[66:67], v[66:67], v[162:163]
    v_pk_mul_f32 v[68:69], v[68:69], v[164:165]
    v_pk_mul_f32 v[70:71], v[70:71], v[166:167]
    v_pk_mul_f32 v[72:73], v[72:73], v[168:169]
    v_pk_mul_f32 v[74:75], v[74:75], v[170:171]
    v_pk_mul_f32 v[76:77], v[76:77], v[172:173]
    v_pk_mul_f32 v[78:79], v[78:79], v[174:175]
    v_exp_f32 v64, v64
    v_exp_f32 v65, v65
    v_exp_f32 v66, v66
    v_exp_f32 v67, v67
    v_exp_f32 v68, v68
    v_exp_f32 v69, v69
    v_exp_f32 v70, v70
    v_exp_f32 v71, v71
    v_exp_f32 v72, v72
    v_exp_f32 v73, v73
    v_exp_f32 v74, v74
    v_exp_f32 v75, v75
    v_exp_f32 v76, v76
    v_exp_f32 v77, v77
    v_exp_f32 v78, v78
    v_exp_f32 v79, v79
    v_pk_fma_f32 v[64:65], v[64:65], v[26:27], v[26:27] op_sel:[0,1,1] op_sel_hi:[1,1,1]
    v_pk_fma_f32 v[66:67], v[66:67], v[26:27], v[26:27] op_sel:[0,1,1] op_sel_hi:[1,1,1]
    v_pk_fma_f32 v[68:69], v[68:69], v[26:27], v[26:27] op_sel:[0,1,1] op_sel_hi:[1,1,1]
    v_pk_fma_f32 v[70:71], v[70:71], v[26:27], v[26:27] op_sel:[0,1,1] op_sel_hi:[1,1,1]
    v_pk_fma_f32 v[72:73], v[72:73], v[26:27], v[26:27] op_sel:[0,1,1] op_sel_hi:[1,1,1]
    v_pk_fma_f32 v[74:75], v[74:75], v[26:27], v[26:27] op_sel:[0,1,1] op_sel_hi:[1,1,1]
    v_pk_fma_f32 v[76:77], v[76:77], v[26:27], v[26:27] op_sel:[0,1,1] op_sel_hi:[1,1,1]
    v_pk_fma_f32 v[78:79], v[78:79], v[26:27], v[26:27] op_sel:[0,1,1] op_sel_hi:[1,1,1]
    v_rcp_f32 v64, v64
    v_rcp_f32 v65, v65
    v_rcp_f32 v66, v66
    v_rcp_f32 v67, v67
    v_rcp_f32 v68, v68
    v_rcp_f32 v69, v69
    v_rcp_f32 v70, v70
    v_rcp_f32 v71, v71
    v_rcp_f32 v72, v72
    v_rcp_f32 v73, v73
    v_rcp_f32 v74, v74
    v_rcp_f32 v75, v75
    v_rcp_f32 v76, v76
    v_rcp_f32 v77, v77
    v_rcp_f32 v78, v78
    v_rcp_f32 v79, v79
    v_pk_mul_f32 v[160:161], v[160:161], v[64:65]
    v_pk_mul_f32 v[162:163], v[162:163], v[66:67]
    v_pk_mul_f32 v[164:165], v[164:165], v[68:69]
    v_pk_mul_f32 v[166:167], v[166:167], v[70:71]
    v_pk_mul_f32 v[168:169], v[168:169], v[72:73]
    v_pk_mul_f32 v[170:171], v[170:171], v[74:75]
    v_pk_mul_f32 v[172:173], v[172:173], v[76:77]
    v_pk_mul_f32 v[174:175], v[174:175], v[78:79]
    v_cvt_pk_bf16_f32 v96, v160, v161
    v_cvt_pk_bf16_f32 v97, v162, v163
    v_cvt_pk_bf16_f32 v98, v164, v165
    v_cvt_pk_bf16_f32 v99, v166, v167
    v_cvt_pk_bf16_f32 v100, v168, v169
    v_cvt_pk_bf16_f32 v101, v170, v171
    v_cvt_pk_bf16_f32 v102, v172, v173
    v_cvt_pk_bf16_f32 v103, v174, v175
    ds_write_b64 v4, v[96:97] offset:4096
    ds_write_b64 v5, v[98:99] offset:4096
    ds_write_b64 v6, v[100:101] offset:4096
    ds_write_b64 v7, v[102:103] offset:4096
    ds_read_b128 v[80:83], v8 offset:4096
    ds_read_b128 v[84:87], v9 offset:5120
    v_pk_fma_f32 v[176:177], v[192:193], v[28:29], v[176:177] op_sel:[0,0,0] op_sel_hi:[1,0,1]
    v_pk_fma_f32 v[178:179], v[194:195], v[28:29], v[178:179] op_sel:[0,0,0] op_sel_hi:[1,0,1]
    v_pk_fma_f32 v[180:181], v[196:197], v[28:29], v[180:181] op_sel:[0,0,0] op_sel_hi:[1,0,1]
    v_pk_fma_f32 v[182:183], v[198:199], v[28:29], v[182:183] op_sel:[0,0,0] op_sel_hi:[1,0,1]
    v_pk_fma_f32 v[184:185], v[200:201], v[28:29], v[184:185] op_sel:[0,0,0] op_sel_hi:[1,0,1]
    v_pk_fma_f32 v[186:187], v[202:203], v[28:29], v[186:187] op_sel:[0,0,0] op_sel_hi:[1,0,1]
    v_pk_fma_f32 v[188:189], v[204:205], v[28:29], v[188:189] op_sel:[0,0,0] op_sel_hi:[1,0,1]
    v_pk_fma_f32 v[190:191], v[206:207], v[28:29], v[190:191] op_sel:[0,0,0] op_sel_hi:[1,0,1]
    v_pk_mul_f32 v[64:65], v[176:177], v[176:177]
    v_pk_mul_f32 v[66:67], v[178:179], v[178:179]
    v_pk_mul_f32 v[68:69], v[180:181], v[180:181]
    v_pk_mul_f32 v[70:71], v[182:183], v[182:183]
    v_pk_mul_f32 v[72:73], v[184:185], v[184:185]
    v_pk_mul_f32 v[74:75], v[186:187], v[186:187]
    v_pk_mul_f32 v[76:77], v[188:189], v[188:189]
    v_pk_mul_f32 v[78:79], v[190:191], v[190:191]
    s_waitcnt lgkmcnt(0)
    v_add_u32 v12, 0x10000, v10
    v_add_u32 v13, 0x14000, v10
    buffer_store_dwordx4 v[80:83], v12, s[36:39], 0 offen sc1
    buffer_store_dwordx4 v[84:87], v13, s[36:39], 0 offen sc1
    v_pk_fma_f32 v[64:65], v[64:65], v[28:29], v[30:31] op_sel:[0,1,0] op_sel_hi:[1,1,0]
    v_pk_fma_f32 v[66:67], v[66:67], v[28:29], v[30:31] op_sel:[0,1,0] op_sel_hi:[1,1,0]
    v_pk_fma_f32 v[68:69], v[68:69], v[28:29], v[30:31] op_sel:[0,1,0] op_sel_hi:[1,1,0]
    v_pk_fma_f32 v[70:71], v[70:71], v[28:29], v[30:31] op_sel:[0,1,0] op_sel_hi:[1,1,0]
    v_pk_fma_f32 v[72:73], v[72:73], v[28:29], v[30:31] op_sel:[0,1,0] op_sel_hi:[1,1,0]
    v_pk_fma_f32 v[74:75], v[74:75], v[28:29], v[30:31] op_sel:[0,1,0] op_sel_hi:[1,1,0]
    v_pk_fma_f32 v[76:77], v[76:77], v[28:29], v[30:31] op_sel:[0,1,0] op_sel_hi:[1,1,0]
    v_pk_fma_f32 v[78:79], v[78:79], v[28:29], v[30:31] op_sel:[0,1,0] op_sel_hi:[1,1,0]
    v_pk_mul_f32 v[64:65], v[64:65], v[176:177]
    v_pk_mul_f32 v[66:67], v[66:67], v[178:179]
    v_pk_mul_f32 v[68:69], v[68:69], v[180:181]
    v_pk_mul_f32 v[70:71], v[70:71], v[182:183]
    v_pk_mul_f32 v[72:73], v[72:73], v[184:185]
    v_pk_mul_f32 v[74:75], v[74:75], v[186:187]
    v_pk_mul_f32 v[76:77], v[76:77], v[188:189]
    v_pk_mul_f32 v[78:79], v[78:79], v[190:191]
    v_exp_f32 v64, v64
    v_exp_f32 v65, v65
    v_exp_f32 v66, v66
    v_exp_f32 v67, v67
    v_exp_f32 v68, v68
    v_exp_f32 v69, v69
    v_exp_f32 v70, v70
    v_exp_f32 v71, v71
    v_exp_f32 v72, v72
    v_exp_f32 v73, v73
    v_exp_f32 v74, v74
    v_exp_f32 v75, v75
    v_exp_f32 v76, v76
    v_exp_f32 v77, v77
    v_exp_f32 v78, v78
    v_exp_f32 v79, v79
    v_pk_fma_f32 v[64:65], v[64:65], v[30:31], v[30:31] op_sel:[0,1,1] op_sel_hi:[1,1,1]
    v_pk_fma_f32 v[66:67], v[66:67], v[30:31], v[30:31] op_sel:[0,1,1] op_sel_hi:[1,1,1]
    v_pk_fma_f32 v[68:69], v[68:69], v[30:31], v[30:31] op_sel:[0,1,1] op_sel_hi:[1,1,1]
    v_pk_fma_f32 v[70:71], v[70:71], v[30:31], v[30:31] op_sel:[0,1,1] op_sel_hi:[1,1,1]
    v_pk_fma_f32 v[72:73], v[72:73], v[30:31], v[30:31] op_sel:[0,1,1] op_sel_hi:[1,1,1]
    v_pk_fma_f32 v[74:75], v[74:75], v[30:31], v[30:31] op_sel:[0,1,1] op_sel_hi:[1,1,1]
    v_pk_fma_f32 v[76:77], v[76:77], v[30:31], v[30:31] op_sel:[0,1,1] op_sel_hi:[1,1,1]
    v_pk_fma_f32 v[78:79], v[78:79], v[30:31], v[30:31] op_sel:[0,1,1] op_sel_hi:[1,1,1]
    v_rcp_f32 v64, v64
    v_rcp_f32 v65, v65
    v_rcp_f32 v66, v66
    v_rcp_f32 v67, v67
    v_rcp_f32 v68, v68
    v_rcp_f32 v69, v69
    v_rcp_f32 v70, v70
    v_rcp_f32 v71, v71
    v_rcp_f32 v72, v72
    v_rcp_f32 v73, v73
    v_rcp_f32 v74, v74
    v_rcp_f32 v75, v75
    v_rcp_f32 v76, v76
    v_rcp_f32 v77, v77
    v_rcp_f32 v78, v78
    v_rcp_f32 v79, v79
    v_pk_mul_f32 v[176:177], v[176:177], v[64:65]
    v_pk_mul_f32 v[178:179], v[178:179], v[66:67]
    v_pk_mul_f32 v[180:181], v[180:181], v[68:69]
    v_pk_mul_f32 v[182:183], v[182:183], v[70:71]
    v_pk_mul_f32 v[184:185], v[184:185], v[72:73]
    v_pk_mul_f32 v[186:187], v[186:187], v[74:75]
    v_pk_mul_f32 v[188:189], v[188:189], v[76:77]
    v_pk_mul_f32 v[190:191], v[190:191], v[78:79]
    v_cvt_pk_bf16_f32 v104, v176, v177
    v_cvt_pk_bf16_f32 v105, v178, v179
    v_cvt_pk_bf16_f32 v106, v180, v181
    v_cvt_pk_bf16_f32 v107, v182, v183
    v_cvt_pk_bf16_f32 v108, v184, v185
    v_cvt_pk_bf16_f32 v109, v186, v187
    v_cvt_pk_bf16_f32 v110, v188, v189
    v_cvt_pk_bf16_f32 v111, v190, v191
    ds_write_b64 v4, v[104:105] offset:6144
    ds_write_b64 v5, v[106:107] offset:6144
    ds_write_b64 v6, v[108:109] offset:6144
    ds_write_b64 v7, v[110:111] offset:6144
    ds_read_b128 v[88:91], v8 offset:6144
    ds_read_b128 v[92:95], v9 offset:7168
    s_waitcnt lgkmcnt(0)
    v_add_u32 v14, 0x18000, v10
    v_add_u32 v15, 0x1c000, v10
    buffer_store_dwordx4 v[88:91], v14, s[36:39], 0 offen sc1
    buffer_store_dwordx4 v[92:95], v15, s[36:39], 0 offen sc1
    s_add_u32 s36, s26, 0x800000
    s_addc_u32 s37, s27, 0
    s_mov_b32 s38, 0x400000
    s_mov_b32 s39, 0x20000
    s_lshr_b32 s73, s60, 1
    s_lshl_b32 s73, s73, 6
    s_add_u32 s73, s73, s61
    s_and_b32 s74, s60, 1
    s_lshl_b32 s74, s74, 6
    s_add_u32 s74, s74, s62
    s_lshl_b32 s74, s74, 1
    s_and_b32 s71, s60, 1
    s_mul_i32 s71, s71, 49152
    s_lshr_b32 s72, s60, 1
    s_lshl_b32 s72, s72, 13
    s_add_u32 s71, s71, s72
    v_lshrrev_b32 v225, 4, v1
    v_and_b32 v2, 15, v1
    v_lshrrev_b32 v3, 1, v2
    v_lshrrev_b32 v226, 1, v225
    v_xor_b32 v3, v3, v226
    v_and_b32 v226, 1, v225
    v_lshlrev_b32 v226, 3, v226
    v_lshl_add_u32 v226, v2, 7, v226
    v_add_u32 v226, s71, v226
    v_xor_b32 v228, 0, v3
    v_lshl_add_u32 v228, v228, 4, v226
    v_xor_b32 v229, 2, v3
    v_lshl_add_u32 v229, v229, 4, v226
    v_xor_b32 v230, 4, v3
    v_lshl_add_u32 v230, v230, 4, v226
    v_xor_b32 v231, 6, v3
    v_lshl_add_u32 v231, v231, 4, v226
    v_lshrrev_b32 v2, 3, v1
    v_and_b32 v3, 7, v1
    v_xor_b32 v226, v3, v225
    v_lshlrev_b32 v226, 4, v226
    v_lshl_add_u32 v226, v2, 7, v226
    v_add_u32 v226, s71, v226
    v_xor_b32 v227, 64, v226
    v_add_u32 v2, s73, v2
    v_lshlrev_b32 v2, 11, v2
    v_lshl_add_u32 v2, v3, 4, v2
    v_add_u32 v225, s74, v2
    s_and_b32 s72, s60, 1
    s_mul_i32 s72, s72, -16384
    s_add_u32 s72, s72, 65536
    v_and_b32 v2, 15, v1
    s_lshr_b32 s71, s60, 1
    s_lshl_b32 s71, s71, 6
    v_add_u32 v2, s71, v2
    v_lshlrev_b32 v2, 7, v2
    v_bfe_u32 v3, v1, 1, 3
    v_lshrrev_b32 v16, 4, v1
    v_xor_b32 v3, v3, v16
    v_xor_b32 v17, 0, v3
    v_lshl_add_u32 v8, v17, 4, v2
    v_mov_b32 v4, v8
    v_xor_b32 v17, 4, v3
    v_lshl_add_u32 v9, v17, 4, v2
    v_mov_b32 v5, v9
    v_bfe_u32 v2, v1, 2, 2
    v_lshl_add_u32 v18, v16, 3, v2
    v_and_b32 v3, 1, v1
    v_lshlrev_b32 v3, 3, v3
    v_lshl_add_u32 v3, v18, 8, v3
    v_bfe_u32 v17, v1, 1, 1
    s_and_b32 s71, s60, 1
    s_lshl_b32 s71, s71, 3
    v_add_u32 v17, s71, v17
    v_lshlrev_b32 v2, 2, v2
    v_xor_b32 v17, v17, v2
    v_and_b32 v2, 1, v16
    v_lshlrev_b32 v2, 1, v2
    v_xor_b32 v17, v17, v2
    v_xor_b32 v19, 0, v17
    v_lshl_add_u32 v19, v19, 4, v3
    v_add_u32 v10, 16384, v19
    v_mov_b32 v6, v10
    v_xor_b32 v19, 2, v17
    v_lshl_add_u32 v19, v19, 4, v3
    v_add_u32 v11, 16384, v19
    v_mov_b32 v7, v11
    v_xor_b32 v19, 4, v17
    v_lshl_add_u32 v19, v19, 4, v3
    v_add_u32 v14, 16384, v19
    v_mov_b32 v12, v14
    v_xor_b32 v19, 6, v17
    v_lshl_add_u32 v19, v19, 4, v3
    v_add_u32 v15, 16384, v19
    v_mov_b32 v13, v15
    s_mov_b32 s70, 0
    s_barrier
    ds_read_b64_tr_b16 v[32:33], v6 offset:0
    ds_read_b64_tr_b16 v[34:35], v6 offset:1024
    ds_read_b128 v[16:19], v4 offset:0
    ds_read_b64_tr_b16 v[36:37], v7 offset:0
    ds_read_b64_tr_b16 v[38:39], v7 offset:1024
    ds_read_b128 v[20:23], v4 offset:2048
    ds_read_b64_tr_b16 v[40:41], v12 offset:0
    ds_read_b64_tr_b16 v[42:43], v12 offset:1024
    ds_read_b128 v[24:27], v4 offset:4096
    ds_read_b64_tr_b16 v[44:45], v13 offset:0
    ds_read_b64_tr_b16 v[46:47], v13 offset:1024
    ds_read_b128 v[28:31], v4 offset:6144
    s_waitcnt lgkmcnt(0)
    v_mfma_f32_16x16x32_bf16 v[128:131], v[32:35], v[16:19], 0
    ds_read_b64_tr_b16 v[64:65], v6 offset:8192
    ds_read_b64_tr_b16 v[66:67], v6 offset:9216
    v_mfma_f32_16x16x32_bf16 v[144:147], v[32:35], v[20:23], 0
    ds_read_b128 v[48:51], v5 offset:0
    ds_read_b64_tr_b16 v[68:69], v7 offset:8192
    v_mfma_f32_16x16x32_bf16 v[160:163], v[32:35], v[24:27], 0
    ds_read_b64_tr_b16 v[70:71], v7 offset:9216
    ds_read_b128 v[52:55], v5 offset:2048
    v_mfma_f32_16x16x32_bf16 v[176:179], v[32:35], v[28:31], 0
    ds_read_b64_tr_b16 v[72:73], v12 offset:8192
    ds_read_b64_tr_b16 v[74:75], v12 offset:9216
    v_mfma_f32_16x16x32_bf16 v[180:183], v[36:39], v[28:31], 0
    ds_read_b128 v[56:59], v5 offset:4096
    ds_read_b64_tr_b16 v[76:77], v13 offset:8192
    v_mfma_f32_16x16x32_bf16 v[164:167], v[36:39], v[24:27], 0
    ds_read_b64_tr_b16 v[78:79], v13 offset:9216
    ds_read_b128 v[60:63], v5 offset:6144
    v_mfma_f32_16x16x32_bf16 v[148:151], v[36:39], v[20:23], 0
    s_add_u32 s70, s70, 32768
    s_cmp_eq_u32 s70, 131072
    v_mfma_f32_16x16x32_bf16 v[132:135], v[36:39], v[16:19], 0
    s_cselect_b32 s70, 0, s70
    v_add_u32 v4, s70, v8
    v_mfma_f32_16x16x32_bf16 v[136:139], v[40:43], v[16:19], 0
    v_add_u32 v5, s70, v9
    v_add_u32 v6, s70, v10
    v_mfma_f32_16x16x32_bf16 v[152:155], v[40:43], v[20:23], 0
    v_add_u32 v7, s70, v11
    v_add_u32 v12, s70, v14
    v_mfma_f32_16x16x32_bf16 v[168:171], v[40:43], v[24:27], 0
    v_add_u32 v13, s70, v15
    v_mfma_f32_16x16x32_bf16 v[184:187], v[40:43], v[28:31], 0
    v_mfma_f32_16x16x32_bf16 v[188:191], v[44:47], v[28:31], 0
    v_mfma_f32_16x16x32_bf16 v[172:175], v[44:47], v[24:27], 0
    v_mfma_f32_16x16x32_bf16 v[156:159], v[44:47], v[20:23], 0
    v_mfma_f32_16x16x32_bf16 v[140:143], v[44:47], v[16:19], 0
    s_waitcnt lgkmcnt(0)
    v_mfma_f32_16x16x32_bf16 v[128:131], v[64:67], v[48:51], v[128:131]
    s_barrier
    v_mfma_f32_16x16x32_bf16 v[144:147], v[64:67], v[52:55], v[144:147]
    ds_read_b64_tr_b16 v[32:33], v6 offset:0
    ds_read_b64_tr_b16 v[34:35], v6 offset:1024
    v_mfma_f32_16x16x32_bf16 v[160:163], v[64:67], v[56:59], v[160:163]
    ds_read_b128 v[16:19], v4 offset:0
    ds_read_b64_tr_b16 v[36:37], v7 offset:0
    v_mfma_f32_16x16x32_bf16 v[176:179], v[64:67], v[60:63], v[176:179]
    ds_read_b64_tr_b16 v[38:39], v7 offset:1024
    ds_read_b128 v[20:23], v4 offset:2048
    v_mfma_f32_16x16x32_bf16 v[180:183], v[68:71], v[60:63], v[180:183]
    ds_read_b64_tr_b16 v[40:41], v12 offset:0
    ds_read_b64_tr_b16 v[42:43], v12 offset:1024
    v_mfma_f32_16x16x32_bf16 v[164:167], v[68:71], v[56:59], v[164:167]
    ds_read_b128 v[24:27], v4 offset:4096
    ds_read_b64_tr_b16 v[44:45], v13 offset:0
    v_mfma_f32_16x16x32_bf16 v[148:151], v[68:71], v[52:55], v[148:151]
    ds_read_b64_tr_b16 v[46:47], v13 offset:1024
    ds_read_b128 v[28:31], v4 offset:6144
    v_mfma_f32_16x16x32_bf16 v[132:135], v[68:71], v[48:51], v[132:135]
    v_mfma_f32_16x16x32_bf16 v[136:139], v[72:75], v[48:51], v[136:139]
    v_mfma_f32_16x16x32_bf16 v[152:155], v[72:75], v[52:55], v[152:155]
    v_mfma_f32_16x16x32_bf16 v[168:171], v[72:75], v[56:59], v[168:171]
    v_mfma_f32_16x16x32_bf16 v[184:187], v[72:75], v[60:63], v[184:187]
    v_mfma_f32_16x16x32_bf16 v[188:191], v[76:79], v[60:63], v[188:191]
    v_mfma_f32_16x16x32_bf16 v[172:175], v[76:79], v[56:59], v[172:175]
    v_mfma_f32_16x16x32_bf16 v[156:159], v[76:79], v[52:55], v[156:159]
    v_mfma_f32_16x16x32_bf16 v[140:143], v[76:79], v[48:51], v[140:143]
    s_waitcnt vmcnt(0)
    s_barrier
    s_cmp_lg_u32 s60, 0
    s_cbranch_scc1 L_w0_24
    s_add_u32 s48, s26, 0x2700000
    s_addc_u32 s49, s27, 0
    s_mov_b32 s50, 0x8000
    s_mov_b32 s51, 0x20000
    s_lshl_b32 s71, s77, 7
    s_add_u32 s71, s71, 10240
    v_mov_b32 v2, s71
    v_mov_b32 v3, 1
    s_mov_b64 exec, 1
    buffer_atomic_add v3, v2, s[48:51], 0 offen sc1
    s_mov_b64 exec, -1
    s_add_u32 s48, s26, 0x2700000
    s_addc_u32 s49, s27, 0
    s_mov_b32 s50, 0x8000
    s_mov_b32 s51, 0x20000
    v_mov_b32 v2, 20864
    v_mov_b32 v3, 1
    s_mov_b64 exec, 1
    buffer_atomic_add v3, v2, s[48:51], 0 offen sc1
    s_mov_b64 exec, -1
L_w0_24:
    s_mov_b32 s81, 0
    s_mov_b32 s67, 15
L_sl_25:
    s_waitcnt lgkmcnt(0)
    v_mfma_f32_16x16x32_bf16 v[128:131], v[32:35], v[16:19], v[128:131]
    ds_read_b64_tr_b16 v[64:65], v6 offset:8192
    ds_read_b64_tr_b16 v[66:67], v6 offset:9216
    v_mfma_f32_16x16x32_bf16 v[144:147], v[32:35], v[20:23], v[144:147]
    ds_read_b128 v[48:51], v5 offset:0
    ds_read_b64_tr_b16 v[68:69], v7 offset:8192
    v_mfma_f32_16x16x32_bf16 v[160:163], v[32:35], v[24:27], v[160:163]
    ds_read_b64_tr_b16 v[70:71], v7 offset:9216
    ds_read_b128 v[52:55], v5 offset:2048
    v_mfma_f32_16x16x32_bf16 v[176:179], v[32:35], v[28:31], v[176:179]
    ds_read_b64_tr_b16 v[72:73], v12 offset:8192
    ds_read_b64_tr_b16 v[74:75], v12 offset:9216
    v_mfma_f32_16x16x32_bf16 v[180:183], v[36:39], v[28:31], v[180:183]
    ds_read_b128 v[56:59], v5 offset:4096
    ds_read_b64_tr_b16 v[76:77], v13 offset:8192
    v_mfma_f32_16x16x32_bf16 v[164:167], v[36:39], v[24:27], v[164:167]
    ds_read_b64_tr_b16 v[78:79], v13 offset:9216
    ds_read_b128 v[60:63], v5 offset:6144
    v_mfma_f32_16x16x32_bf16 v[148:151], v[36:39], v[20:23], v[148:151]
    s_add_u32 s70, s70, 32768
    s_cmp_eq_u32 s70, 131072
    v_mfma_f32_16x16x32_bf16 v[132:135], v[36:39], v[16:19], v[132:135]
    s_cselect_b32 s70, 0, s70
    v_add_u32 v4, s70, v8
    v_mfma_f32_16x16x32_bf16 v[136:139], v[40:43], v[16:19], v[136:139]
    v_add_u32 v5, s70, v9
    v_add_u32 v6, s70, v10
    v_mfma_f32_16x16x32_bf16 v[152:155], v[40:43], v[20:23], v[152:155]
    v_add_u32 v7, s70, v11
    v_add_u32 v12, s70, v14
    v_mfma_f32_16x16x32_bf16 v[168:171], v[40:43], v[24:27], v[168:171]
    v_add_u32 v13, s70, v15
    v_mfma_f32_16x16x32_bf16 v[184:187], v[40:43], v[28:31], v[184:187]
    v_mfma_f32_16x16x32_bf16 v[188:191], v[44:47], v[28:31], v[188:191]
    v_mfma_f32_16x16x32_bf16 v[172:175], v[44:47], v[24:27], v[172:175]
    v_mfma_f32_16x16x32_bf16 v[156:159], v[44:47], v[20:23], v[156:159]
    v_mfma_f32_16x16x32_bf16 v[140:143], v[44:47], v[16:19], v[140:143]
    s_waitcnt lgkmcnt(0)
    v_mfma_f32_16x16x32_bf16 v[128:131], v[64:67], v[48:51], v[128:131]
    s_barrier
    v_mfma_f32_16x16x32_bf16 v[144:147], v[64:67], v[52:55], v[144:147]
    ds_read_b64_tr_b16 v[32:33], v6 offset:0
    ds_read_b64_tr_b16 v[34:35], v6 offset:1024
    v_mfma_f32_16x16x32_bf16 v[160:163], v[64:67], v[56:59], v[160:163]
    ds_read_b128 v[16:19], v4 offset:0
    ds_read_b64_tr_b16 v[36:37], v7 offset:0
    v_mfma_f32_16x16x32_bf16 v[176:179], v[64:67], v[60:63], v[176:179]
    ds_read_b64_tr_b16 v[38:39], v7 offset:1024
    ds_read_b128 v[20:23], v4 offset:2048
    v_mfma_f32_16x16x32_bf16 v[180:183], v[68:71], v[60:63], v[180:183]
    ds_read_b64_tr_b16 v[40:41], v12 offset:0
    ds_read_b64_tr_b16 v[42:43], v12 offset:1024
    v_mfma_f32_16x16x32_bf16 v[164:167], v[68:71], v[56:59], v[164:167]
    ds_read_b128 v[24:27], v4 offset:4096
    ds_read_b64_tr_b16 v[44:45], v13 offset:0
    v_mfma_f32_16x16x32_bf16 v[148:151], v[68:71], v[52:55], v[148:151]
    ds_read_b64_tr_b16 v[46:47], v13 offset:1024
    ds_read_b128 v[28:31], v4 offset:6144
    v_mfma_f32_16x16x32_bf16 v[132:135], v[68:71], v[48:51], v[132:135]
    v_mfma_f32_16x16x32_bf16 v[136:139], v[72:75], v[48:51], v[136:139]
    v_mfma_f32_16x16x32_bf16 v[152:155], v[72:75], v[52:55], v[152:155]
    v_mfma_f32_16x16x32_bf16 v[168:171], v[72:75], v[56:59], v[168:171]
    v_mfma_f32_16x16x32_bf16 v[184:187], v[72:75], v[60:63], v[184:187]
    v_mfma_f32_16x16x32_bf16 v[188:191], v[76:79], v[60:63], v[188:191]
    v_mfma_f32_16x16x32_bf16 v[172:175], v[76:79], v[56:59], v[172:175]
    v_mfma_f32_16x16x32_bf16 v[156:159], v[76:79], v[52:55], v[156:159]
    v_mfma_f32_16x16x32_bf16 v[140:143], v[76:79], v[48:51], v[140:143]
    s_sub_u32 s67, s67, 1
    s_cmp_lg_u32 s67, 0
    s_cbranch_scc1 L_sl_25
    ds_read_b64 v[192:193], v228 offset:0
    ds_read_b64 v[194:195], v229 offset:0
    ds_read_b64 v[196:197], v230 offset:0
    ds_read_b64 v[198:199], v231 offset:0
    ds_read_b64 v[200:201], v228 offset:2048
    ds_read_b64 v[202:203], v229 offset:2048
    ds_read_b64 v[204:205], v230 offset:2048
    ds_read_b64 v[206:207], v231 offset:2048
    ds_read_b64 v[208:209], v228 offset:4096
    ds_read_b64 v[210:211], v229 offset:4096
    ds_read_b64 v[212:213], v230 offset:4096
    ds_read_b64 v[214:215], v231 offset:4096
    ds_read_b64 v[216:217], v228 offset:6144
    ds_read_b64 v[218:219], v229 offset:6144
    ds_read_b64 v[220:221], v230 offset:6144
    ds_read_b64 v[222:223], v231 offset:6144
L_m2_done:
    s_waitcnt vmcnt(0) lgkmcnt(0)
    v_mov_b32 v120, 0x3f803f80
    v_mov_b32 v112, 0
    v_mov_b32 v113, 0
    v_mov_b32 v114, 0
    v_mov_b32 v115, 0
    v_mov_b32 v116, 0
    v_mov_b32 v117, 0
    v_mov_b32 v118, 0
    v_mov_b32 v119, 0
    s_nop 3
    v_cvt_pk_bf16_f32 v16, v128, v129
    v_cvt_pk_bf16_f32 v17, v130, v131
    v_cvt_pk_bf16_f32 v18, v132, v133
    v_cvt_pk_bf16_f32 v19, v134, v135
    v_cvt_pk_bf16_f32 v20, v136, v137
    v_cvt_pk_bf16_f32 v21, v138, v139
    v_cvt_pk_bf16_f32 v22, v140, v141
    v_cvt_pk_bf16_f32 v23, v142, v143
    v_lshlrev_b32 v128, 16, v16
    v_and_b32 v129, 0xffff0000, v16
    v_lshlrev_b32 v130, 16, v17
    v_and_b32 v131, 0xffff0000, v17
    v_lshlrev_b32 v132, 16, v18
    v_and_b32 v133, 0xffff0000, v18
    v_lshlrev_b32 v134, 16, v19
    v_and_b32 v135, 0xffff0000, v19
    v_lshlrev_b32 v136, 16, v20
    v_and_b32 v137, 0xffff0000, v20
    v_lshlrev_b32 v138, 16, v21
    v_and_b32 v139, 0xffff0000, v21
    v_lshlrev_b32 v140, 16, v22
    v_and_b32 v141, 0xffff0000, v22
    v_lshlrev_b32 v142, 16, v23
    v_and_b32 v143, 0xffff0000, v23
    v_lshlrev_b32 v32, 16, v192
    v_and_b32 v33, 0xffff0000, v192
    v_lshlrev_b32 v34, 16, v193
    v_and_b32 v35, 0xffff0000, v193
    v_lshlrev_b32 v36, 16, v194
    v_and_b32 v37, 0xffff0000, v194
    v_lshlrev_b32 v38, 16, v195
    v_and_b32 v39, 0xffff0000, v195
    v_lshlrev_b32 v40, 16, v196
    v_and_b32 v41, 0xffff0000, v196
    v_lshlrev_b32 v42, 16, v197
    v_and_b32 v43, 0xffff0000, v197
    v_lshlrev_b32 v44, 16, v198
    v_and_b32 v45, 0xffff0000, v198
    v_lshlrev_b32 v46, 16, v199
    v_and_b32 v47, 0xffff0000, v199
    v_pk_add_f32 v[128:129], v[128:129], v[32:33]
    v_pk_add_f32 v[130:131], v[130:131], v[34:35]
    v_pk_add_f32 v[132:133], v[132:133], v[36:37]
    v_pk_add_f32 v[134:135], v[134:135], v[38:39]
    v_pk_add_f32 v[136:137], v[136:137], v[40:41]
    v_pk_add_f32 v[138:139], v[138:139], v[42:43]
    v_pk_add_f32 v[140:141], v[140:141], v[44:45]
    v_pk_add_f32 v[142:143], v[142:143], v[46:47]
    v_cvt_pk_bf16_f32 v96, v128, v129
    v_cvt_pk_bf16_f32 v97, v130, v131
    v_cvt_pk_bf16_f32 v98, v132, v133
    v_cvt_pk_bf16_f32 v99, v134, v135
    v_cvt_pk_bf16_f32 v100, v136, v137
    v_cvt_pk_bf16_f32 v101, v138, v139
    v_cvt_pk_bf16_f32 v102, v140, v141
    v_cvt_pk_bf16_f32 v103, v142, v143
    ds_write_b64 v228, v[96:97] offset:0
    ds_write_b64 v229, v[98:99] offset:0
    ds_write_b64 v230, v[100:101] offset:0
    ds_write_b64 v231, v[102:103] offset:0
    ds_read_b128 v[80:83], v226 offset:0
    ds_read_b128 v[84:87], v227 offset:1024
    v_dot2_f32_bf16 v112, v96, v120, v112
    v_dot2_f32_bf16 v113, v96, v96, v113
    v_dot2_f32_bf16 v112, v97, v120, v112
    v_dot2_f32_bf16 v113, v97, v97, v113
    v_dot2_f32_bf16 v112, v98, v120, v112
    v_dot2_f32_bf16 v113, v98, v98, v113
    v_dot2_f32_bf16 v112, v99, v120, v112
    v_dot2_f32_bf16 v113, v99, v99, v113
    v_dot2_f32_bf16 v112, v100, v120, v112
    v_dot2_f32_bf16 v113, v100, v100, v113
    v_dot2_f32_bf16 v112, v101, v120, v112
    v_dot2_f32_bf16 v113, v101, v101, v113
    v_dot2_f32_bf16 v112, v102, v120, v112
    v_dot2_f32_bf16 v113, v102, v102, v113
    v_dot2_f32_bf16 v112, v103, v120, v112
    v_dot2_f32_bf16 v113, v103, v103, v113
    v_cvt_pk_bf16_f32 v16, v144, v145
    v_cvt_pk_bf16_f32 v17, v146, v147
    v_cvt_pk_bf16_f32 v18, v148, v149
    v_cvt_pk_bf16_f32 v19, v150, v151
    v_cvt_pk_bf16_f32 v20, v152, v153
    v_cvt_pk_bf16_f32 v21, v154, v155
    v_cvt_pk_bf16_f32 v22, v156, v157
    v_cvt_pk_bf16_f32 v23, v158, v159
    v_lshlrev_b32 v144, 16, v16
    v_and_b32 v145, 0xffff0000, v16
    v_lshlrev_b32 v146, 16, v17
    v_and_b32 v147, 0xffff0000, v17
    v_lshlrev_b32 v148, 16, v18
    v_and_b32 v149, 0xffff0000, v18
    v_lshlrev_b32 v150, 16, v19
    v_and_b32 v151, 0xffff0000, v19
    s_waitcnt lgkmcnt(0)
    v_add_u32 v232, 0x0, v225
    v_add_u32 v233, 0x4000, v225
    buffer_store_dwordx4 v[80:83], v232, s[36:39], 0 offen sc1
    buffer_store_dwordx4 v[84:87], v233, s[36:39], 0 offen sc1
    v_lshlrev_b32 v152, 16, v20
    v_and_b32 v153, 0xffff0000, v20
    v_lshlrev_b32 v154, 16, v21
    v_and_b32 v155, 0xffff0000, v21
    v_lshlrev_b32 v156, 16, v22
    v_and_b32 v157, 0xffff0000, v22
    v_lshlrev_b32 v158, 16, v23
    v_and_b32 v159, 0xffff0000, v23
    v_lshlrev_b32 v32, 16, v200
    v_and_b32 v33, 0xffff0000, v200
    v_lshlrev_b32 v34, 16, v201
    v_and_b32 v35, 0xffff0000, v201
    v_lshlrev_b32 v36, 16, v202
    v_and_b32 v37, 0xffff0000, v202
    v_lshlrev_b32 v38, 16, v203
    v_and_b32 v39, 0xffff0000, v203
    v_lshlrev_b32 v40, 16, v204
    v_and_b32 v41, 0xffff0000, v204
    v_lshlrev_b32 v42, 16, v205
    v_and_b32 v43, 0xffff0000, v205
    v_lshlrev_b32 v44, 16, v206
    v_and_b32 v45, 0xffff0000, v206
    v_lshlrev_b32 v46, 16, v207
    v_and_b32 v47, 0xffff0000, v207
    v_pk_add_f32 v[144:145], v[144:145], v[32:33]
    v_pk_add_f32 v[146:147], v[146:147], v[34:35]
    v_pk_add_f32 v[148:149], v[148:149], v[36:37]
    v_pk_add_f32 v[150:151], v[150:151], v[38:39]
    v_pk_add_f32 v[152:153], v[152:153], v[40:41]
    v_pk_add_f32 v[154:155], v[154:155], v[42:43]
    v_pk_add_f32 v[156:157], v[156:157], v[44:45]
    v_pk_add_f32 v[158:159], v[158:159], v[46:47]
    v_cvt_pk_bf16_f32 v104, v144, v145
    v_cvt_pk_bf16_f32 v105, v146, v147
    v_cvt_pk_bf16_f32 v106, v148, v149
    v_cvt_pk_bf16_f32 v107, v150, v151
    v_cvt_pk_bf16_f32 v108, v152, v153
    v_cvt_pk_bf16_f32 v109, v154, v155
    v_cvt_pk_bf16_f32 v110, v156, v157
    v_cvt_pk_bf16_f32 v111, v158, v159
    ds_write_b64 v228, v[104:105] offset:2048
    ds_write_b64 v229, v[106:107] offset:2048
    ds_write_b64 v230, v[108:109] offset:2048
    ds_write_b64 v231, v[110:111] offset:2048
    ds_read_b128 v[88:91], v226 offset:2048
    ds_read_b128 v[92:95], v227 offset:3072
    v_dot2_f32_bf16 v114, v104, v120, v114
    v_dot2_f32_bf16 v115, v104, v104, v115
    v_dot2_f32_bf16 v114, v105, v120, v114
    v_dot2_f32_bf16 v115, v105, v105, v115
    v_dot2_f32_bf16 v114, v106, v120, v114
    v_dot2_f32_bf16 v115, v106, v106, v115
    v_dot2_f32_bf16 v114, v107, v120, v114
    v_dot2_f32_bf16 v115, v107, v107, v115
    v_dot2_f32_bf16 v114, v108, v120, v114
    v_dot2_f32_bf16 v115, v108, v108, v115
    v_dot2_f32_bf16 v114, v109, v120, v114
    v_dot2_f32_bf16 v115, v109, v109, v115
    v_dot2_f32_bf16 v114, v110, v120, v114
    v_dot2_f32_bf16 v115, v110, v110, v115
    v_dot2_f32_bf16 v114, v111, v120, v114
    v_dot2_f32_bf16 v115, v111, v111, v115
    v_cvt_pk_bf16_f32 v16, v160, v161
    v_cvt_pk_bf16_f32 v17, v162, v163
    v_cvt_pk_bf16_f32 v18, v164, v165
    v_cvt_pk_bf16_f32 v19, v166, v167
    v_cvt_pk_bf16_f32 v20, v168, v169
    v_cvt_pk_bf16_f32 v21, v170, v171
    v_cvt_pk_bf16_f32 v22, v172, v173
    v_cvt_pk_bf16_f32 v23, v174, v175
    v_lshlrev_b32 v160, 16, v16
    v_and_b32 v161, 0xffff0000, v16
    v_lshlrev_b32 v162, 16, v17
    v_and_b32 v163, 0xffff0000, v17
    v_lshlrev_b32 v164, 16, v18
    v_and_b32 v165, 0xffff0000, v18
    v_lshlrev_b32 v166, 16, v19
    v_and_b32 v167, 0xffff0000, v19
    s_waitcnt lgkmcnt(0)
    v_add_u32 v234, 0x8000, v225
    v_add_u32 v235, 0xc000, v225
    buffer_store_dwordx4 v[88:91], v234, s[36:39], 0 offen sc1
    buffer_store_dwordx4 v[92:95], v235, s[36:39], 0 offen sc1
    v_lshlrev_b32 v168, 16, v20
    v_and_b32 v169, 0xffff0000, v20
    v_lshlrev_b32 v170, 16, v21
    v_and_b32 v171, 0xffff0000, v21
    v_lshlrev_b32 v172, 16, v22
    v_and_b32 v173, 0xffff0000, v22
    v_lshlrev_b32 v174, 16, v23
    v_and_b32 v175, 0xffff0000, v23
    v_lshlrev_b32 v32, 16, v208
    v_and_b32 v33, 0xffff0000, v208
    v_lshlrev_b32 v34, 16, v209
    v_and_b32 v35, 0xffff0000, v209
    v_lshlrev_b32 v36, 16, v210
    v_and_b32 v37, 0xffff0000, v210
    v_lshlrev_b32 v38, 16, v211
    v_and_b32 v39, 0xffff0000, v211
    v_lshlrev_b32 v40, 16, v212
    v_and_b32 v41, 0xffff0000, v212
    v_lshlrev_b32 v42, 16, v213
    v_and_b32 v43, 0xffff0000, v213
    v_lshlrev_b32 v44, 16, v214
    v_and_b32 v45, 0xffff0000, v214
    v_lshlrev_b32 v46, 16, v215
    v_and_b32 v47, 0xffff0000, v215
    v_pk_add_f32 v[160:161], v[160:161], v[32:33]
    v_pk_add_f32 v[162:163], v[162:163], v[34:35]
    v_pk_add_f32 v[164:165], v[164:165], v[36:37]
    v_pk_add_f32 v[166:167], v[166:167], v[38:39]
    v_pk_add_f32 v[168:169], v[168:169], v[40:41]
    v_pk_add_f32 v[170:171], v[170:171], v[42:43]
    v_pk_add_f32 v[172:173], v[172:173], v[44:45]
    v_pk_add_f32 v[174:175], v[174:175], v[46:47]
    v_cvt_pk_bf16_f32 v96, v160, v161
    v_cvt_pk_bf16_f32 v97, v162, v163
    v_cvt_pk_bf16_f32 v98, v164, v165
    v_cvt_pk_bf16_f32 v99, v166, v167
    v_cvt_pk_bf16_f32 v100, v168, v169
    v_cvt_pk_bf16_f32 v101, v170, v171
    v_cvt_pk_bf16_f32 v102, v172, v173
    v_cvt_pk_bf16_f32 v103, v174, v175
    ds_write_b64 v228, v[96:97] offset:4096
    ds_write_b64 v229, v[98:99] offset:4096
    ds_write_b64 v230, v[100:101] offset:4096
    ds_write_b64 v231, v[102:103] offset:4096
    ds_read_b128 v[80:83], v226 offset:4096
    ds_read_b128 v[84:87], v227 offset:5120
    v_dot2_f32_bf16 v116, v96, v120, v116
    v_dot2_f32_bf16 v117, v96, v96, v117
    v_dot2_f32_bf16 v116, v97, v120, v116
    v_dot2_f32_bf16 v117, v97, v97, v117
    v_dot2_f32_bf16 v116, v98, v120, v116
    v_dot2_f32_bf16 v117, v98, v98, v117
    v_dot2_f32_bf16 v116, v99, v120, v116
    v_dot2_f32_bf16 v117, v99, v99, v117
    v_dot2_f32_bf16 v116, v100, v120, v116
    v_dot2_f32_bf16 v117, v100, v100, v117
    v_dot2_f32_bf16 v116, v101, v120, v116
    v_dot2_f32_bf16 v117, v101, v101, v117
    v_dot2_f32_bf16 v116, v102, v120, v116
    v_dot2_f32_bf16 v117, v102, v102, v117
    v_dot2_f32_bf16 v116, v103, v120, v116
    v_dot2_f32_bf16 v117, v103, v103, v117
    v_cvt_pk_bf16_f32 v16, v176, v177
    v_cvt_pk_bf16_f32 v17, v178, v179
    v_cvt_pk_bf16_f32 v18, v180, v181
    v_cvt_pk_bf16_f32 v19, v182, v183
    v_cvt_pk_bf16_f32 v20, v184, v185
    v_cvt_pk_bf16_f32 v21, v186, v187
    v_cvt_pk_bf16_f32 v22, v188, v189
    v_cvt_pk_bf16_f32 v23, v190, v191
    v_lshlrev_b32 v176, 16, v16
    v_and_b32 v177, 0xffff0000, v16
    v_lshlrev_b32 v178, 16, v17
    v_and_b32 v179, 0xffff0000, v17
    v_lshlrev_b32 v180, 16, v18
    v_and_b32 v181, 0xffff0000, v18
    v_lshlrev_b32 v182, 16, v19
    v_and_b32 v183, 0xffff0000, v19
    s_waitcnt lgkmcnt(0)
    v_add_u32 v232, 0x10000, v225
    v_add_u32 v233, 0x14000, v225
    buffer_store_dwordx4 v[80:83], v232, s[36:39], 0 offen sc1
    buffer_store_dwordx4 v[84:87], v233, s[36:39], 0 offen sc1
    v_lshlrev_b32 v184, 16, v20
    v_and_b32 v185, 0xffff0000, v20
    v_lshlrev_b32 v186, 16, v21
    v_and_b32 v187, 0xffff0000, v21
    v_lshlrev_b32 v188, 16, v22
    v_and_b32 v189, 0xffff0000, v22
    v_lshlrev_b32 v190, 16, v23
    v_and_b32 v191, 0xffff0000, v23
    v_lshlrev_b32 v32, 16, v216
    v_and_b32 v33, 0xffff0000, v216
    v_lshlrev_b32 v34, 16, v217
    v_and_b32 v35, 0xffff0000, v217
    v_lshlrev_b32 v36, 16, v218
    v_and_b32 v37, 0xffff0000, v218
    v_lshlrev_b32 v38, 16, v219
    v_and_b32 v39, 0xffff0000, v219
    v_lshlrev_b32 v40, 16, v220
    v_and_b32 v41, 0xffff0000, v220
    v_lshlrev_b32 v42, 16, v221
    v_and_b32 v43, 0xffff0000, v221
    v_lshlrev_b32 v44, 16, v222
    v_and_b32 v45, 0xffff0000, v222
    v_lshlrev_b32 v46, 16, v223
    v_and_b32 v47, 0xffff0000, v223
    v_pk_add_f32 v[176:177], v[176:177], v[32:33]
    v_pk_add_f32 v[178:179], v[178:179], v[34:35]
    v_pk_add_f32 v[180:181], v[180:181], v[36:37]
    v_pk_add_f32 v[182:183], v[182:183], v[38:39]
    v_pk_add_f32 v[184:185], v[184:185], v[40:41]
    v_pk_add_f32 v[186:187], v[186:187], v[42:43]
    v_pk_add_f32 v[188:189], v[188:189], v[44:45]
    v_pk_add_f32 v[190:191], v[190:191], v[46:47]
    v_cvt_pk_bf16_f32 v104, v176, v177
    v_cvt_pk_bf16_f32 v105, v178, v179
    v_cvt_pk_bf16_f32 v106, v180, v181
    v_cvt_pk_bf16_f32 v107, v182, v183
    v_cvt_pk_bf16_f32 v108, v184, v185
    v_cvt_pk_bf16_f32 v109, v186, v187
    v_cvt_pk_bf16_f32 v110, v188, v189
    v_cvt_pk_bf16_f32 v111, v190, v191
    ds_write_b64 v228, v[104:105] offset:6144
    ds_write_b64 v229, v[106:107] offset:6144
    ds_write_b64 v230, v[108:109] offset:6144
    ds_write_b64 v231, v[110:111] offset:6144
    ds_read_b128 v[88:91], v226 offset:6144
    ds_read_b128 v[92:95], v227 offset:7168
    v_dot2_f32_bf16 v118, v104, v120, v118
    v_dot2_f32_bf16 v119, v104, v104, v119
    v_dot2_f32_bf16 v118, v105, v120, v118
    v_dot2_f32_bf16 v119, v105, v105, v119
    v_dot2_f32_bf16 v118, v106, v120, v118
    v_dot2_f32_bf16 v119, v106, v106, v119
    v_dot2_f32_bf16 v118, v107, v120, v118
    v_dot2_f32_bf16 v119, v107, v107, v119
    v_dot2_f32_bf16 v118, v108, v120, v118
    v_dot2_f32_bf16 v119, v108, v108, v119
    v_dot2_f32_bf16 v118, v109, v120, v118
    v_dot2_f32_bf16 v119, v109, v109, v119
    v_dot2_f32_bf16 v118, v110, v120, v118
    v_dot2_f32_bf16 v119, v110, v110, v119
    v_dot2_f32_bf16 v118, v111, v120, v118
    v_dot2_f32_bf16 v119, v111, v111, v119
    s_waitcnt lgkmcnt(0)
    v_add_u32 v234, 0x18000, v225
    v_add_u32 v235, 0x1c000, v225
    buffer_store_dwordx4 v[88:91], v234, s[36:39], 0 offen sc1
    buffer_store_dwordx4 v[92:95], v235, s[36:39], 0 offen sc1
    s_add_u32 s52, s26, 0x2500000
    s_addc_u32 s53, s27, 0
    s_mov_b32 s54, 0x40000
    s_mov_b32 s55, 0x20000
    s_lshl_b32 s71, s77, 3
    s_add_u32 s71, s71, s63
    s_lshl_b32 s71, s71, 1
    s_and_b32 s72, s60, 1
    s_add_u32 s71, s71, s72
    s_lshl_b32 s71, s71, 1
    s_lshr_b32 s72, s60, 1
    s_add_u32 s71, s71, s72
    s_lshl_b32 s71, s71, 9
    v_permlane32_swap_b32 v112, v116
    v_permlane32_swap_b32 v113, v117
    v_permlane32_swap_b32 v114, v118
    v_permlane32_swap_b32 v115, v119
    s_nop 1
    v_pk_add_f32 v[112:113], v[112:113], v[116:117]
    v_pk_add_f32 v[114:115], v[114:115], v[118:119]
    v_lshlrev_b32 v3, 3, v1
    s_nop 0
    v_permlane16_swap_b32 v112, v114
    v_permlane16_swap_b32 v113, v115
    s_nop 1
    v_pk_add_f32 v[116:117], v[112:113], v[114:115]
    buffer_store_dwordx2 v[116:117], v3, s[52:55], s71 offen sc1
    s_nop 1
    s_branch L_p3
L_A:
    s_barrier
    ds_read_b64_tr_b16 v[48:49], v6 offset:0
    ds_read_b64_tr_b16 v[50:51], v6 offset:2048
    ds_read_b128 v[16:19], v4 offset:0
    ds_read_b64_tr_b16 v[52:53], v7 offset:0
    ds_read_b64_tr_b16 v[54:55], v7 offset:2048
    ds_read_b128 v[20:23], v4 offset:2048
    ds_read_b64_tr_b16 v[56:57], v12 offset:0
    ds_read_b64_tr_b16 v[58:59], v12 offset:2048
    ds_read_b128 v[24:27], v4 offset:4096
    ds_read_b64_tr_b16 v[60:61], v13 offset:0
    ds_read_b64_tr_b16 v[62:63], v13 offset:2048
    ds_read_b128 v[28:31], v4 offset:6144
    ds_read_b128 v[32:35], v4 offset:8192
    ds_read_b128 v[36:39], v4 offset:10240
    ds_read_b128 v[40:43], v4 offset:12288
    ds_read_b128 v[44:47], v4 offset:14336
    s_cmp_lg_u32 s60, 0
    s_cbranch_scc1 L_w0_30
    s_mov_b32 s48, s24
    s_mov_b32 s49, s25
    s_mov_b32 s50, 0x100
    s_mov_b32 s51, 0x20000
    v_mov_b32 v121, 252
    v_mov_b32 v122, 0
    s_mov_b32 s71, 252
    v_mov_b32 v121, s71
    s_mov_b32 s71, 1
    v_writelane_b32 v122, s71, 0
    buffer_load_dword v123, v121, s[48:51], 0 offen sc1
L_w0_30:
    s_waitcnt lgkmcnt(0)
    v_mfma_f32_16x16x32_bf16 v[128:131], v[16:19], v[48:51], 0
    ds_read_b64_tr_b16 v[96:97], v6 offset:16384
    ds_read_b64_tr_b16 v[98:99], v6 offset:18432
    v_mfma_f32_16x16x32_bf16 v[144:147], v[20:23], v[48:51], 0
    ds_read_b128 v[64:67], v5 offset:0
    ds_read_b64_tr_b16 v[100:101], v7 offset:16384
    v_mfma_f32_16x16x32_bf16 v[160:163], v[24:27], v[48:51], 0
    ds_read_b64_tr_b16 v[102:103], v7 offset:18432
    ds_read_b128 v[68:71], v5 offset:2048
    v_mfma_f32_16x16x32_bf16 v[176:179], v[28:31], v[48:51], 0
    ds_read_b64_tr_b16 v[104:105], v12 offset:16384
    ds_read_b64_tr_b16 v[106:107], v12 offset:18432
    v_mfma_f32_16x16x32_bf16 v[192:195], v[32:35], v[48:51], 0
    ds_read_b128 v[72:75], v5 offset:4096
    ds_read_b64_tr_b16 v[108:109], v13 offset:16384
    v_mfma_f32_16x16x32_bf16 v[208:211], v[36:39], v[48:51], 0
    ds_read_b64_tr_b16 v[110:111], v13 offset:18432
    ds_read_b128 v[76:79], v5 offset:6144
    v_mfma_f32_16x16x32_bf16 v[224:227], v[40:43], v[48:51], 0
    ds_read_b128 v[80:83], v5 offset:8192
    ds_read_b128 v[84:87], v5 offset:10240
    v_mfma_f32_16x16x32_bf16 v[240:243], v[44:47], v[48:51], 0
    ds_read_b128 v[88:91], v5 offset:12288
    ds_read_b128 v[92:95], v5 offset:14336
    v_mfma_f32_16x16x32_bf16 v[244:247], v[44:47], v[52:55], 0
    s_add_u32 s70, s70, 49152
    s_cmp_eq_u32 s70, 147456
    v_mfma_f32_16x16x32_bf16 v[228:231], v[40:43], v[52:55], 0
    s_cselect_b32 s70, 0, s70
    v_add_u32 v4, s70, v8
    v_mfma_f32_16x16x32_bf16 v[212:215], v[36:39], v[52:55], 0
    v_add_u32 v5, s70, v9
    v_add_u32 v6, s70, v10
    v_mfma_f32_16x16x32_bf16 v[196:199], v[32:35], v[52:55], 0
    v_add_u32 v7, s70, v11
    v_add_u32 v12, s70, v14
    v_mfma_f32_16x16x32_bf16 v[180:183], v[28:31], v[52:55], 0
    v_add_u32 v13, s70, v15
    buffer_load_dword v127, v126, s[56:59], s85 offen
    v_mfma_f32_16x16x32_bf16 v[164:167], v[24:27], v[52:55], 0
    s_add_u32 s85, s85, s87
    v_mfma_f32_16x16x32_bf16 v[148:151], v[20:23], v[52:55], 0
    v_mfma_f32_16x16x32_bf16 v[132:135], v[16:19], v[52:55], 0
    v_mfma_f32_16x16x32_bf16 v[136:139], v[16:19], v[56:59], 0
    v_mfma_f32_16x16x32_bf16 v[152:155], v[20:23], v[56:59], 0
    v_mfma_f32_16x16x32_bf16 v[168:171], v[24:27], v[56:59], 0
    v_mfma_f32_16x16x32_bf16 v[184:187], v[28:31], v[56:59], 0
    v_mfma_f32_16x16x32_bf16 v[200:203], v[32:35], v[56:59], 0
    v_mfma_f32_16x16x32_bf16 v[216:219], v[36:39], v[56:59], 0
    v_mfma_f32_16x16x32_bf16 v[232:235], v[40:43], v[56:59], 0
    v_mfma_f32_16x16x32_bf16 v[248:251], v[44:47], v[56:59], 0
    v_mfma_f32_16x16x32_bf16 v[252:255], v[44:47], v[60:63], 0
    v_mfma_f32_16x16x32_bf16 v[236:239], v[40:43], v[60:63], 0
    v_mfma_f32_16x16x32_bf16 v[220:223], v[36:39], v[60:63], 0
    v_mfma_f32_16x16x32_bf16 v[204:207], v[32:35], v[60:63], 0
    v_mfma_f32_16x16x32_bf16 v[188:191], v[28:31], v[60:63], 0
    v_mfma_f32_16x16x32_bf16 v[172:175], v[24:27], v[60:63], 0
    v_mfma_f32_16x16x32_bf16 v[156:159], v[20:23], v[60:63], 0
    v_mfma_f32_16x16x32_bf16 v[140:143], v[16:19], v[60:63], 0
    s_waitcnt lgkmcnt(0)
    v_mfma_f32_16x16x32_bf16 v[128:131], v[64:67], v[96:99], v[128:131]
    s_barrier
    v_mfma_f32_16x16x32_bf16 v[144:147], v[68:71], v[96:99], v[144:147]
    ds_read_b64_tr_b16 v[48:49], v6 offset:0
    v_mfma_f32_16x16x32_bf16 v[160:163], v[72:75], v[96:99], v[160:163]
    ds_read_b64_tr_b16 v[50:51], v6 offset:2048
    v_mfma_f32_16x16x32_bf16 v[176:179], v[76:79], v[96:99], v[176:179]
    ds_read_b128 v[16:19], v4 offset:0
    v_mfma_f32_16x16x32_bf16 v[192:195], v[80:83], v[96:99], v[192:195]
    ds_read_b64_tr_b16 v[52:53], v7 offset:0
    v_mfma_f32_16x16x32_bf16 v[208:211], v[84:87], v[96:99], v[208:211]
    ds_read_b64_tr_b16 v[54:55], v7 offset:2048
    v_mfma_f32_16x16x32_bf16 v[224:227], v[88:91], v[96:99], v[224:227]
    ds_read_b128 v[20:23], v4 offset:2048
    v_mfma_f32_16x16x32_bf16 v[240:243], v[92:95], v[96:99], v[240:243]
    ds_read_b64_tr_b16 v[56:57], v12 offset:0
    v_mfma_f32_16x16x32_bf16 v[244:247], v[92:95], v[100:103], v[244:247]
    ds_read_b64_tr_b16 v[58:59], v12 offset:2048
    v_mfma_f32_16x16x32_bf16 v[228:231], v[88:91], v[100:103], v[228:231]
    ds_read_b128 v[24:27], v4 offset:4096
    v_mfma_f32_16x16x32_bf16 v[212:215], v[84:87], v[100:103], v[212:215]
    ds_read_b64_tr_b16 v[60:61], v13 offset:0
    v_mfma_f32_16x16x32_bf16 v[196:199], v[80:83], v[100:103], v[196:199]
    ds_read_b64_tr_b16 v[62:63], v13 offset:2048
    v_mfma_f32_16x16x32_bf16 v[180:183], v[76:79], v[100:103], v[180:183]
    ds_read_b128 v[28:31], v4 offset:6144
    v_mfma_f32_16x16x32_bf16 v[164:167], v[72:75], v[100:103], v[164:167]
    ds_read_b128 v[32:35], v4 offset:8192
    v_mfma_f32_16x16x32_bf16 v[148:151], v[68:71], v[100:103], v[148:151]
    ds_read_b128 v[36:39], v4 offset:10240
    v_mfma_f32_16x16x32_bf16 v[132:135], v[64:67], v[100:103], v[132:135]
    ds_read_b128 v[40:43], v4 offset:12288
    v_mfma_f32_16x16x32_bf16 v[136:139], v[64:67], v[104:107], v[136:139]
    ds_read_b128 v[44:47], v4 offset:14336
    v_mfma_f32_16x16x32_bf16 v[152:155], v[68:71], v[104:107], v[152:155]
    v_mfma_f32_16x16x32_bf16 v[168:171], v[72:75], v[104:107], v[168:171]
    v_mfma_f32_16x16x32_bf16 v[184:187], v[76:79], v[104:107], v[184:187]
    v_mfma_f32_16x16x32_bf16 v[200:203], v[80:83], v[104:107], v[200:203]
    v_mfma_f32_16x16x32_bf16 v[216:219], v[84:87], v[104:107], v[216:219]
    v_mfma_f32_16x16x32_bf16 v[232:235], v[88:91], v[104:107], v[232:235]
    v_mfma_f32_16x16x32_bf16 v[248:251], v[92:95], v[104:107], v[248:251]
    v_mfma_f32_16x16x32_bf16 v[252:255], v[92:95], v[108:111], v[252:255]
    v_mfma_f32_16x16x32_bf16 v[236:239], v[88:91], v[108:111], v[236:239]
    v_mfma_f32_16x16x32_bf16 v[220:223], v[84:87], v[108:111], v[220:223]
    v_mfma_f32_16x16x32_bf16 v[204:207], v[80:83], v[108:111], v[204:207]
    v_mfma_f32_16x16x32_bf16 v[188:191], v[76:79], v[108:111], v[188:191]
    v_mfma_f32_16x16x32_bf16 v[172:175], v[72:75], v[108:111], v[172:175]
    v_mfma_f32_16x16x32_bf16 v[156:159], v[68:71], v[108:111], v[156:159]
    v_mfma_f32_16x16x32_bf16 v[140:143], v[64:67], v[108:111], v[140:143]
    s_waitcnt vmcnt(1)
    s_sub_u32 s71, s80, 24
    s_and_b32 s72, s79, 3
    s_lshl_b32 s72, s72, 3
    s_add_u32 s69, s71, s72
    s_lshr_b32 s68, s69, 1
    s_cmp_ge_u32 s80, 24
    s_cselect_b32 s68, s68, s77
    s_mov_b32 s81, 0
    s_mov_b32 s67, 1
L_sl_31:
    s_waitcnt lgkmcnt(0)
    v_mfma_f32_16x16x32_bf16 v[128:131], v[16:19], v[48:51], v[128:131]
    ds_read_b64_tr_b16 v[96:97], v6 offset:16384
    ds_read_b64_tr_b16 v[98:99], v6 offset:18432
    v_mfma_f32_16x16x32_bf16 v[144:147], v[20:23], v[48:51], v[144:147]
    ds_read_b128 v[64:67], v5 offset:0
    ds_read_b64_tr_b16 v[100:101], v7 offset:16384
    v_mfma_f32_16x16x32_bf16 v[160:163], v[24:27], v[48:51], v[160:163]
    ds_read_b64_tr_b16 v[102:103], v7 offset:18432
    ds_read_b128 v[68:71], v5 offset:2048
    v_mfma_f32_16x16x32_bf16 v[176:179], v[28:31], v[48:51], v[176:179]
    ds_read_b64_tr_b16 v[104:105], v12 offset:16384
    ds_read_b64_tr_b16 v[106:107], v12 offset:18432
    v_mfma_f32_16x16x32_bf16 v[192:195], v[32:35], v[48:51], v[192:195]
    ds_read_b128 v[72:75], v5 offset:4096
    ds_read_b64_tr_b16 v[108:109], v13 offset:16384
    v_mfma_f32_16x16x32_bf16 v[208:211], v[36:39], v[48:51], v[208:211]
    ds_read_b64_tr_b16 v[110:111], v13 offset:18432
    ds_read_b128 v[76:79], v5 offset:6144
    v_mfma_f32_16x16x32_bf16 v[224:227], v[40:43], v[48:51], v[224:227]
    ds_read_b128 v[80:83], v5 offset:8192
    ds_read_b128 v[84:87], v5 offset:10240
    v_mfma_f32_16x16x32_bf16 v[240:243], v[44:47], v[48:51], v[240:243]
    ds_read_b128 v[88:91], v5 offset:12288
    ds_read_b128 v[92:95], v5 offset:14336
    v_mfma_f32_16x16x32_bf16 v[244:247], v[44:47], v[52:55], v[244:247]
    s_add_u32 s70, s70, 49152
    s_cmp_eq_u32 s70, 147456
    v_mfma_f32_16x16x32_bf16 v[228:231], v[40:43], v[52:55], v[228:231]
    s_cselect_b32 s70, 0, s70
    v_add_u32 v4, s70, v8
    v_mfma_f32_16x16x32_bf16 v[212:215], v[36:39], v[52:55], v[212:215]
    v_add_u32 v5, s70, v9
    v_add_u32 v6, s70, v10
    v_mfma_f32_16x16x32_bf16 v[196:199], v[32:35], v[52:55], v[196:199]
    v_add_u32 v7, s70, v11
    v_add_u32 v12, s70, v14
    v_mfma_f32_16x16x32_bf16 v[180:183], v[28:31], v[52:55], v[180:183]
    v_add_u32 v13, s70, v15
    buffer_load_dword v127, v126, s[56:59], s85 offen
    v_mfma_f32_16x16x32_bf16 v[164:167], v[24:27], v[52:55], v[164:167]
    s_add_u32 s85, s85, s87
    v_mfma_f32_16x16x32_bf16 v[148:151], v[20:23], v[52:55], v[148:151]
    v_mfma_f32_16x16x32_bf16 v[132:135], v[16:19], v[52:55], v[132:135]
    v_mfma_f32_16x16x32_bf16 v[136:139], v[16:19], v[56:59], v[136:139]
    v_mfma_f32_16x16x32_bf16 v[152:155], v[20:23], v[56:59], v[152:155]
    v_mfma_f32_16x16x32_bf16 v[168:171], v[24:27], v[56:59], v[168:171]
    v_mfma_f32_16x16x32_bf16 v[184:187], v[28:31], v[56:59], v[184:187]
    v_mfma_f32_16x16x32_bf16 v[200:203], v[32:35], v[56:59], v[200:203]
    v_mfma_f32_16x16x32_bf16 v[216:219], v[36:39], v[56:59], v[216:219]
    v_mfma_f32_16x16x32_bf16 v[232:235], v[40:43], v[56:59], v[232:235]
    v_mfma_f32_16x16x32_bf16 v[248:251], v[44:47], v[56:59], v[248:251]
    v_mfma_f32_16x16x32_bf16 v[252:255], v[44:47], v[60:63], v[252:255]
    v_mfma_f32_16x16x32_bf16 v[236:239], v[40:43], v[60:63], v[236:239]
    v_mfma_f32_16x16x32_bf16 v[220:223], v[36:39], v[60:63], v[220:223]
    v_mfma_f32_16x16x32_bf16 v[204:207], v[32:35], v[60:63], v[204:207]
    v_mfma_f32_16x16x32_bf16 v[188:191], v[28:31], v[60:63], v[188:191]
    v_mfma_f32_16x16x32_bf16 v[172:175], v[24:27], v[60:63], v[172:175]
    v_mfma_f32_16x16x32_bf16 v[156:159], v[20:23], v[60:63], v[156:159]
    v_mfma_f32_16x16x32_bf16 v[140:143], v[16:19], v[60:63], v[140:143]
    s_waitcnt lgkmcnt(0)
    v_mfma_f32_16x16x32_bf16 v[128:131], v[64:67], v[96:99], v[128:131]
    s_barrier
    v_mfma_f32_16x16x32_bf16 v[144:147], v[68:71], v[96:99], v[144:147]
    ds_read_b64_tr_b16 v[48:49], v6 offset:0
    v_mfma_f32_16x16x32_bf16 v[160:163], v[72:75], v[96:99], v[160:163]
    ds_read_b64_tr_b16 v[50:51], v6 offset:2048
    v_mfma_f32_16x16x32_bf16 v[176:179], v[76:79], v[96:99], v[176:179]
    ds_read_b128 v[16:19], v4 offset:0
    v_mfma_f32_16x16x32_bf16 v[192:195], v[80:83], v[96:99], v[192:195]
    ds_read_b64_tr_b16 v[52:53], v7 offset:0
    v_mfma_f32_16x16x32_bf16 v[208:211], v[84:87], v[96:99], v[208:211]
    ds_read_b64_tr_b16 v[54:55], v7 offset:2048
    v_mfma_f32_16x16x32_bf16 v[224:227], v[88:91], v[96:99], v[224:227]
    ds_read_b128 v[20:23], v4 offset:2048
    v_mfma_f32_16x16x32_bf16 v[240:243], v[92:95], v[96:99], v[240:243]
    ds_read_b64_tr_b16 v[56:57], v12 offset:0
    v_mfma_f32_16x16x32_bf16 v[244:247], v[92:95], v[100:103], v[244:247]
    ds_read_b64_tr_b16 v[58:59], v12 offset:2048
    v_mfma_f32_16x16x32_bf16 v[228:231], v[88:91], v[100:103], v[228:231]
    ds_read_b128 v[24:27], v4 offset:4096
    v_mfma_f32_16x16x32_bf16 v[212:215], v[84:87], v[100:103], v[212:215]
    ds_read_b64_tr_b16 v[60:61], v13 offset:0
    v_mfma_f32_16x16x32_bf16 v[196:199], v[80:83], v[100:103], v[196:199]
    ds_read_b64_tr_b16 v[62:63], v13 offset:2048
    v_mfma_f32_16x16x32_bf16 v[180:183], v[76:79], v[100:103], v[180:183]
    ds_read_b128 v[28:31], v4 offset:6144
    v_mfma_f32_16x16x32_bf16 v[164:167], v[72:75], v[100:103], v[164:167]
    ds_read_b128 v[32:35], v4 offset:8192
    v_mfma_f32_16x16x32_bf16 v[148:151], v[68:71], v[100:103], v[148:151]
    ds_read_b128 v[36:39], v4 offset:10240
    v_mfma_f32_16x16x32_bf16 v[132:135], v[64:67], v[100:103], v[132:135]
    ds_read_b128 v[40:43], v4 offset:12288
    v_mfma_f32_16x16x32_bf16 v[136:139], v[64:67], v[104:107], v[136:139]
    ds_read_b128 v[44:47], v4 offset:14336
    v_mfma_f32_16x16x32_bf16 v[152:155], v[68:71], v[104:107], v[152:155]
    v_mfma_f32_16x16x32_bf16 v[168:171], v[72:75], v[104:107], v[168:171]
    v_mfma_f32_16x16x32_bf16 v[184:187], v[76:79], v[104:107], v[184:187]
    v_mfma_f32_16x16x32_bf16 v[200:203], v[80:83], v[104:107], v[200:203]
    v_mfma_f32_16x16x32_bf16 v[216:219], v[84:87], v[104:107], v[216:219]
    v_mfma_f32_16x16x32_bf16 v[232:235], v[88:91], v[104:107], v[232:235]
    v_mfma_f32_16x16x32_bf16 v[248:251], v[92:95], v[104:107], v[248:251]
    v_mfma_f32_16x16x32_bf16 v[252:255], v[92:95], v[108:111], v[252:255]
    v_mfma_f32_16x16x32_bf16 v[236:239], v[88:91], v[108:111], v[236:239]
    v_mfma_f32_16x16x32_bf16 v[220:223], v[84:87], v[108:111], v[220:223]
    v_mfma_f32_16x16x32_bf16 v[204:207], v[80:83], v[108:111], v[204:207]
    v_mfma_f32_16x16x32_bf16 v[188:191], v[76:79], v[108:111], v[188:191]
    v_mfma_f32_16x16x32_bf16 v[172:175], v[72:75], v[108:111], v[172:175]
    v_mfma_f32_16x16x32_bf16 v[156:159], v[68:71], v[108:111], v[156:159]
    v_mfma_f32_16x16x32_bf16 v[140:143], v[64:67], v[108:111], v[140:143]
    s_sub_u32 s67, s67, 1
    s_cmp_lg_u32 s67, 0
    s_cbranch_scc1 L_sl_31
    s_cmp_lg_u32 s81, 0
    s_cbranch_scc1 L_sn_32
    s_cmp_lg_u32 s60, 0
    s_cbranch_scc1 L_w0_33
    s_waitcnt vmcnt(2)
    v_cmp_lt_u32 vcc, v123, v122
    s_nop 0
    s_cmp_eq_u64 vcc, 0
    s_cbranch_scc1 L_apolld_35
    s_mov_b32 s48, s24
    s_mov_b32 s49, s25
    s_mov_b32 s50, 0x100
    s_mov_b32 s51, 0x20000
    s_mov_b32 s72, 0x40000
L_apoll_34:
    buffer_load_dword v123, v121, s[48:51], 0 offen sc1
    s_waitcnt vmcnt(0)
    v_cmp_lt_u32 vcc, v123, v122
    s_sub_u32 s72, s72, 1
    s_cmp_eq_u32 s72, 0
    s_cbranch_scc1 L_apolld_35
    s_cmp_eq_u64 vcc, 0
    s_cbranch_scc1 L_apolld_35
    s_sleep 4
    s_branch L_apoll_34
L_apolld_35:
    s_add_u32 s48, s26, 0x2700000
    s_addc_u32 s49, s27, 0
    s_mov_b32 s50, 0x8000
    s_mov_b32 s51, 0x20000
    s_lshl_b32 s71, s77, 7
    s_add_u32 s71, s71, 14336
    v_mov_b32 v2, s71
    v_mov_b32 v3, 1
    s_mov_b64 exec, 1
    buffer_atomic_add v3, v2, s[48:51], 0 offen sc1
    s_mov_b64 exec, -1
L_w0_33:
    s_mov_b32 s81, 1
    s_mov_b32 s67, 8
    s_branch L_sl_31
L_sn_32:
    s_cmp_lg_u32 s81, 1
    s_cbranch_scc1 L_sn_36
    s_cmp_lg_u32 s60, 0
    s_cbranch_scc1 L_w0_37
    s_add_u32 s48, s26, 0x2700000
    s_addc_u32 s49, s27, 0
    s_mov_b32 s50, 0x8000
    s_mov_b32 s51, 0x20000
    v_mov_b32 v121, 0
    v_mov_b32 v122, 0
    s_lshl_b32 s71, s77, 7
    s_add_u32 s71, s71, 14336
    v_mov_b32 v121, s71
    s_mov_b32 s71, 16
    v_writelane_b32 v122, s71, 0
    s_lshl_b32 s71, s68, 7
    s_add_u32 s71, s71, 14336
    v_writelane_b32 v121, s71, 1
    s_mov_b32 s71, 16
    v_writelane_b32 v122, s71, 1
    buffer_load_dword v123, v121, s[48:51], 0 offen sc1
L_w0_37:
    s_mov_b32 s81, 2
    s_mov_b32 s67, 2
    s_branch L_sl_31
L_sn_36:
    s_cmp_lg_u32 s81, 2
    s_cbranch_scc1 L_sn_38
    s_cmp_lg_u32 s60, 0
    s_cbranch_scc1 L_w0_39
    s_waitcnt vmcnt(2)
    v_cmp_lt_u32 vcc, v123, v122
    s_nop 0
    s_cmp_eq_u64 vcc, 0
    s_cbranch_scc1 L_apolld_41
    s_add_u32 s48, s26, 0x2700000
    s_addc_u32 s49, s27, 0
    s_mov_b32 s50, 0x8000
    s_mov_b32 s51, 0x20000
    s_mov_b32 s72, 0x40000
L_apoll_40:
    buffer_load_dword v123, v121, s[48:51], 0 offen sc1
    s_waitcnt vmcnt(0)
    v_cmp_lt_u32 vcc, v123, v122
    s_sub_u32 s72, s72, 1
    s_cmp_eq_u32 s72, 0
    s_cbranch_scc1 L_apolld_41
    s_cmp_eq_u64 vcc, 0
    s_cbranch_scc1 L_apolld_41
    s_sleep 4
    s_branch L_apoll_40
L_apolld_41:
L_w0_39:
    s_mov_b32 s81, 3
    s_mov_b32 s67, 4
    s_branch L_sl_31
L_sn_38:
    s_waitcnt lgkmcnt(0)
    s_nop 7
    s_xor_b32 s77, s77, s86
    s_xor_b32 s86, s77, s86
    s_xor_b32 s77, s77, s86
    v_mov_b32 v48, 0x3fb8aa3b
    v_mov_b32 v49, 0x358637bd
    v_mov_b32 v32, 0x3f803f80
    v_mov_b32 v33, 0x3f803f80
    v_mov_b32 v34, 0x3f803f80
    v_mov_b32 v35, 0x3f803f80
    v_mov_b32 v80, 0
    v_mov_b32 v81, 0
    v_mov_b32 v82, 0
    v_mov_b32 v83, 0
    v_mov_b32 v84, 0
    v_mov_b32 v85, 0
    v_mov_b32 v86, 0
    v_mov_b32 v87, 0
    v_mov_b32 v88, 0
    v_mov_b32 v89, 0
    v_mov_b32 v90, 0
    v_mov_b32 v91, 0
    v_mov_b32 v92, 0
    v_mov_b32 v93, 0
    v_mov_b32 v94, 0
    v_mov_b32 v95, 0
    v_mov_b32 v96, 0
    v_mov_b32 v97, 0
    v_mov_b32 v98, 0
    v_mov_b32 v99, 0
    v_mov_b32 v100, 0
    v_mov_b32 v101, 0
    v_mov_b32 v102, 0
    v_mov_b32 v103, 0
    v_pk_mul_f32 v[64:65], v[128:129], v[48:49] op_sel:[0,0] op_sel_hi:[1,0]
    v_pk_mul_f32 v[66:67], v[130:131], v[48:49] op_sel:[0,0] op_sel_hi:[1,0]
    v_pk_mul_f32 v[68:69], v[144:145], v[48:49] op_sel:[0,0] op_sel_hi:[1,0]
    v_pk_mul_f32 v[70:71], v[146:147], v[48:49] op_sel:[0,0] op_sel_hi:[1,0]
    v_pk_mul_f32 v[72:73], v[132:133], v[48:49] op_sel:[0,0] op_sel_hi:[1,0]
    v_pk_mul_f32 v[74:75], v[134:135], v[48:49] op_sel:[0,0] op_sel_hi:[1,0]
    v_pk_mul_f32 v[76:77], v[148:149], v[48:49] op_sel:[0,0] op_sel_hi:[1,0]
    v_pk_mul_f32 v[78:79], v[150:151], v[48:49] op_sel:[0,0] op_sel_hi:[1,0]
    v_exp_f32 v64, v64 clamp
    v_exp_f32 v65, v65 clamp
    v_exp_f32 v66, v66 clamp
    v_exp_f32 v67, v67 clamp
    v_exp_f32 v68, v68 clamp
    v_exp_f32 v69, v69 clamp
    v_exp_f32 v70, v70 clamp
    v_exp_f32 v71, v71 clamp
    v_exp_f32 v72, v72 clamp
    v_exp_f32 v73, v73 clamp
    v_exp_f32 v74, v74 clamp
    v_exp_f32 v75, v75 clamp
    v_exp_f32 v76, v76 clamp
    v_exp_f32 v77, v77 clamp
    v_exp_f32 v78, v78 clamp
    v_exp_f32 v79, v79 clamp
    v_max_f32 v128, 0, v128
    v_max_f32 v129, 0, v129
    v_max_f32 v130, 0, v130
    v_max_f32 v131, 0, v131
    v_max_f32 v144, 0, v144
    v_max_f32 v145, 0, v145
    v_max_f32 v146, 0, v146
    v_max_f32 v147, 0, v147
    v_max_f32 v132, 0, v132
    v_max_f32 v133, 0, v133
    v_max_f32 v134, 0, v134
    v_max_f32 v135, 0, v135
    v_max_f32 v148, 0, v148
    v_max_f32 v149, 0, v149
    v_max_f32 v150, 0, v150
    v_max_f32 v151, 0, v151
    v_pk_add_f32 v[64:65], v[64:65], v[48:49] op_sel:[0,1] op_sel_hi:[1,1]
    v_pk_add_f32 v[66:67], v[66:67], v[48:49] op_sel:[0,1] op_sel_hi:[1,1]
    v_pk_add_f32 v[68:69], v[68:69], v[48:49] op_sel:[0,1] op_sel_hi:[1,1]
    v_pk_add_f32 v[70:71], v[70:71], v[48:49] op_sel:[0,1] op_sel_hi:[1,1]
    v_pk_add_f32 v[72:73], v[72:73], v[48:49] op_sel:[0,1] op_sel_hi:[1,1]
    v_pk_add_f32 v[74:75], v[74:75], v[48:49] op_sel:[0,1] op_sel_hi:[1,1]
    v_pk_add_f32 v[76:77], v[76:77], v[48:49] op_sel:[0,1] op_sel_hi:[1,1]
    v_pk_add_f32 v[78:79], v[78:79], v[48:49] op_sel:[0,1] op_sel_hi:[1,1]
    v_pk_add_f32 v[128:129], v[128:129], v[64:65]
    v_pk_add_f32 v[130:131], v[130:131], v[66:67]
    v_pk_add_f32 v[144:145], v[144:145], v[68:69]
    v_pk_add_f32 v[146:147], v[146:147], v[70:71]
    v_pk_add_f32 v[132:133], v[132:133], v[72:73]
    v_pk_add_f32 v[134:135], v[134:135], v[74:75]
    v_pk_add_f32 v[148:149], v[148:149], v[76:77]
    v_pk_add_f32 v[150:151], v[150:151], v[78:79]
    v_cvt_pk_bf16_f32 v16, v128, v129
    v_cvt_pk_bf16_f32 v17, v130, v131
    v_cvt_pk_bf16_f32 v18, v144, v145
    v_cvt_pk_bf16_f32 v19, v146, v147
    v_cvt_pk_bf16_f32 v20, v132, v133
    v_cvt_pk_bf16_f32 v21, v134, v135
    v_cvt_pk_bf16_f32 v22, v148, v149
    v_cvt_pk_bf16_f32 v23, v150, v151
    v_cvt_pk_bf16_f32 v24, v136, v137
    v_cvt_pk_bf16_f32 v25, v138, v139
    v_cvt_pk_bf16_f32 v26, v152, v153
    v_cvt_pk_bf16_f32 v27, v154, v155
    v_cvt_pk_bf16_f32 v28, v140, v141
    v_cvt_pk_bf16_f32 v29, v142, v143
    v_cvt_pk_bf16_f32 v30, v156, v157
    v_cvt_pk_bf16_f32 v31, v158, v159
    s_nop 1
    v_mfma_f32_16x16x32_bf16 v[80:83], v[16:19], v[24:27], v[80:83]
    v_mfma_f32_16x16x32_bf16 v[84:87], v[16:19], v[28:31], v[84:87]
    v_mfma_f32_16x16x32_bf16 v[96:99], v[16:19], v[32:35], v[96:99]
    v_mfma_f32_16x16x32_bf16 v[88:91], v[20:23], v[24:27], v[88:91]
    v_mfma_f32_16x16x32_bf16 v[92:95], v[20:23], v[28:31], v[92:95]
    v_mfma_f32_16x16x32_bf16 v[100:103], v[20:23], v[32:35], v[100:103]
    v_pk_mul_f32 v[64:65], v[160:161], v[48:49] op_sel:[0,0] op_sel_hi:[1,0]
    v_pk_mul_f32 v[66:67], v[162:163], v[48:49] op_sel:[0,0] op_sel_hi:[1,0]
    v_pk_mul_f32 v[68:69], v[176:177], v[48:49] op_sel:[0,0] op_sel_hi:[1,0]
    v_pk_mul_f32 v[70:71], v[178:179], v[48:49] op_sel:[0,0] op_sel_hi:[1,0]
    v_pk_mul_f32 v[72:73], v[164:165], v[48:49] op_sel:[0,0] op_sel_hi:[1,0]
    v_pk_mul_f32 v[74:75], v[166:167], v[48:49] op_sel:[0,0] op_sel_hi:[1,0]
    v_pk_mul_f32 v[76:77], v[180:181], v[48:49] op_sel:[0,0] op_sel_hi:[1,0]
    v_pk_mul_f32 v[78:79], v[182:183], v[48:49] op_sel:[0,0] op_sel_hi:[1,0]
    v_exp_f32 v64, v64 clamp
    v_exp_f32 v65, v65 clamp
    v_exp_f32 v66, v66 clamp
    v_exp_f32 v67, v67 clamp
    v_exp_f32 v68, v68 clamp
    v_exp_f32 v69, v69 clamp
    v_exp_f32 v70, v70 clamp
    v_exp_f32 v71, v71 clamp
    v_exp_f32 v72, v72 clamp
    v_exp_f32 v73, v73 clamp
    v_exp_f32 v74, v74 clamp
    v_exp_f32 v75, v75 clamp
    v_exp_f32 v76, v76 clamp
    v_exp_f32 v77, v77 clamp
    v_exp_f32 v78, v78 clamp
    v_exp_f32 v79, v79 clamp
    v_max_f32 v160, 0, v160
    v_max_f32 v161, 0, v161
    v_max_f32 v162, 0, v162
    v_max_f32 v163, 0, v163
    v_max_f32 v176, 0, v176
    v_max_f32 v177, 0, v177
    v_max_f32 v178, 0, v178
    v_max_f32 v179, 0, v179
    v_max_f32 v164, 0, v164
    v_max_f32 v165, 0, v165
    v_max_f32 v166, 0, v166
    v_max_f32 v167, 0, v167
    v_max_f32 v180, 0, v180
    v_max_f32 v181, 0, v181
    v_max_f32 v182, 0, v182
    v_max_f32 v183, 0, v183
    v_pk_add_f32 v[64:65], v[64:65], v[48:49] op_sel:[0,1] op_sel_hi:[1,1]
    v_pk_add_f32 v[66:67], v[66:67], v[48:49] op_sel:[0,1] op_sel_hi:[1,1]
    v_pk_add_f32 v[68:69], v[68:69], v[48:49] op_sel:[0,1] op_sel_hi:[1,1]
    v_pk_add_f32 v[70:71], v[70:71], v[48:49] op_sel:[0,1] op_sel_hi:[1,1]
    v_pk_add_f32 v[72:73], v[72:73], v[48:49] op_sel:[0,1] op_sel_hi:[1,1]
    v_pk_add_f32 v[74:75], v[74:75], v[48:49] op_sel:[0,1] op_sel_hi:[1,1]
    v_pk_add_f32 v[76:77], v[76:77], v[48:49] op_sel:[0,1] op_sel_hi:[1,1]
    v_pk_add_f32 v[78:79], v[78:79], v[48:49] op_sel:[0,1] op_sel_hi:[1,1]
    v_pk_add_f32 v[160:161], v[160:161], v[64:65]
    v_pk_add_f32 v[162:163], v[162:163], v[66:67]
    v_pk_add_f32 v[176:177], v[176:177], v[68:69]
    v_pk_add_f32 v[178:179], v[178:179], v[70:71]
    v_pk_add_f32 v[164:165], v[164:165], v[72:73]
    v_pk_add_f32 v[166:167], v[166:167], v[74:75]
    v_pk_add_f32 v[180:181], v[180:181], v[76:77]
    v_pk_add_f32 v[182:183], v[182:183], v[78:79]
    v_cvt_pk_bf16_f32 v16, v160, v161
    v_cvt_pk_bf16_f32 v17, v162, v163
    v_cvt_pk_bf16_f32 v18, v176, v177
    v_cvt_pk_bf16_f32 v19, v178, v179
    v_cvt_pk_bf16_f32 v20, v164, v165
    v_cvt_pk_bf16_f32 v21, v166, v167
    v_cvt_pk_bf16_f32 v22, v180, v181
    v_cvt_pk_bf16_f32 v23, v182, v183
    v_cvt_pk_bf16_f32 v24, v168, v169
    v_cvt_pk_bf16_f32 v25, v170, v171
    v_cvt_pk_bf16_f32 v26, v184, v185
    v_cvt_pk_bf16_f32 v27, v186, v187
    v_cvt_pk_bf16_f32 v28, v172, v173
    v_cvt_pk_bf16_f32 v29, v174, v175
    v_cvt_pk_bf16_f32 v30, v188, v189
    v_cvt_pk_bf16_f32 v31, v190, v191
    s_nop 1
    v_mfma_f32_16x16x32_bf16 v[80:83], v[16:19], v[24:27], v[80:83]
    v_mfma_f32_16x16x32_bf16 v[84:87], v[16:19], v[28:31], v[84:87]
    v_mfma_f32_16x16x32_bf16 v[96:99], v[16:19], v[32:35], v[96:99]
    v_mfma_f32_16x16x32_bf16 v[88:91], v[20:23], v[24:27], v[88:91]
    v_mfma_f32_16x16x32_bf16 v[92:95], v[20:23], v[28:31], v[92:95]
    v_mfma_f32_16x16x32_bf16 v[100:103], v[20:23], v[32:35], v[100:103]
    v_pk_mul_f32 v[64:65], v[192:193], v[48:49] op_sel:[0,0] op_sel_hi:[1,0]
    v_pk_mul_f32 v[66:67], v[194:195], v[48:49] op_sel:[0,0] op_sel_hi:[1,0]
    v_pk_mul_f32 v[68:69], v[208:209], v[48:49] op_sel:[0,0] op_sel_hi:[1,0]
    v_pk_mul_f32 v[70:71], v[210:211], v[48:49] op_sel:[0,0] op_sel_hi:[1,0]
    v_pk_mul_f32 v[72:73], v[196:197], v[48:49] op_sel:[0,0] op_sel_hi:[1,0]
    v_pk_mul_f32 v[74:75], v[198:199], v[48:49] op_sel:[0,0] op_sel_hi:[1,0]
    v_pk_mul_f32 v[76:77], v[212:213], v[48:49] op_sel:[0,0] op_sel_hi:[1,0]
    v_pk_mul_f32 v[78:79], v[214:215], v[48:49] op_sel:[0,0] op_sel_hi:[1,0]
    v_exp_f32 v64, v64 clamp
    v_exp_f32 v65, v65 clamp
    v_exp_f32 v66, v66 clamp
    v_exp_f32 v67, v67 clamp
    v_exp_f32 v68, v68 clamp
    v_exp_f32 v69, v69 clamp
    v_exp_f32 v70, v70 clamp
    v_exp_f32 v71, v71 clamp
    v_exp_f32 v72, v72 clamp
    v_exp_f32 v73, v73 clamp
    v_exp_f32 v74, v74 clamp
    v_exp_f32 v75, v75 clamp
    v_exp_f32 v76, v76 clamp
    v_exp_f32 v77, v77 clamp
    v_exp_f32 v78, v78 clamp
    v_exp_f32 v79, v79 clamp
    v_max_f32 v192, 0, v192
    v_max_f32 v193, 0, v193
    v_max_f32 v194, 0, v194
    v_max_f32 v195, 0, v195
    v_max_f32 v208, 0, v208
    v_max_f32 v209, 0, v209
    v_max_f32 v210, 0, v210
    v_max_f32 v211, 0, v211
    v_max_f32 v196, 0, v196
    v_max_f32 v197, 0, v197
    v_max_f32 v198, 0, v198
    v_max_f32 v199, 0, v199
    v_max_f32 v212, 0, v212
    v_max_f32 v213, 0, v213
    v_max_f32 v214, 0, v214
    v_max_f32 v215, 0, v215
    v_pk_add_f32 v[64:65], v[64:65], v[48:49] op_sel:[0,1] op_sel_hi:[1,1]
    v_pk_add_f32 v[66:67], v[66:67], v[48:49] op_sel:[0,1] op_sel_hi:[1,1]
    v_pk_add_f32 v[68:69], v[68:69], v[48:49] op_sel:[0,1] op_sel_hi:[1,1]
    v_pk_add_f32 v[70:71], v[70:71], v[48:49] op_sel:[0,1] op_sel_hi:[1,1]
    v_pk_add_f32 v[72:73], v[72:73], v[48:49] op_sel:[0,1] op_sel_hi:[1,1]
    v_pk_add_f32 v[74:75], v[74:75], v[48:49] op_sel:[0,1] op_sel_hi:[1,1]
    v_pk_add_f32 v[76:77], v[76:77], v[48:49] op_sel:[0,1] op_sel_hi:[1,1]
    v_pk_add_f32 v[78:79], v[78:79], v[48:49] op_sel:[0,1] op_sel_hi:[1,1]
    v_pk_add_f32 v[192:193], v[192:193], v[64:65]
    v_pk_add_f32 v[194:195], v[194:195], v[66:67]
    v_pk_add_f32 v[208:209], v[208:209], v[68:69]
    v_pk_add_f32 v[210:211], v[210:211], v[70:71]
    v_pk_add_f32 v[196:197], v[196:197], v[72:73]
    v_pk_add_f32 v[198:199], v[198:199], v[74:75]
    v_pk_add_f32 v[212:213], v[212:213], v[76:77]
    v_pk_add_f32 v[214:215], v[214:215], v[78:79]
    v_cvt_pk_bf16_f32 v16, v192, v193
    v_cvt_pk_bf16_f32 v17, v194, v195
    v_cvt_pk_bf16_f32 v18, v208, v209
    v_cvt_pk_bf16_f32 v19, v210, v211
    v_cvt_pk_bf16_f32 v20, v196, v197
    v_cvt_pk_bf16_f32 v21, v198, v199
    v_cvt_pk_bf16_f32 v22, v212, v213
    v_cvt_pk_bf16_f32 v23, v214, v215
    v_cvt_pk_bf16_f32 v24, v200, v201
    v_cvt_pk_bf16_f32 v25, v202, v203
    v_cvt_pk_bf16_f32 v26, v216, v217
    v_cvt_pk_bf16_f32 v27, v218, v219
    v_cvt_pk_bf16_f32 v28, v204, v205
    v_cvt_pk_bf16_f32 v29, v206, v207
    v_cvt_pk_bf16_f32 v30, v220, v221
    v_cvt_pk_bf16_f32 v31, v222, v223
    s_nop 1
    v_mfma_f32_16x16x32_bf16 v[80:83], v[16:19], v[24:27], v[80:83]
    v_mfma_f32_16x16x32_bf16 v[84:87], v[16:19], v[28:31], v[84:87]
    v_mfma_f32_16x16x32_bf16 v[96:99], v[16:19], v[32:35], v[96:99]
    v_mfma_f32_16x16x32_bf16 v[88:91], v[20:23], v[24:27], v[88:91]
    v_mfma_f32_16x16x32_bf16 v[92:95], v[20:23], v[28:31], v[92:95]
    v_mfma_f32_16x16x32_bf16 v[100:103], v[20:23], v[32:35], v[100:103]
    v_pk_mul_f32 v[64:65], v[224:225], v[48:49] op_sel:[0,0] op_sel_hi:[1,0]
    v_pk_mul_f32 v[66:67], v[226:227], v[48:49] op_sel:[0,0] op_sel_hi:[1,0]
    v_pk_mul_f32 v[68:69], v[240:241], v[48:49] op_sel:[0,0] op_sel_hi:[1,0]
    v_pk_mul_f32 v[70:71], v[242:243], v[48:49] op_sel:[0,0] op_sel_hi:[1,0]
    v_pk_mul_f32 v[72:73], v[228:229], v[48:49] op_sel:[0,0] op_sel_hi:[1,0]
    v_pk_mul_f32 v[74:75], v[230:231], v[48:49] op_sel:[0,0] op_sel_hi:[1,0]
    v_pk_mul_f32 v[76:77], v[244:245], v[48:49] op_sel:[0,0] op_sel_hi:[1,0]
    v_pk_mul_f32 v[78:79], v[246:247], v[48:49] op_sel:[0,0] op_sel_hi:[1,0]
    v_exp_f32 v64, v64 clamp
    v_exp_f32 v65, v65 clamp
    v_exp_f32 v66, v66 clamp
    v_exp_f32 v67, v67 clamp
    v_exp_f32 v68, v68 clamp
    v_exp_f32 v69, v69 clamp
    v_exp_f32 v70, v70 clamp
    v_exp_f32 v71, v71 clamp
    v_exp_f32 v72, v72 clamp
    v_exp_f32 v73, v73 clamp
    v_exp_f32 v74, v74 clamp
    v_exp_f32 v75, v75 clamp
    v_exp_f32 v76, v76 clamp
    v_exp_f32 v77, v77 clamp
    v_exp_f32 v78, v78 clamp
    v_exp_f32 v79, v79 clamp
    v_max_f32 v224, 0, v224
    v_max_f32 v225, 0, v225
    v_max_f32 v226, 0, v226
    v_max_f32 v227, 0, v227
    v_max_f32 v240, 0, v240
    v_max_f32 v241, 0, v241
    v_max_f32 v242, 0, v242
    v_max_f32 v243, 0, v243
    v_max_f32 v228, 0, v228
    v_max_f32 v229, 0, v229
    v_max_f32 v230, 0, v230
    v_max_f32 v231, 0, v231
    v_max_f32 v244, 0, v244
    v_max_f32 v245, 0, v245
    v_max_f32 v246, 0, v246
    v_max_f32 v247, 0, v247
    v_pk_add_f32 v[64:65], v[64:65], v[48:49] op_sel:[0,1] op_sel_hi:[1,1]
    v_pk_add_f32 v[66:67], v[66:67], v[48:49] op_sel:[0,1] op_sel_hi:[1,1]
    v_pk_add_f32 v[68:69], v[68:69], v[48:49] op_sel:[0,1] op_sel_hi:[1,1]
    v_pk_add_f32 v[70:71], v[70:71], v[48:49] op_sel:[0,1] op_sel_hi:[1,1]
    v_pk_add_f32 v[72:73], v[72:73], v[48:49] op_sel:[0,1] op_sel_hi:[1,1]
    v_pk_add_f32 v[74:75], v[74:75], v[48:49] op_sel:[0,1] op_sel_hi:[1,1]
    v_pk_add_f32 v[76:77], v[76:77], v[48:49] op_sel:[0,1] op_sel_hi:[1,1]
    v_pk_add_f32 v[78:79], v[78:79], v[48:49] op_sel:[0,1] op_sel_hi:[1,1]
    v_pk_add_f32 v[224:225], v[224:225], v[64:65]
    v_pk_add_f32 v[226:227], v[226:227], v[66:67]
    v_pk_add_f32 v[240:241], v[240:241], v[68:69]
    v_pk_add_f32 v[242:243], v[242:243], v[70:71]
    v_pk_add_f32 v[228:229], v[228:229], v[72:73]
    v_pk_add_f32 v[230:231], v[230:231], v[74:75]
    v_pk_add_f32 v[244:245], v[244:245], v[76:77]
    v_pk_add_f32 v[246:247], v[246:247], v[78:79]
    v_cvt_pk_bf16_f32 v16, v224, v225
    v_cvt_pk_bf16_f32 v17, v226, v227
    v_cvt_pk_bf16_f32 v18, v240, v241
    v_cvt_pk_bf16_f32 v19, v242, v243
    v_cvt_pk_bf16_f32 v20, v228, v229
    v_cvt_pk_bf16_f32 v21, v230, v231
    v_cvt_pk_bf16_f32 v22, v244, v245
    v_cvt_pk_bf16_f32 v23, v246, v247
    v_cvt_pk_bf16_f32 v24, v232, v233
    v_cvt_pk_bf16_f32 v25, v234, v235
    v_cvt_pk_bf16_f32 v26, v248, v249
    v_cvt_pk_bf16_f32 v27, v250, v251
    v_cvt_pk_bf16_f32 v28, v236, v237
    v_cvt_pk_bf16_f32 v29, v238, v239
    v_cvt_pk_bf16_f32 v30, v252, v253
    v_cvt_pk_bf16_f32 v31, v254, v255
    s_nop 1
    v_mfma_f32_16x16x32_bf16 v[80:83], v[16:19], v[24:27], v[80:83]
    v_mfma_f32_16x16x32_bf16 v[84:87], v[16:19], v[28:31], v[84:87]
    v_mfma_f32_16x16x32_bf16 v[96:99], v[16:19], v[32:35], v[96:99]
    v_mfma_f32_16x16x32_bf16 v[88:91], v[20:23], v[24:27], v[88:91]
    v_mfma_f32_16x16x32_bf16 v[92:95], v[20:23], v[28:31], v[92:95]
    v_mfma_f32_16x16x32_bf16 v[100:103], v[20:23], v[32:35], v[100:103]
    s_sub_u32 s71, s78, 4
    s_lshl_b32 s71, s71, 2
    s_add_u32 s71, s71, s60
    s_lshl_b32 s72, s77, 5
    s_add_u32 s71, s71, s72
    s_lshl_b32 s72, s71, 12
    s_lshl_b32 s73, s71, 7
    v_and_b32 v2, 15, v1
    v_lshrrev_b32 v3, 4, v1
    v_lshlrev_b32 v4, 9, v3
    v_lshl_add_u32 v4, v2, 4, v4
    v_add_u32 v4, s72, v4
    v_lshlrev_b32 v5, 4, v3
    v_add_u32 v5, s73, v5
    v_cmp_eq_u32 vcc, 0, v2
    s_nop 15
    buffer_store_dwordx4 v[80:83], v4, s[40:43], 0 offen offset:0 sc1
    buffer_store_dwordx4 v[84:87], v4, s[40:43], 0 offen offset:256 sc1
    buffer_store_dwordx4 v[88:91], v4, s[40:43], 0 offen offset:2048 sc1
    buffer_store_dwordx4 v[92:95], v4, s[40:43], 0 offen offset:2304 sc1
    s_and_saveexec_b64 s[82:83], vcc
    buffer_store_dwordx4 v[96:99], v5, s[52:55], 0 offen offset:0 sc1
    buffer_store_dwordx4 v[100:103], v5, s[52:55], 0 offen offset:64 sc1
    s_mov_b64 exec, s[82:83]
    s_xor_b32 s77, s77, s86
    s_xor_b32 s86, s77, s86
    s_xor_b32 s77, s77, s86
    s_lshl_b32 s62, s63, 7
    s_mov_b32 s36, s26
    s_mov_b32 s37, s27
    s_mov_b32 s38, 0x400000
    s_mov_b32 s39, 0x20000
    v_and_b32 v2, 15, v1
    s_lshr_b32 s71, s60, 1
    s_lshl_b32 s71, s71, 6
    v_add_u32 v2, s71, v2
    v_lshlrev_b32 v2, 7, v2
    v_bfe_u32 v3, v1, 1, 3
    v_lshrrev_b32 v16, 4, v1
    v_xor_b32 v3, v3, v16
    v_xor_b32 v17, 0, v3
    v_lshl_add_u32 v8, v17, 4, v2
    v_mov_b32 v4, v8
    v_xor_b32 v17, 4, v3
    v_lshl_add_u32 v9, v17, 4, v2
    v_mov_b32 v5, v9
    v_bfe_u32 v2, v1, 2, 2
    v_lshl_add_u32 v18, v16, 3, v2
    v_and_b32 v3, 1, v1
    v_lshlrev_b32 v3, 3, v3
    v_lshl_add_u32 v3, v18, 8, v3
    v_bfe_u32 v17, v1, 1, 1
    s_and_b32 s71, s60, 1
    s_lshl_b32 s71, s71, 3
    v_add_u32 v17, s71, v17
    v_lshlrev_b32 v2, 2, v2
    v_xor_b32 v17, v17, v2
    v_and_b32 v2, 1, v16
    v_lshlrev_b32 v2, 1, v2
    v_xor_b32 v17, v17, v2
    v_xor_b32 v19, 0, v17
    v_lshl_add_u32 v19, v19, 4, v3
    v_add_u32 v10, 16384, v19
    v_mov_b32 v6, v10
    v_xor_b32 v19, 2, v17
    v_lshl_add_u32 v19, v19, 4, v3
    v_add_u32 v11, 16384, v19
    v_mov_b32 v7, v11
    v_xor_b32 v19, 4, v17
    v_lshl_add_u32 v19, v19, 4, v3
    v_add_u32 v14, 16384, v19
    v_mov_b32 v12, v14
    v_xor_b32 v19, 6, v17
    v_lshl_add_u32 v19, v19, 4, v3
    v_add_u32 v15, 16384, v19
    v_mov_b32 v13, v15
    s_mov_b32 s70, 0
    s_barrier
    ds_read_b64_tr_b16 v[32:33], v6 offset:0
    ds_read_b64_tr_b16 v[34:35], v6 offset:1024
    ds_read_b128 v[16:19], v4 offset:0
    ds_read_b64_tr_b16 v[36:37], v7 offset:0
    ds_read_b64_tr_b16 v[38:39], v7 offset:1024
    ds_read_b128 v[20:23], v4 offset:2048
    ds_read_b64_tr_b16 v[40:41], v12 offset:0
    ds_read_b64_tr_b16 v[42:43], v12 offset:1024
    ds_read_b128 v[24:27], v4 offset:4096
    ds_read_b64_tr_b16 v[44:45], v13 offset:0
    ds_read_b64_tr_b16 v[46:47], v13 offset:1024
    ds_read_b128 v[28:31], v4 offset:6144
    s_waitcnt lgkmcnt(0)
    v_mfma_f32_16x16x32_bf16 v[128:131], v[32:35], v[16:19], 0
    ds_read_b64_tr_b16 v[64:65], v6 offset:8192
    ds_read_b64_tr_b16 v[66:67], v6 offset:9216
    v_mfma_f32_16x16x32_bf16 v[144:147], v[32:35], v[20:23], 0
    ds_read_b128 v[48:51], v5 offset:0
    ds_read_b64_tr_b16 v[68:69], v7 offset:8192
    v_mfma_f32_16x16x32_bf16 v[160:163], v[32:35], v[24:27], 0
    ds_read_b64_tr_b16 v[70:71], v7 offset:9216
    ds_read_b128 v[52:55], v5 offset:2048
    v_mfma_f32_16x16x32_bf16 v[176:179], v[32:35], v[28:31], 0
    ds_read_b64_tr_b16 v[72:73], v12 offset:8192
    ds_read_b64_tr_b16 v[74:75], v12 offset:9216
    v_mfma_f32_16x16x32_bf16 v[180:183], v[36:39], v[28:31], 0
    ds_read_b128 v[56:59], v5 offset:4096
    ds_read_b64_tr_b16 v[76:77], v13 offset:8192
    v_mfma_f32_16x16x32_bf16 v[164:167], v[36:39], v[24:27], 0
    ds_read_b64_tr_b16 v[78:79], v13 offset:9216
    ds_read_b128 v[60:63], v5 offset:6144
    v_mfma_f32_16x16x32_bf16 v[148:151], v[36:39], v[20:23], 0
    s_add_u32 s70, s70, 32768
    s_cmp_eq_u32 s70, 131072
    v_mfma_f32_16x16x32_bf16 v[132:135], v[36:39], v[16:19], 0
    s_cselect_b32 s70, 0, s70
    v_add_u32 v4, s70, v8
    v_mfma_f32_16x16x32_bf16 v[136:139], v[40:43], v[16:19], 0
    v_add_u32 v5, s70, v9
    v_add_u32 v6, s70, v10
    v_mfma_f32_16x16x32_bf16 v[152:155], v[40:43], v[20:23], 0
    v_add_u32 v7, s70, v11
    v_add_u32 v12, s70, v14
    v_mfma_f32_16x16x32_bf16 v[168:171], v[40:43], v[24:27], 0
    v_add_u32 v13, s70, v15
    v_mfma_f32_16x16x32_bf16 v[184:187], v[40:43], v[28:31], 0
    v_mfma_f32_16x16x32_bf16 v[188:191], v[44:47], v[28:31], 0
    v_mfma_f32_16x16x32_bf16 v[172:175], v[44:47], v[24:27], 0
    v_mfma_f32_16x16x32_bf16 v[156:159], v[44:47], v[20:23], 0
    v_mfma_f32_16x16x32_bf16 v[140:143], v[44:47], v[16:19], 0
    s_waitcnt lgkmcnt(0)
    v_mfma_f32_16x16x32_bf16 v[128:131], v[64:67], v[48:51], v[128:131]
    s_barrier
    v_mfma_f32_16x16x32_bf16 v[144:147], v[64:67], v[52:55], v[144:147]
    ds_read_b64_tr_b16 v[32:33], v6 offset:0
    ds_read_b64_tr_b16 v[34:35], v6 offset:1024
    v_mfma_f32_16x16x32_bf16 v[160:163], v[64:67], v[56:59], v[160:163]
    ds_read_b128 v[16:19], v4 offset:0
    ds_read_b64_tr_b16 v[36:37], v7 offset:0
    v_mfma_f32_16x16x32_bf16 v[176:179], v[64:67], v[60:63], v[176:179]
    ds_read_b64_tr_b16 v[38:39], v7 offset:1024
    ds_read_b128 v[20:23], v4 offset:2048
    v_mfma_f32_16x16x32_bf16 v[180:183], v[68:71], v[60:63], v[180:183]
    ds_read_b64_tr_b16 v[40:41], v12 offset:0
    ds_read_b64_tr_b16 v[42:43], v12 offset:1024
    v_mfma_f32_16x16x32_bf16 v[164:167], v[68:71], v[56:59], v[164:167]
    ds_read_b128 v[24:27], v4 offset:4096
    ds_read_b64_tr_b16 v[44:45], v13 offset:0
    v_mfma_f32_16x16x32_bf16 v[148:151], v[68:71], v[52:55], v[148:151]
    ds_read_b64_tr_b16 v[46:47], v13 offset:1024
    ds_read_b128 v[28:31], v4 offset:6144
    v_mfma_f32_16x16x32_bf16 v[132:135], v[68:71], v[48:51], v[132:135]
    v_mfma_f32_16x16x32_bf16 v[136:139], v[72:75], v[48:51], v[136:139]
    v_mfma_f32_16x16x32_bf16 v[152:155], v[72:75], v[52:55], v[152:155]
    v_mfma_f32_16x16x32_bf16 v[168:171], v[72:75], v[56:59], v[168:171]
    v_mfma_f32_16x16x32_bf16 v[184:187], v[72:75], v[60:63], v[184:187]
    v_mfma_f32_16x16x32_bf16 v[188:191], v[76:79], v[60:63], v[188:191]
    v_mfma_f32_16x16x32_bf16 v[172:175], v[76:79], v[56:59], v[172:175]
    v_mfma_f32_16x16x32_bf16 v[156:159], v[76:79], v[52:55], v[156:159]
    v_mfma_f32_16x16x32_bf16 v[140:143], v[76:79], v[48:51], v[140:143]
    s_waitcnt vmcnt(0)
    s_mov_b32 s81, 0
    s_mov_b32 s67, 1
L_sl_42:
    s_waitcnt lgkmcnt(0)
    v_mfma_f32_16x16x32_bf16 v[128:131], v[32:35], v[16:19], v[128:131]
    ds_read_b64_tr_b16 v[64:65], v6 offset:8192
    ds_read_b64_tr_b16 v[66:67], v6 offset:9216
    v_mfma_f32_16x16x32_bf16 v[144:147], v[32:35], v[20:23], v[144:147]
    ds_read_b128 v[48:51], v5 offset:0
    ds_read_b64_tr_b16 v[68:69], v7 offset:8192
    v_mfma_f32_16x16x32_bf16 v[160:163], v[32:35], v[24:27], v[160:163]
    ds_read_b64_tr_b16 v[70:71], v7 offset:9216
    ds_read_b128 v[52:55], v5 offset:2048
    v_mfma_f32_16x16x32_bf16 v[176:179], v[32:35], v[28:31], v[176:179]
    ds_read_b64_tr_b16 v[72:73], v12 offset:8192
    ds_read_b64_tr_b16 v[74:75], v12 offset:9216
    v_mfma_f32_16x16x32_bf16 v[180:183], v[36:39], v[28:31], v[180:183]
    ds_read_b128 v[56:59], v5 offset:4096
    ds_read_b64_tr_b16 v[76:77], v13 offset:8192
    v_mfma_f32_16x16x32_bf16 v[164:167], v[36:39], v[24:27], v[164:167]
    ds_read_b64_tr_b16 v[78:79], v13 offset:9216
    ds_read_b128 v[60:63], v5 offset:6144
    v_mfma_f32_16x16x32_bf16 v[148:151], v[36:39], v[20:23], v[148:151]
    s_add_u32 s70, s70, 32768
    s_cmp_eq_u32 s70, 131072
    v_mfma_f32_16x16x32_bf16 v[132:135], v[36:39], v[16:19], v[132:135]
    s_cselect_b32 s70, 0, s70
    v_add_u32 v4, s70, v8
    v_mfma_f32_16x16x32_bf16 v[136:139], v[40:43], v[16:19], v[136:139]
    v_add_u32 v5, s70, v9
    v_add_u32 v6, s70, v10
    v_mfma_f32_16x16x32_bf16 v[152:155], v[40:43], v[20:23], v[152:155]
    v_add_u32 v7, s70, v11
    v_add_u32 v12, s70, v14
    v_mfma_f32_16x16x32_bf16 v[168:171], v[40:43], v[24:27], v[168:171]
    v_add_u32 v13, s70, v15
    v_mfma_f32_16x16x32_bf16 v[184:187], v[40:43], v[28:31], v[184:187]
    v_mfma_f32_16x16x32_bf16 v[188:191], v[44:47], v[28:31], v[188:191]
    v_mfma_f32_16x16x32_bf16 v[172:175], v[44:47], v[24:27], v[172:175]
    v_mfma_f32_16x16x32_bf16 v[156:159], v[44:47], v[20:23], v[156:159]
    v_mfma_f32_16x16x32_bf16 v[140:143], v[44:47], v[16:19], v[140:143]
    s_waitcnt lgkmcnt(0)
    v_mfma_f32_16x16x32_bf16 v[128:131], v[64:67], v[48:51], v[128:131]
    s_barrier
    v_mfma_f32_16x16x32_bf16 v[144:147], v[64:67], v[52:55], v[144:147]
    ds_read_b64_tr_b16 v[32:33], v6 offset:0
    ds_read_b64_tr_b16 v[34:35], v6 offset:1024
    v_mfma_f32_16x16x32_bf16 v[160:163], v[64:67], v[56:59], v[160:163]
    ds_read_b128 v[16:19], v4 offset:0
    ds_read_b64_tr_b16 v[36:37], v7 offset:0
    v_mfma_f32_16x16x32_bf16 v[176:179], v[64:67], v[60:63], v[176:179]
    ds_read_b64_tr_b16 v[38:39], v7 offset:1024
    ds_read_b128 v[20:23], v4 offset:2048
    v_mfma_f32_16x16x32_bf16 v[180:183], v[68:71], v[60:63], v[180:183]
    ds_read_b64_tr_b16 v[40:41], v12 offset:0
    ds_read_b64_tr_b16 v[42:43], v12 offset:1024
    v_mfma_f32_16x16x32_bf16 v[164:167], v[68:71], v[56:59], v[164:167]
    ds_read_b128 v[24:27], v4 offset:4096
    ds_read_b64_tr_b16 v[44:45], v13 offset:0
    v_mfma_f32_16x16x32_bf16 v[148:151], v[68:71], v[52:55], v[148:151]
    ds_read_b64_tr_b16 v[46:47], v13 offset:1024
    ds_read_b128 v[28:31], v4 offset:6144
    v_mfma_f32_16x16x32_bf16 v[132:135], v[68:71], v[48:51], v[132:135]
    v_mfma_f32_16x16x32_bf16 v[136:139], v[72:75], v[48:51], v[136:139]
    v_mfma_f32_16x16x32_bf16 v[152:155], v[72:75], v[52:55], v[152:155]
    v_mfma_f32_16x16x32_bf16 v[168:171], v[72:75], v[56:59], v[168:171]
    v_mfma_f32_16x16x32_bf16 v[184:187], v[72:75], v[60:63], v[184:187]
    v_mfma_f32_16x16x32_bf16 v[188:191], v[76:79], v[60:63], v[188:191]
    v_mfma_f32_16x16x32_bf16 v[172:175], v[76:79], v[56:59], v[172:175]
    v_mfma_f32_16x16x32_bf16 v[156:159], v[76:79], v[52:55], v[156:159]
    v_mfma_f32_16x16x32_bf16 v[140:143], v[76:79], v[48:51], v[140:143]
    s_sub_u32 s67, s67, 1
    s_cmp_lg_u32 s67, 0
    s_cbranch_scc1 L_sl_42
    s_cmp_lg_u32 s81, 0
    s_cbranch_scc1 L_sn_43
    s_cmp_lg_u32 s60, 0
    s_cbranch_scc1 L_w0_44
    s_add_u32 s48, s26, 0x2700000
    s_addc_u32 s49, s27, 0
    s_mov_b32 s50, 0x8000
    s_mov_b32 s51, 0x20000
    v_mov_b32 v2, 20608
    v_mov_b32 v3, 1
    s_mov_b64 exec, 1
    buffer_atomic_add v3, v2, s[48:51], 0 offen sc1
    s_mov_b64 exec, -1
L_w0_44:
    s_mov_b32 s81, 1
    s_cmp_ge_u32 s80, 24
    s_cselect_b32 s67, 3, 14
    s_cselect_b32 s81, 1, 6
    s_branch L_sl_42
L_sn_43:
    s_cmp_lg_u32 s81, 1
    s_cbranch_scc1 L_sn_45
    s_cmp_lt_u32 s80, 24
    s_cbranch_scc1 L_cnd_46
    s_cmp_lg_u32 s60, 0
    s_cbranch_scc1 L_w0_47
    s_add_u32 s48, s26, 0x2700000
    s_addc_u32 s49, s27, 0
    s_mov_b32 s50, 0x8000
    s_mov_b32 s51, 0x20000
    v_mov_b32 v121, 20608
    v_mov_b32 v122, 0
    s_mov_b32 s71, 20608
    v_mov_b32 v121, s71
    s_mov_b32 s71, 128
    v_writelane_b32 v122, s71, 0
    buffer_load_dword v123, v121, s[48:51], 0 offen sc1
L_w0_47:
L_cnd_46:
    s_mov_b32 s81, 2
    s_mov_b32 s67, 2
    s_branch L_sl_42
L_sn_45:
    s_cmp_lg_u32 s81, 2
    s_cbranch_scc1 L_sn_48
    s_cmp_lt_u32 s80, 24
    s_cbranch_scc1 L_cnd_49
    s_cmp_lg_u32 s60, 0
    s_cbranch_scc1 L_w0_50
    s_waitcnt vmcnt(0)
    v_cmp_lt_u32 vcc, v123, v122
    s_nop 0
    s_cmp_eq_u64 vcc, 0
    s_cbranch_scc1 L_apolld_52
    s_add_u32 s48, s26, 0x2700000
    s_addc_u32 s49, s27, 0
    s_mov_b32 s50, 0x8000
    s_mov_b32 s51, 0x20000
    s_mov_b32 s72, 0x40000
L_apoll_51:
    buffer_load_dword v123, v121, s[48:51], 0 offen sc1
    s_waitcnt vmcnt(0)
    v_cmp_lt_u32 vcc, v123, v122
    s_sub_u32 s72, s72, 1
    s_cmp_eq_u32 s72, 0
    s_cbranch_scc1 L_apolld_52
    s_cmp_eq_u64 vcc, 0
    s_cbranch_scc1 L_apolld_52
    s_sleep 4
    s_branch L_apoll_51
L_apolld_52:
L_w0_50:
L_cnd_49:
    s_mov_b32 s81, 3
    s_mov_b32 s67, 1
    s_branch L_sl_42
L_sn_48:
    s_cmp_lg_u32 s81, 3
    s_cbranch_scc1 L_sn_53
    s_cmp_lt_u32 s80, 24
    s_cbranch_scc1 L_cnd_54
    s_lshl_b32 s73, s69, 3
    s_add_u32 s73, s73, s60
    s_add_u32 s44, s26, 0x2000000
    s_addc_u32 s45, s27, 0
    s_mov_b32 s46, 0x200000
    s_mov_b32 s47, 0x20000
    v_and_b32 v2, 31, v1
    v_lshrrev_b32 v3, 5, v1
    v_lshlrev_b32 v3, 20, v3
    v_lshl_add_u32 v3, v2, 4, v3
    s_lshl_b32 s71, s73, 9
    v_add_u32 v3, s71, v3
    s_mov_b32 s72, 0x0
    buffer_load_dwordx4 v[192:195], v3, s[44:47], s72 offen sc1
    s_mov_b32 s72, 0x20000
    buffer_load_dwordx4 v[196:199], v3, s[44:47], s72 offen sc1
    s_mov_b32 s72, 0x40000
    buffer_load_dwordx4 v[200:203], v3, s[44:47], s72 offen sc1
    s_mov_b32 s72, 0x60000
    buffer_load_dwordx4 v[204:207], v3, s[44:47], s72 offen sc1
    s_mov_b32 s72, 0x80000
    buffer_load_dwordx4 v[208:211], v3, s[44:47], s72 offen sc1
    s_mov_b32 s72, 0xa0000
    buffer_load_dwordx4 v[212:215], v3, s[44:47], s72 offen sc1
    s_mov_b32 s72, 0xc0000
    buffer_load_dwordx4 v[216:219], v3, s[44:47], s72 offen sc1
    s_mov_b32 s72, 0xe0000
    buffer_load_dwordx4 v[220:223], v3, s[44:47], s72 offen sc1
    s_add_u32 s44, s26, 0x2200000
    s_addc_u32 s45, s27, 0
    s_mov_b32 s46, 0x10000
    s_mov_b32 s47, 0x20000
    v_and_b32 v2, 7, v1
    v_lshrrev_b32 v3, 3, v1
    v_lshlrev_b32 v3, 12, v3
    v_lshl_add_u32 v3, v2, 4, v3
    s_lshl_b32 s71, s69, 7
    v_add_u32 v3, s71, v3
    s_mov_b32 s72, 0x8000
    buffer_load_dwordx4 v[232:235], v3, s[44:47], 0 offen sc1
    buffer_load_dwordx4 v[236:239], v3, s[44:47], s72 offen sc1
L_cnd_54:
    s_mov_b32 s81, 4
    s_mov_b32 s67, 3
    s_branch L_sl_42
L_sn_53:
    s_cmp_lg_u32 s81, 4
    s_cbranch_scc1 L_sn_55
    s_cmp_lt_u32 s80, 24
    s_cbranch_scc1 L_cnd_56
    s_lshl_b32 s73, s69, 3
    s_add_u32 s73, s73, s60
    s_waitcnt vmcnt(0)
    v_pk_add_f32 v[192:193], v[192:193], v[196:197]
    v_pk_add_f32 v[194:195], v[194:195], v[198:199]
    v_pk_add_f32 v[192:193], v[192:193], v[200:201]
    v_pk_add_f32 v[194:195], v[194:195], v[202:203]
    v_pk_add_f32 v[192:193], v[192:193], v[204:205]
    v_pk_add_f32 v[194:195], v[194:195], v[206:207]
    v_pk_add_f32 v[192:193], v[192:193], v[208:209]
    v_pk_add_f32 v[194:195], v[194:195], v[210:211]
    v_pk_add_f32 v[192:193], v[192:193], v[212:213]
    v_pk_add_f32 v[194:195], v[194:195], v[214:215]
    v_pk_add_f32 v[192:193], v[192:193], v[216:217]
    v_pk_add_f32 v[194:195], v[194:195], v[218:219]
    v_pk_add_f32 v[192:193], v[192:193], v[220:221]
    v_pk_add_f32 v[194:195], v[194:195], v[222:223]
    v_mov_b32 v196, v192
    v_mov_b32 v197, v193
    v_mov_b32 v198, v194
    v_mov_b32 v199, v195
    s_nop 1
    v_permlane32_swap_b32 v192, v196
    v_permlane32_swap_b32 v193, v197
    v_permlane32_swap_b32 v194, v198
    v_permlane32_swap_b32 v195, v199
    s_nop 1
    v_pk_add_f32 v[192:193], v[192:193], v[196:197]
    v_pk_add_f32 v[194:195], v[194:195], v[198:199]
    v_cvt_pk_bf16_f32 v224, v192, v193
    v_cvt_pk_bf16_f32 v225, v194, v195
    s_add_u32 s48, s26, 0x2400000
    s_addc_u32 s49, s27, 0
    s_mov_b32 s50, 0x10000
    s_mov_b32 s51, 0x20000
    s_lshl_b32 s71, s73, 8
    v_and_b32 v2, 31, v1
    v_lshlrev_b32 v2, 3, v2
    v_add_u32 v2, s71, v2
    s_mov_b32 exec_hi, 0
    buffer_store_dwordx2 v[224:225], v2, s[48:51], 0 offen sc1
    s_mov_b64 exec, -1
    s_cmp_lg_u32 s60, 0
    s_cbranch_scc1 L_zdone_57
    s_add_u32 s48, s26, 0x2410000
    s_addc_u32 s49, s27, 0
    s_mov_b32 s50, 0x800
    s_mov_b32 s51, 0x20000
    v_pk_add_f32 v[232:233], v[232:233], v[236:237]
    v_pk_add_f32 v[234:235], v[234:235], v[238:239]
    ds_swizzle_b32 v236, v232 offset:0x201f
    ds_swizzle_b32 v237, v233 offset:0x201f
    ds_swizzle_b32 v238, v234 offset:0x201f
    ds_swizzle_b32 v239, v235 offset:0x201f
    s_waitcnt lgkmcnt(0)
    v_pk_add_f32 v[232:233], v[232:233], v[236:237]
    v_pk_add_f32 v[234:235], v[234:235], v[238:239]
    ds_swizzle_b32 v236, v232 offset:0x401f
    ds_swizzle_b32 v237, v233 offset:0x401f
    ds_swizzle_b32 v238, v234 offset:0x401f
    ds_swizzle_b32 v239, v235 offset:0x401f
    s_waitcnt lgkmcnt(0)
    v_pk_add_f32 v[232:233], v[232:233], v[236:237]
    v_pk_add_f32 v[234:235], v[234:235], v[238:239]
    v_mov_b32 v236, v232
    v_mov_b32 v237, v233
    v_mov_b32 v238, v234
    v_mov_b32 v239, v235
    s_nop 1
    v_permlane32_swap_b32 v232, v236
    v_permlane32_swap_b32 v233, v237
    v_permlane32_swap_b32 v234, v238
    v_permlane32_swap_b32 v235, v239
    s_nop 1
    v_pk_add_f32 v[232:233], v[232:233], v[236:237]
    v_pk_add_f32 v[234:235], v[234:235], v[238:239]
    v_cvt_pk_bf16_f32 v240, v232, v233
    v_cvt_pk_bf16_f32 v241, v234, v235
    s_lshl_b32 s71, s69, 6
    v_and_b32 v2, 7, v1
    v_lshlrev_b32 v2, 3, v2
    v_add_u32 v2, s71, v2
    s_mov_b64 exec, 0xff
    buffer_store_dwordx2 v[240:241], v2, s[48:51], 0 offen sc1
    s_mov_b64 exec, -1
L_zdone_57:
    s_lshl_b32 s73, s69, 3
    s_add_u32 s73, s73, s60
    s_add_u32 s73, s73, 4
    s_add_u32 s44, s26, 0x2000000
    s_addc_u32 s45, s27, 0
    s_mov_b32 s46, 0x200000
    s_mov_b32 s47, 0x20000
    v_and_b32 v2, 31, v1
    v_lshrrev_b32 v3, 5, v1
    v_lshlrev_b32 v3, 20, v3
    v_lshl_add_u32 v3, v2, 4, v3
    s_lshl_b32 s71, s73, 9
    v_add_u32 v3, s71, v3
    s_mov_b32 s72, 0x0
    buffer_load_dwordx4 v[192:195], v3, s[44:47], s72 offen sc1
    s_mov_b32 s72, 0x20000
    buffer_load_dwordx4 v[196:199], v3, s[44:47], s72 offen sc1
    s_mov_b32 s72, 0x40000
    buffer_load_dwordx4 v[200:203], v3, s[44:47], s72 offen sc1
    s_mov_b32 s72, 0x60000
    buffer_load_dwordx4 v[204:207], v3, s[44:47], s72 offen sc1
    s_mov_b32 s72, 0x80000
    buffer_load_dwordx4 v[208:211], v3, s[44:47], s72 offen sc1
    s_mov_b32 s72, 0xa0000
    buffer_load_dwordx4 v[212:215], v3, s[44:47], s72 offen sc1
    s_mov_b32 s72, 0xc0000
    buffer_load_dwordx4 v[216:219], v3, s[44:47], s72 offen sc1
    s_mov_b32 s72, 0xe0000
    buffer_load_dwordx4 v[220:223], v3, s[44:47], s72 offen sc1
L_cnd_56:
    s_mov_b32 s81, 5
    s_mov_b32 s67, 3
    s_branch L_sl_42
L_sn_55:
    s_cmp_lg_u32 s81, 5
    s_cbranch_scc1 L_sn_58
    s_cmp_lt_u32 s80, 24
    s_cbranch_scc1 L_cnd_59
    s_lshl_b32 s73, s69, 3
    s_add_u32 s73, s73, s60
    s_add_u32 s73, s73, 4
    s_waitcnt vmcnt(0)
    v_pk_add_f32 v[192:193], v[192:193], v[196:197]
    v_pk_add_f32 v[194:195], v[194:195], v[198:199]
    v_pk_add_f32 v[192:193], v[192:193], v[200:201]
    v_pk_add_f32 v[194:195], v[194:195], v[202:203]
    v_pk_add_f32 v[192:193], v[192:193], v[204:205]
    v_pk_add_f32 v[194:195], v[194:195], v[206:207]
    v_pk_add_f32 v[192:193], v[192:193], v[208:209]
    v_pk_add_f32 v[194:195], v[194:195], v[210:211]
    v_pk_add_f32 v[192:193], v[192:193], v[212:213]
    v_pk_add_f32 v[194:195], v[194:195], v[214:215]
    v_pk_add_f32 v[192:193], v[192:193], v[216:217]
    v_pk_add_f32 v[194:195], v[194:195], v[218:219]
    v_pk_add_f32 v[192:193], v[192:193], v[220:221]
    v_pk_add_f32 v[194:195], v[194:195], v[222:223]
    v_mov_b32 v196, v192
    v_mov_b32 v197, v193
    v_mov_b32 v198, v194
    v_mov_b32 v199, v195
    s_nop 1
    v_permlane32_swap_b32 v192, v196
    v_permlane32_swap_b32 v193, v197
    v_permlane32_swap_b32 v194, v198
    v_permlane32_swap_b32 v195, v199
    s_nop 1
    v_pk_add_f32 v[192:193], v[192:193], v[196:197]
    v_pk_add_f32 v[194:195], v[194:195], v[198:199]
    v_cvt_pk_bf16_f32 v224, v192, v193
    v_cvt_pk_bf16_f32 v225, v194, v195
    s_add_u32 s48, s26, 0x2400000
    s_addc_u32 s49, s27, 0
    s_mov_b32 s50, 0x10000
    s_mov_b32 s51, 0x20000
    s_lshl_b32 s71, s73, 8
    v_and_b32 v2, 31, v1
    v_lshlrev_b32 v2, 3, v2
    v_add_u32 v2, s71, v2
    s_mov_b32 exec_hi, 0
    buffer_store_dwordx2 v[224:225], v2, s[48:51], 0 offen sc1
    s_mov_b64 exec, -1
L_cnd_59:
    s_mov_b32 s81, 6
    s_mov_b32 s67, 2
    s_branch L_sl_42
L_sn_58:
    s_waitcnt lgkmcnt(0)
    v_mov_b32 v48, 0x3fb8aa3b
    v_mov_b32 v49, 0x358637bd
    s_lshr_b32 s73, s60, 1
    s_lshl_b32 s73, s73, 6
    s_add_u32 s73, s73, s61
    s_and_b32 s74, s60, 1
    s_lshl_b32 s74, s74, 6
    s_add_u32 s74, s74, s62
    s_lshl_b32 s74, s74, 1
    s_lshl_b32 s71, s60, 13
    s_add_u32 s71, s71, 98304
    v_lshrrev_b32 v10, 4, v1
    v_and_b32 v2, 15, v1
    v_lshrrev_b32 v3, 1, v2
    v_lshrrev_b32 v8, 1, v10
    v_xor_b32 v3, v3, v8
    v_and_b32 v8, 1, v10
    v_lshlrev_b32 v8, 3, v8
    v_lshl_add_u32 v8, v2, 7, v8
    v_add_u32 v8, s71, v8
    v_xor_b32 v4, 0, v3
    v_lshl_add_u32 v4, v4, 4, v8
    v_xor_b32 v5, 2, v3
    v_lshl_add_u32 v5, v5, 4, v8
    v_xor_b32 v6, 4, v3
    v_lshl_add_u32 v6, v6, 4, v8
    v_xor_b32 v7, 6, v3
    v_lshl_add_u32 v7, v7, 4, v8
    v_lshrrev_b32 v2, 3, v1
    v_and_b32 v3, 7, v1
    v_xor_b32 v8, v3, v10
    v_lshlrev_b32 v8, 4, v8
    v_lshl_add_u32 v8, v2, 7, v8
    v_add_u32 v8, s71, v8
    v_xor_b32 v9, 64, v8
    v_add_u32 v2, s73, v2
    v_lshlrev_b32 v2, 11, v2
    v_lshl_add_u32 v2, v3, 4, v2
    v_add_u32 v10, s74, v2
    v_pk_mul_f32 v[64:65], v[128:129], v[48:49] op_sel:[0,0] op_sel_hi:[1,0]
    v_pk_mul_f32 v[66:67], v[130:131], v[48:49] op_sel:[0,0] op_sel_hi:[1,0]
    v_pk_mul_f32 v[68:69], v[132:133], v[48:49] op_sel:[0,0] op_sel_hi:[1,0]
    v_pk_mul_f32 v[70:71], v[134:135], v[48:49] op_sel:[0,0] op_sel_hi:[1,0]
    v_pk_mul_f32 v[72:73], v[136:137], v[48:49] op_sel:[0,0] op_sel_hi:[1,0]
    v_pk_mul_f32 v[74:75], v[138:139], v[48:49] op_sel:[0,0] op_sel_hi:[1,0]
    v_pk_mul_f32 v[76:77], v[140:141], v[48:49] op_sel:[0,0] op_sel_hi:[1,0]
    v_pk_mul_f32 v[78:79], v[142:143], v[48:49] op_sel:[0,0] op_sel_hi:[1,0]
    v_exp_f32 v64, v64 clamp
    v_exp_f32 v65, v65 clamp
    v_exp_f32 v66, v66 clamp
    v_exp_f32 v67, v67 clamp
    v_exp_f32 v68, v68 clamp
    v_exp_f32 v69, v69 clamp
    v_exp_f32 v70, v70 clamp
    v_exp_f32 v71, v71 clamp
    v_exp_f32 v72, v72 clamp
    v_exp_f32 v73, v73 clamp
    v_exp_f32 v74, v74 clamp
    v_exp_f32 v75, v75 clamp
    v_exp_f32 v76, v76 clamp
    v_exp_f32 v77, v77 clamp
    v_exp_f32 v78, v78 clamp
    v_exp_f32 v79, v79 clamp
    v_max_f32 v128, 0, v128
    v_max_f32 v129, 0, v129
    v_max_f32 v130, 0, v130
    v_max_f32 v131, 0, v131
    v_max_f32 v132, 0, v132
    v_max_f32 v133, 0, v133
    v_max_f32 v134, 0, v134
    v_max_f32 v135, 0, v135
    v_max_f32 v136, 0, v136
    v_max_f32 v137, 0, v137
    v_max_f32 v138, 0, v138
    v_max_f32 v139, 0, v139
    v_max_f32 v140, 0, v140
    v_max_f32 v141, 0, v141
    v_max_f32 v142, 0, v142
    v_max_f32 v143, 0, v143
    v_pk_add_f32 v[64:65], v[64:65], v[48:49] op_sel:[0,1] op_sel_hi:[1,1]
    v_pk_add_f32 v[66:67], v[66:67], v[48:49] op_sel:[0,1] op_sel_hi:[1,1]
    v_pk_add_f32 v[68:69], v[68:69], v[48:49] op_sel:[0,1] op_sel_hi:[1,1]
    v_pk_add_f32 v[70:71], v[70:71], v[48:49] op_sel:[0,1] op_sel_hi:[1,1]
    v_pk_add_f32 v[72:73], v[72:73], v[48:49] op_sel:[0,1] op_sel_hi:[1,1]
    v_pk_add_f32 v[74:75], v[74:75], v[48:49] op_sel:[0,1] op_sel_hi:[1,1]
    v_pk_add_f32 v[76:77], v[76:77], v[48:49] op_sel:[0,1] op_sel_hi:[1,1]
    v_pk_add_f32 v[78:79], v[78:79], v[48:49] op_sel:[0,1] op_sel_hi:[1,1]
    v_pk_add_f32 v[128:129], v[128:129], v[64:65]
    v_pk_add_f32 v[130:131], v[130:131], v[66:67]
    v_pk_add_f32 v[132:133], v[132:133], v[68:69]
    v_pk_add_f32 v[134:135], v[134:135], v[70:71]
    v_pk_add_f32 v[136:137], v[136:137], v[72:73]
    v_pk_add_f32 v[138:139], v[138:139], v[74:75]
    v_pk_add_f32 v[140:141], v[140:141], v[76:77]
    v_pk_add_f32 v[142:143], v[142:143], v[78:79]
    v_cvt_pk_bf16_f32 v96, v128, v129
    v_cvt_pk_bf16_f32 v97, v130, v131
    v_cvt_pk_bf16_f32 v98, v132, v133
    v_cvt_pk_bf16_f32 v99, v134, v135
    v_cvt_pk_bf16_f32 v100, v136, v137
    v_cvt_pk_bf16_f32 v101, v138, v139
    v_cvt_pk_bf16_f32 v102, v140, v141
    v_cvt_pk_bf16_f32 v103, v142, v143
    ds_write_b64 v4, v[96:97] offset:0
    ds_write_b64 v5, v[98:99] offset:0
    ds_write_b64 v6, v[100:101] offset:0
    ds_write_b64 v7, v[102:103] offset:0
    ds_read_b128 v[80:83], v8 offset:0
    ds_read_b128 v[84:87], v9 offset:1024
    v_pk_mul_f32 v[64:65], v[144:145], v[48:49] op_sel:[0,0] op_sel_hi:[1,0]
    v_pk_mul_f32 v[66:67], v[146:147], v[48:49] op_sel:[0,0] op_sel_hi:[1,0]
    v_pk_mul_f32 v[68:69], v[148:149], v[48:49] op_sel:[0,0] op_sel_hi:[1,0]
    v_pk_mul_f32 v[70:71], v[150:151], v[48:49] op_sel:[0,0] op_sel_hi:[1,0]
    v_pk_mul_f32 v[72:73], v[152:153], v[48:49] op_sel:[0,0] op_sel_hi:[1,0]
    v_pk_mul_f32 v[74:75], v[154:155], v[48:49] op_sel:[0,0] op_sel_hi:[1,0]
    v_pk_mul_f32 v[76:77], v[156:157], v[48:49] op_sel:[0,0] op_sel_hi:[1,0]
    v_pk_mul_f32 v[78:79], v[158:159], v[48:49] op_sel:[0,0] op_sel_hi:[1,0]
    v_exp_f32 v64, v64 clamp
    v_exp_f32 v65, v65 clamp
    v_exp_f32 v66, v66 clamp
    v_exp_f32 v67, v67 clamp
    v_exp_f32 v68, v68 clamp
    v_exp_f32 v69, v69 clamp
    v_exp_f32 v70, v70 clamp
    v_exp_f32 v71, v71 clamp
    s_waitcnt lgkmcnt(0)
    v_add_u32 v12, 0x0, v10
    v_add_u32 v13, 0x4000, v10
    buffer_store_dwordx4 v[80:83], v12, s[36:39], 0 offen sc1
    buffer_store_dwordx4 v[84:87], v13, s[36:39], 0 offen sc1
    v_exp_f32 v72, v72 clamp
    v_exp_f32 v73, v73 clamp
    v_exp_f32 v74, v74 clamp
    v_exp_f32 v75, v75 clamp
    v_exp_f32 v76, v76 clamp
    v_exp_f32 v77, v77 clamp
    v_exp_f32 v78, v78 clamp
    v_exp_f32 v79, v79 clamp
    v_max_f32 v144, 0, v144
    v_max_f32 v145, 0, v145
    v_max_f32 v146, 0, v146
    v_max_f32 v147, 0, v147
    v_max_f32 v148, 0, v148
    v_max_f32 v149, 0, v149
    v_max_f32 v150, 0, v150
    v_max_f32 v151, 0, v151
    v_max_f32 v152, 0, v152
    v_max_f32 v153, 0, v153
    v_max_f32 v154, 0, v154
    v_max_f32 v155, 0, v155
    v_max_f32 v156, 0, v156
    v_max_f32 v157, 0, v157
    v_max_f32 v158, 0, v158
    v_max_f32 v159, 0, v159
    v_pk_add_f32 v[64:65], v[64:65], v[48:49] op_sel:[0,1] op_sel_hi:[1,1]
    v_pk_add_f32 v[66:67], v[66:67], v[48:49] op_sel:[0,1] op_sel_hi:[1,1]
    v_pk_add_f32 v[68:69], v[68:69], v[48:49] op_sel:[0,1] op_sel_hi:[1,1]
    v_pk_add_f32 v[70:71], v[70:71], v[48:49] op_sel:[0,1] op_sel_hi:[1,1]
    v_pk_add_f32 v[72:73], v[72:73], v[48:49] op_sel:[0,1] op_sel_hi:[1,1]
    v_pk_add_f32 v[74:75], v[74:75], v[48:49] op_sel:[0,1] op_sel_hi:[1,1]
    v_pk_add_f32 v[76:77], v[76:77], v[48:49] op_sel:[0,1] op_sel_hi:[1,1]
    v_pk_add_f32 v[78:79], v[78:79], v[48:49] op_sel:[0,1] op_sel_hi:[1,1]
    v_pk_add_f32 v[144:145], v[144:145], v[64:65]
    v_pk_add_f32 v[146:147], v[146:147], v[66:67]
    v_pk_add_f32 v[148:149], v[148:149], v[68:69]
    v_pk_add_f32 v[150:151], v[150:151], v[70:71]
    v_pk_add_f32 v[152:153], v[152:153], v[72:73]
    v_pk_add_f32 v[154:155], v[154:155], v[74:75]
    v_pk_add_f32 v[156:157], v[156:157], v[76:77]
    v_pk_add_f32 v[158:159], v[158:159], v[78:79]
    v_cvt_pk_bf16_f32 v104, v144, v145
    v_cvt_pk_bf16_f32 v105, v146, v147
    v_cvt_pk_bf16_f32 v106, v148, v149
    v_cvt_pk_bf16_f32 v107, v150, v151
    v_cvt_pk_bf16_f32 v108, v152, v153
    v_cvt_pk_bf16_f32 v109, v154, v155
    v_cvt_pk_bf16_f32 v110, v156, v157
    v_cvt_pk_bf16_f32 v111, v158, v159
    ds_write_b64 v4, v[104:105] offset:2048
    ds_write_b64 v5, v[106:107] offset:2048
    ds_write_b64 v6, v[108:109] offset:2048
    ds_write_b64 v7, v[110:111] offset:2048
    ds_read_b128 v[88:91], v8 offset:2048
    ds_read_b128 v[92:95], v9 offset:3072
    v_pk_mul_f32 v[64:65], v[160:161], v[48:49] op_sel:[0,0] op_sel_hi:[1,0]
    v_pk_mul_f32 v[66:67], v[162:163], v[48:49] op_sel:[0,0] op_sel_hi:[1,0]
    v_pk_mul_f32 v[68:69], v[164:165], v[48:49] op_sel:[0,0] op_sel_hi:[1,0]
    v_pk_mul_f32 v[70:71], v[166:167], v[48:49] op_sel:[0,0] op_sel_hi:[1,0]
    v_pk_mul_f32 v[72:73], v[168:169], v[48:49] op_sel:[0,0] op_sel_hi:[1,0]
    v_pk_mul_f32 v[74:75], v[170:171], v[48:49] op_sel:[0,0] op_sel_hi:[1,0]
    v_pk_mul_f32 v[76:77], v[172:173], v[48:49] op_sel:[0,0] op_sel_hi:[1,0]
    v_pk_mul_f32 v[78:79], v[174:175], v[48:49] op_sel:[0,0] op_sel_hi:[1,0]
    v_exp_f32 v64, v64 clamp
    v_exp_f32 v65, v65 clamp
    v_exp_f32 v66, v66 clamp
    v_exp_f32 v67, v67 clamp
    v_exp_f32 v68, v68 clamp
    v_exp_f32 v69, v69 clamp
    v_exp_f32 v70, v70 clamp
    v_exp_f32 v71, v71 clamp
    s_waitcnt lgkmcnt(0)
    v_add_u32 v14, 0x8000, v10
    v_add_u32 v15, 0xc000, v10
    buffer_store_dwordx4 v[88:91], v14, s[36:39], 0 offen sc1
    buffer_store_dwordx4 v[92:95], v15, s[36:39], 0 offen sc1
    v_exp_f32 v72, v72 clamp
    v_exp_f32 v73, v73 clamp
    v_exp_f32 v74, v74 clamp
    v_exp_f32 v75, v75 clamp
    v_exp_f32 v76, v76 clamp
    v_exp_f32 v77, v77 clamp
    v_exp_f32 v78, v78 clamp
    v_exp_f32 v79, v79 clamp
    v_max_f32 v160, 0, v160
    v_max_f32 v161, 0, v161
    v_max_f32 v162, 0, v162
    v_max_f32 v163, 0, v163
    v_max_f32 v164, 0, v164
    v_max_f32 v165, 0, v165
    v_max_f32 v166, 0, v166
    v_max_f32 v167, 0, v167
    v_max_f32 v168, 0, v168
    v_max_f32 v169, 0, v169
    v_max_f32 v170, 0, v170
    v_max_f32 v171, 0, v171
    v_max_f32 v172, 0, v172
    v_max_f32 v173, 0, v173
    v_max_f32 v174, 0, v174
    v_max_f32 v175, 0, v175
    v_pk_add_f32 v[64:65], v[64:65], v[48:49] op_sel:[0,1] op_sel_hi:[1,1]
    v_pk_add_f32 v[66:67], v[66:67], v[48:49] op_sel:[0,1] op_sel_hi:[1,1]
    v_pk_add_f32 v[68:69], v[68:69], v[48:49] op_sel:[0,1] op_sel_hi:[1,1]
    v_pk_add_f32 v[70:71], v[70:71], v[48:49] op_sel:[0,1] op_sel_hi:[1,1]
    v_pk_add_f32 v[72:73], v[72:73], v[48:49] op_sel:[0,1] op_sel_hi:[1,1]
    v_pk_add_f32 v[74:75], v[74:75], v[48:49] op_sel:[0,1] op_sel_hi:[1,1]
    v_pk_add_f32 v[76:77], v[76:77], v[48:49] op_sel:[0,1] op_sel_hi:[1,1]
    v_pk_add_f32 v[78:79], v[78:79], v[48:49] op_sel:[0,1] op_sel_hi:[1,1]
    v_pk_add_f32 v[160:161], v[160:161], v[64:65]
    v_pk_add_f32 v[162:163], v[162:163], v[66:67]
    v_pk_add_f32 v[164:165], v[164:165], v[68:69]
    v_pk_add_f32 v[166:167], v[166:167], v[70:71]
    v_pk_add_f32 v[168:169], v[168:169], v[72:73]
    v_pk_add_f32 v[170:171], v[170:171], v[74:75]
    v_pk_add_f32 v[172:173], v[172:173], v[76:77]
    v_pk_add_f32 v[174:175], v[174:175], v[78:79]
    v_cvt_pk_bf16_f32 v96, v160, v161
    v_cvt_pk_bf16_f32 v97, v162, v163
    v_cvt_pk_bf16_f32 v98, v164, v165
    v_cvt_pk_bf16_f32 v99, v166, v167
    v_cvt_pk_bf16_f32 v100, v168, v169
    v_cvt_pk_bf16_f32 v101, v170, v171
    v_cvt_pk_bf16_f32 v102, v172, v173
    v_cvt_pk_bf16_f32 v103, v174, v175
    ds_write_b64 v4, v[96:97] offset:4096
    ds_write_b64 v5, v[98:99] offset:4096
    ds_write_b64 v6, v[100:101] offset:4096
    ds_write_b64 v7, v[102:103] offset:4096
    ds_read_b128 v[80:83], v8 offset:4096
    ds_read_b128 v[84:87], v9 offset:5120
    v_pk_mul_f32 v[64:65], v[176:177], v[48:49] op_sel:[0,0] op_sel_hi:[1,0]
    v_pk_mul_f32 v[66:67], v[178:179], v[48:49] op_sel:[0,0] op_sel_hi:[1,0]
    v_pk_mul_f32 v[68:69], v[180:181], v[48:49] op_sel:[0,0] op_sel_hi:[1,0]
    v_pk_mul_f32 v[70:71], v[182:183], v[48:49] op_sel:[0,0] op_sel_hi:[1,0]
    v_pk_mul_f32 v[72:73], v[184:185], v[48:49] op_sel:[0,0] op_sel_hi:[1,0]
    v_pk_mul_f32 v[74:75], v[186:187], v[48:49] op_sel:[0,0] op_sel_hi:[1,0]
    v_pk_mul_f32 v[76:77], v[188:189], v[48:49] op_sel:[0,0] op_sel_hi:[1,0]
    v_pk_mul_f32 v[78:79], v[190:191], v[48:49] op_sel:[0,0] op_sel_hi:[1,0]
    v_exp_f32 v64, v64 clamp
    v_exp_f32 v65, v65 clamp
    v_exp_f32 v66, v66 clamp
    v_exp_f32 v67, v67 clamp
    v_exp_f32 v68, v68 clamp
    v_exp_f32 v69, v69 clamp
    v_exp_f32 v70, v70 clamp
    v_exp_f32 v71, v71 clamp
    s_waitcnt lgkmcnt(0)
    v_add_u32 v12, 0x10000, v10
    v_add_u32 v13, 0x14000, v10
    buffer_store_dwordx4 v[80:83], v12, s[36:39], 0 offen sc1
    buffer_store_dwordx4 v[84:87], v13, s[36:39], 0 offen sc1
    v_exp_f32 v72, v72 clamp
    v_exp_f32 v73, v73 clamp
    v_exp_f32 v74, v74 clamp
    v_exp_f32 v75, v75 clamp
    v_exp_f32 v76, v76 clamp
    v_exp_f32 v77, v77 clamp
    v_exp_f32 v78, v78 clamp
    v_exp_f32 v79, v79 clamp
    v_max_f32 v176, 0, v176
    v_max_f32 v177, 0, v177
    v_max_f32 v178, 0, v178
    v_max_f32 v179, 0, v179
    v_max_f32 v180, 0, v180
    v_max_f32 v181, 0, v181
    v_max_f32 v182, 0, v182
    v_max_f32 v183, 0, v183
    v_max_f32 v184, 0, v184
    v_max_f32 v185, 0, v185
    v_max_f32 v186, 0, v186
    v_max_f32 v187, 0, v187
    v_max_f32 v188, 0, v188
    v_max_f32 v189, 0, v189
    v_max_f32 v190, 0, v190
    v_max_f32 v191, 0, v191
    v_pk_add_f32 v[64:65], v[64:65], v[48:49] op_sel:[0,1] op_sel_hi:[1,1]
    v_pk_add_f32 v[66:67], v[66:67], v[48:49] op_sel:[0,1] op_sel_hi:[1,1]
    v_pk_add_f32 v[68:69], v[68:69], v[48:49] op_sel:[0,1] op_sel_hi:[1,1]
    v_pk_add_f32 v[70:71], v[70:71], v[48:49] op_sel:[0,1] op_sel_hi:[1,1]
    v_pk_add_f32 v[72:73], v[72:73], v[48:49] op_sel:[0,1] op_sel_hi:[1,1]
    v_pk_add_f32 v[74:75], v[74:75], v[48:49] op_sel:[0,1] op_sel_hi:[1,1]
    v_pk_add_f32 v[76:77], v[76:77], v[48:49] op_sel:[0,1] op_sel_hi:[1,1]
    v_pk_add_f32 v[78:79], v[78:79], v[48:49] op_sel:[0,1] op_sel_hi:[1,1]
    v_pk_add_f32 v[176:177], v[176:177], v[64:65]
    v_pk_add_f32 v[178:179], v[178:179], v[66:67]
    v_pk_add_f32 v[180:181], v[180:181], v[68:69]
    v_pk_add_f32 v[182:183], v[182:183], v[70:71]
    v_pk_add_f32 v[184:185], v[184:185], v[72:73]
    v_pk_add_f32 v[186:187], v[186:187], v[74:75]
    v_pk_add_f32 v[188:189], v[188:189], v[76:77]
    v_pk_add_f32 v[190:191], v[190:191], v[78:79]
    v_cvt_pk_bf16_f32 v104, v176, v177
    v_cvt_pk_bf16_f32 v105, v178, v179
    v_cvt_pk_bf16_f32 v106, v180, v181
    v_cvt_pk_bf16_f32 v107, v182, v183
    v_cvt_pk_bf16_f32 v108, v184, v185
    v_cvt_pk_bf16_f32 v109, v186, v187
    v_cvt_pk_bf16_f32 v110, v188, v189
    v_cvt_pk_bf16_f32 v111, v190, v191
    ds_write_b64 v4, v[104:105] offset:6144
    ds_write_b64 v5, v[106:107] offset:6144
    ds_write_b64 v6, v[108:109] offset:6144
    ds_write_b64 v7, v[110:111] offset:6144
    ds_read_b128 v[88:91], v8 offset:6144
    ds_read_b128 v[92:95], v9 offset:7168
    s_waitcnt lgkmcnt(0)
    v_add_u32 v14, 0x18000, v10
    v_add_u32 v15, 0x1c000, v10
    buffer_store_dwordx4 v[88:91], v14, s[36:39], 0 offen sc1
    buffer_store_dwordx4 v[92:95], v15, s[36:39], 0 offen sc1
    s_cmp_ge_u32 s80, 24
    s_cbranch_scc1 L_owg_c
L_p3:
    s_lshl_b32 s78, s76, 3
    s_add_u32 s78, s78, s63
    s_lshl_b32 s62, s78, 8
    s_add_u32 s28, s26, 0x800000
    s_addc_u32 s29, s27, 0
    s_mov_b32 s30, 0x400000
    s_mov_b32 s31, 0x20000
    s_mov_b32 s32, s16
    s_mov_b32 s33, s17
    s_mov_b32 s34, 0x700000
    s_mov_b32 s35, 0x20000
    s_add_u32 s36, s26, 0x1000000
    s_addc_u32 s37, s27, 0
    s_mov_b32 s38, 0xe00000
    s_mov_b32 s39, 0x20000
    s_mov_b32 s64, 7168
    s_mov_b32 s65, 32
    s_mov_b32 s66, 64
    v_and_b32 v2, 15, v1
    v_lshlrev_b32 v2, 7, v2
    v_bfe_u32 v3, v1, 1, 3
    v_lshrrev_b32 v16, 4, v1
    v_xor_b32 v3, v3, v16
    v_xor_b32 v17, 0, v3
    v_lshl_add_u32 v8, v17, 4, v2
    v_mov_b32 v4, v8
    v_xor_b32 v17, 4, v3
    v_lshl_add_u32 v9, v17, 4, v2
    v_mov_b32 v5, v9
    v_bfe_u32 v2, v1, 2, 2
    v_lshl_add_u32 v18, v16, 3, v2
    v_and_b32 v3, 1, v1
    v_lshlrev_b32 v3, 3, v3
    v_lshl_add_u32 v3, v18, 9, v3
    v_bfe_u32 v17, v1, 1, 1
    s_and_b32 s71, s60, 3
    s_lshl_b32 s71, s71, 3
    v_add_u32 v17, s71, v17
    v_lshlrev_b32 v2, 2, v2
    v_xor_b32 v17, v17, v2
    v_and_b32 v2, 1, v16
    v_lshlrev_b32 v2, 1, v2
    v_xor_b32 v17, v17, v2
    v_xor_b32 v19, 0, v17
    v_lshl_add_u32 v19, v19, 4, v3
    v_add_u32 v10, 16384, v19
    v_mov_b32 v6, v10
    v_xor_b32 v19, 2, v17
    v_lshl_add_u32 v19, v19, 4, v3
    v_add_u32 v11, 16384, v19
    v_mov_b32 v7, v11
    v_xor_b32 v19, 4, v17
    v_lshl_add_u32 v19, v19, 4, v3
    v_add_u32 v14, 16384, v19
    v_mov_b32 v12, v14
    v_xor_b32 v19, 6, v17
    v_lshl_add_u32 v19, v19, 4, v3
    v_add_u32 v15, 16384, v19
    v_mov_b32 v13, v15
    s_mov_b32 s70, 0
    s_cmp_lg_u32 s76, 0
    s_cbranch_scc1 L_cnd_60
    s_waitcnt vmcnt(0)
L_cnd_60:
    s_barrier
    ds_read_b64_tr_b16 v[48:49], v6 offset:0
    ds_read_b64_tr_b16 v[50:51], v6 offset:2048
    ds_read_b128 v[16:19], v4 offset:0
    ds_read_b64_tr_b16 v[52:53], v7 offset:0
    ds_read_b64_tr_b16 v[54:55], v7 offset:2048
    ds_read_b128 v[20:23], v4 offset:2048
    ds_read_b64_tr_b16 v[56:57], v12 offset:0
    ds_read_b64_tr_b16 v[58:59], v12 offset:2048
    ds_read_b128 v[24:27], v4 offset:4096
    ds_read_b64_tr_b16 v[60:61], v13 offset:0
    ds_read_b64_tr_b16 v[62:63], v13 offset:2048
    ds_read_b128 v[28:31], v4 offset:6144
    ds_read_b128 v[32:35], v4 offset:8192
    ds_read_b128 v[36:39], v4 offset:10240
    ds_read_b128 v[40:43], v4 offset:12288
    ds_read_b128 v[44:47], v4 offset:14336
    s_cmp_lg_u32 s60, 0
    s_cbranch_scc1 L_w0_61
    s_cmp_lg_u32 s76, 0
    s_cbranch_scc1 L_s2a_62
    s_add_u32 s48, s26, 0x2700000
    s_addc_u32 s49, s27, 0
    s_mov_b32 s50, 0x8000
    s_mov_b32 s51, 0x20000
    s_lshl_b32 s71, s77, 7
    s_add_u32 s71, s71, 0
    v_mov_b32 v2, s71
    v_mov_b32 v3, 1
    s_mov_b64 exec, 1
    buffer_atomic_add v3, v2, s[48:51], 0 offen sc1
    s_mov_b64 exec, -1
    s_branch L_s2b_63
L_s2a_62:
L_s2b_63:
L_w0_61:
    s_waitcnt lgkmcnt(0)
    v_mfma_f32_16x16x32_bf16 v[128:131], v[48:51], v[16:19], 0
    ds_read_b64_tr_b16 v[96:97], v6 offset:16384
    ds_read_b64_tr_b16 v[98:99], v6 offset:18432
    v_mfma_f32_16x16x32_bf16 v[144:147], v[48:51], v[20:23], 0
    ds_read_b128 v[64:67], v5 offset:0
    ds_read_b64_tr_b16 v[100:101], v7 offset:16384
    v_mfma_f32_16x16x32_bf16 v[160:163], v[48:51], v[24:27], 0
    ds_read_b64_tr_b16 v[102:103], v7 offset:18432
    ds_read_b128 v[68:71], v5 offset:2048
    v_mfma_f32_16x16x32_bf16 v[176:179], v[48:51], v[28:31], 0
    ds_read_b64_tr_b16 v[104:105], v12 offset:16384
    ds_read_b64_tr_b16 v[106:107], v12 offset:18432
    v_mfma_f32_16x16x32_bf16 v[192:195], v[48:51], v[32:35], 0
    ds_read_b128 v[72:75], v5 offset:4096
    ds_read_b64_tr_b16 v[108:109], v13 offset:16384
    v_mfma_f32_16x16x32_bf16 v[208:211], v[48:51], v[36:39], 0
    ds_read_b64_tr_b16 v[110:111], v13 offset:18432
    ds_read_b128 v[76:79], v5 offset:6144
    v_mfma_f32_16x16x32_bf16 v[224:227], v[48:51], v[40:43], 0
    ds_read_b128 v[80:83], v5 offset:8192
    ds_read_b128 v[84:87], v5 offset:10240
    v_mfma_f32_16x16x32_bf16 v[240:243], v[48:51], v[44:47], 0
    ds_read_b128 v[88:91], v5 offset:12288
    ds_read_b128 v[92:95], v5 offset:14336
    v_mfma_f32_16x16x32_bf16 v[244:247], v[52:55], v[44:47], 0
    s_add_u32 s70, s70, 49152
    s_cmp_eq_u32 s70, 147456
    v_mfma_f32_16x16x32_bf16 v[228:231], v[52:55], v[40:43], 0
    s_cselect_b32 s70, 0, s70
    v_add_u32 v4, s70, v8
    v_mfma_f32_16x16x32_bf16 v[212:215], v[52:55], v[36:39], 0
    v_add_u32 v5, s70, v9
    v_add_u32 v6, s70, v10
    v_mfma_f32_16x16x32_bf16 v[196:199], v[52:55], v[32:35], 0
    v_add_u32 v7, s70, v11
    v_add_u32 v12, s70, v14
    v_mfma_f32_16x16x32_bf16 v[180:183], v[52:55], v[28:31], 0
    v_add_u32 v13, s70, v15
    v_mfma_f32_16x16x32_bf16 v[164:167], v[52:55], v[24:27], 0
    v_mfma_f32_16x16x32_bf16 v[148:151], v[52:55], v[20:23], 0
    v_mfma_f32_16x16x32_bf16 v[132:135], v[52:55], v[16:19], 0
    v_mfma_f32_16x16x32_bf16 v[136:139], v[56:59], v[16:19], 0
    v_mfma_f32_16x16x32_bf16 v[152:155], v[56:59], v[20:23], 0
    v_mfma_f32_16x16x32_bf16 v[168:171], v[56:59], v[24:27], 0
    v_mfma_f32_16x16x32_bf16 v[184:187], v[56:59], v[28:31], 0
    v_mfma_f32_16x16x32_bf16 v[200:203], v[56:59], v[32:35], 0
    v_mfma_f32_16x16x32_bf16 v[216:219], v[56:59], v[36:39], 0
    v_mfma_f32_16x16x32_bf16 v[232:235], v[56:59], v[40:43], 0
    v_mfma_f32_16x16x32_bf16 v[248:251], v[56:59], v[44:47], 0
    v_mfma_f32_16x16x32_bf16 v[252:255], v[60:63], v[44:47], 0
    v_mfma_f32_16x16x32_bf16 v[236:239], v[60:63], v[40:43], 0
    v_mfma_f32_16x16x32_bf16 v[220:223], v[60:63], v[36:39], 0
    v_mfma_f32_16x16x32_bf16 v[204:207], v[60:63], v[32:35], 0
    v_mfma_f32_16x16x32_bf16 v[188:191], v[60:63], v[28:31], 0
    v_mfma_f32_16x16x32_bf16 v[172:175], v[60:63], v[24:27], 0
    v_mfma_f32_16x16x32_bf16 v[156:159], v[60:63], v[20:23], 0
    v_mfma_f32_16x16x32_bf16 v[140:143], v[60:63], v[16:19], 0
    s_waitcnt lgkmcnt(0)
    v_mfma_f32_16x16x32_bf16 v[128:131], v[96:99], v[64:67], v[128:131]
    s_barrier
    v_mfma_f32_16x16x32_bf16 v[144:147], v[96:99], v[68:71], v[144:147]
    ds_read_b64_tr_b16 v[48:49], v6 offset:0
    v_mfma_f32_16x16x32_bf16 v[160:163], v[96:99], v[72:75], v[160:163]
    ds_read_b64_tr_b16 v[50:51], v6 offset:2048
    v_mfma_f32_16x16x32_bf16 v[176:179], v[96:99], v[76:79], v[176:179]
    ds_read_b128 v[16:19], v4 offset:0
    v_mfma_f32_16x16x32_bf16 v[192:195], v[96:99], v[80:83], v[192:195]
    ds_read_b64_tr_b16 v[52:53], v7 offset:0
    v_mfma_f32_16x16x32_bf16 v[208:211], v[96:99], v[84:87], v[208:211]
    ds_read_b64_tr_b16 v[54:55], v7 offset:2048
    v_mfma_f32_16x16x32_bf16 v[224:227], v[96:99], v[88:91], v[224:227]
    ds_read_b128 v[20:23], v4 offset:2048
    v_mfma_f32_16x16x32_bf16 v[240:243], v[96:99], v[92:95], v[240:243]
    ds_read_b64_tr_b16 v[56:57], v12 offset:0
    v_mfma_f32_16x16x32_bf16 v[244:247], v[100:103], v[92:95], v[244:247]
    ds_read_b64_tr_b16 v[58:59], v12 offset:2048
    v_mfma_f32_16x16x32_bf16 v[228:231], v[100:103], v[88:91], v[228:231]
    ds_read_b128 v[24:27], v4 offset:4096
    v_mfma_f32_16x16x32_bf16 v[212:215], v[100:103], v[84:87], v[212:215]
    ds_read_b64_tr_b16 v[60:61], v13 offset:0
    v_mfma_f32_16x16x32_bf16 v[196:199], v[100:103], v[80:83], v[196:199]
    ds_read_b64_tr_b16 v[62:63], v13 offset:2048
    v_mfma_f32_16x16x32_bf16 v[180:183], v[100:103], v[76:79], v[180:183]
    ds_read_b128 v[28:31], v4 offset:6144
    v_mfma_f32_16x16x32_bf16 v[164:167], v[100:103], v[72:75], v[164:167]
    ds_read_b128 v[32:35], v4 offset:8192
    v_mfma_f32_16x16x32_bf16 v[148:151], v[100:103], v[68:71], v[148:151]
    ds_read_b128 v[36:39], v4 offset:10240
    v_mfma_f32_16x16x32_bf16 v[132:135], v[100:103], v[64:67], v[132:135]
    ds_read_b128 v[40:43], v4 offset:12288
    v_mfma_f32_16x16x32_bf16 v[136:139], v[104:107], v[64:67], v[136:139]
    ds_read_b128 v[44:47], v4 offset:14336
    v_mfma_f32_16x16x32_bf16 v[152:155], v[104:107], v[68:71], v[152:155]
    v_mfma_f32_16x16x32_bf16 v[168:171], v[104:107], v[72:75], v[168:171]
    v_mfma_f32_16x16x32_bf16 v[184:187], v[104:107], v[76:79], v[184:187]
    v_mfma_f32_16x16x32_bf16 v[200:203], v[104:107], v[80:83], v[200:203]
    v_mfma_f32_16x16x32_bf16 v[216:219], v[104:107], v[84:87], v[216:219]
    v_mfma_f32_16x16x32_bf16 v[232:235], v[104:107], v[88:91], v[232:235]
    v_mfma_f32_16x16x32_bf16 v[248:251], v[104:107], v[92:95], v[248:251]
    v_mfma_f32_16x16x32_bf16 v[252:255], v[108:111], v[92:95], v[252:255]
    v_mfma_f32_16x16x32_bf16 v[236:239], v[108:111], v[88:91], v[236:239]
    v_mfma_f32_16x16x32_bf16 v[220:223], v[108:111], v[84:87], v[220:223]
    v_mfma_f32_16x16x32_bf16 v[204:207], v[108:111], v[80:83], v[204:207]
    v_mfma_f32_16x16x32_bf16 v[188:191], v[108:111], v[76:79], v[188:191]
    v_mfma_f32_16x16x32_bf16 v[172:175], v[108:111], v[72:75], v[172:175]
    v_mfma_f32_16x16x32_bf16 v[156:159], v[108:111], v[68:71], v[156:159]
    v_mfma_f32_16x16x32_bf16 v[140:143], v[108:111], v[64:67], v[140:143]
    s_cmp_eq_u32 s76, 0
    s_cbranch_scc1 L_cnd_64
    s_waitcnt vmcnt(0)
L_cnd_64:
    s_mov_b32 s81, 0
    s_cmp_eq_u32 s76, 0
    s_cselect_b32 s67, 15, 1
    s_cselect_b32 s81, 1, 0
L_sl_65:
    s_waitcnt lgkmcnt(0)
    v_mfma_f32_16x16x32_bf16 v[128:131], v[48:51], v[16:19], v[128:131]
    ds_read_b64_tr_b16 v[96:97], v6 offset:16384
    ds_read_b64_tr_b16 v[98:99], v6 offset:18432
    v_mfma_f32_16x16x32_bf16 v[144:147], v[48:51], v[20:23], v[144:147]
    ds_read_b128 v[64:67], v5 offset:0
    ds_read_b64_tr_b16 v[100:101], v7 offset:16384
    v_mfma_f32_16x16x32_bf16 v[160:163], v[48:51], v[24:27], v[160:163]
    ds_read_b64_tr_b16 v[102:103], v7 offset:18432
    ds_read_b128 v[68:71], v5 offset:2048
    v_mfma_f32_16x16x32_bf16 v[176:179], v[48:51], v[28:31], v[176:179]
    ds_read_b64_tr_b16 v[104:105], v12 offset:16384
    ds_read_b64_tr_b16 v[106:107], v12 offset:18432
    v_mfma_f32_16x16x32_bf16 v[192:195], v[48:51], v[32:35], v[192:195]
    ds_read_b128 v[72:75], v5 offset:4096
    ds_read_b64_tr_b16 v[108:109], v13 offset:16384
    v_mfma_f32_16x16x32_bf16 v[208:211], v[48:51], v[36:39], v[208:211]
    ds_read_b64_tr_b16 v[110:111], v13 offset:18432
    ds_read_b128 v[76:79], v5 offset:6144
    v_mfma_f32_16x16x32_bf16 v[224:227], v[48:51], v[40:43], v[224:227]
    ds_read_b128 v[80:83], v5 offset:8192
    ds_read_b128 v[84:87], v5 offset:10240
    v_mfma_f32_16x16x32_bf16 v[240:243], v[48:51], v[44:47], v[240:243]
    ds_read_b128 v[88:91], v5 offset:12288
    ds_read_b128 v[92:95], v5 offset:14336
    v_mfma_f32_16x16x32_bf16 v[244:247], v[52:55], v[44:47], v[244:247]
    s_add_u32 s70, s70, 49152
    s_cmp_eq_u32 s70, 147456
    v_mfma_f32_16x16x32_bf16 v[228:231], v[52:55], v[40:43], v[228:231]
    s_cselect_b32 s70, 0, s70
    v_add_u32 v4, s70, v8
    v_mfma_f32_16x16x32_bf16 v[212:215], v[52:55], v[36:39], v[212:215]
    v_add_u32 v5, s70, v9
    v_add_u32 v6, s70, v10
    v_mfma_f32_16x16x32_bf16 v[196:199], v[52:55], v[32:35], v[196:199]
    v_add_u32 v7, s70, v11
    v_add_u32 v12, s70, v14
    v_mfma_f32_16x16x32_bf16 v[180:183], v[52:55], v[28:31], v[180:183]
    v_add_u32 v13, s70, v15
    v_mfma_f32_16x16x32_bf16 v[164:167], v[52:55], v[24:27], v[164:167]
    v_mfma_f32_16x16x32_bf16 v[148:151], v[52:55], v[20:23], v[148:151]
    v_mfma_f32_16x16x32_bf16 v[132:135], v[52:55], v[16:19], v[132:135]
    v_mfma_f32_16x16x32_bf16 v[136:139], v[56:59], v[16:19], v[136:139]
    v_mfma_f32_16x16x32_bf16 v[152:155], v[56:59], v[20:23], v[152:155]
    v_mfma_f32_16x16x32_bf16 v[168:171], v[56:59], v[24:27], v[168:171]
    v_mfma_f32_16x16x32_bf16 v[184:187], v[56:59], v[28:31], v[184:187]
    v_mfma_f32_16x16x32_bf16 v[200:203], v[56:59], v[32:35], v[200:203]
    v_mfma_f32_16x16x32_bf16 v[216:219], v[56:59], v[36:39], v[216:219]
    v_mfma_f32_16x16x32_bf16 v[232:235], v[56:59], v[40:43], v[232:235]
    v_mfma_f32_16x16x32_bf16 v[248:251], v[56:59], v[44:47], v[248:251]
    v_mfma_f32_16x16x32_bf16 v[252:255], v[60:63], v[44:47], v[252:255]
    v_mfma_f32_16x16x32_bf16 v[236:239], v[60:63], v[40:43], v[236:239]
    v_mfma_f32_16x16x32_bf16 v[220:223], v[60:63], v[36:39], v[220:223]
    v_mfma_f32_16x16x32_bf16 v[204:207], v[60:63], v[32:35], v[204:207]
    v_mfma_f32_16x16x32_bf16 v[188:191], v[60:63], v[28:31], v[188:191]
    v_mfma_f32_16x16x32_bf16 v[172:175], v[60:63], v[24:27], v[172:175]
    v_mfma_f32_16x16x32_bf16 v[156:159], v[60:63], v[20:23], v[156:159]
    v_mfma_f32_16x16x32_bf16 v[140:143], v[60:63], v[16:19], v[140:143]
    s_waitcnt lgkmcnt(0)
    v_mfma_f32_16x16x32_bf16 v[128:131], v[96:99], v[64:67], v[128:131]
    s_barrier
    v_mfma_f32_16x16x32_bf16 v[144:147], v[96:99], v[68:71], v[144:147]
    ds_read_b64_tr_b16 v[48:49], v6 offset:0
    v_mfma_f32_16x16x32_bf16 v[160:163], v[96:99], v[72:75], v[160:163]
    ds_read_b64_tr_b16 v[50:51], v6 offset:2048
    v_mfma_f32_16x16x32_bf16 v[176:179], v[96:99], v[76:79], v[176:179]
    ds_read_b128 v[16:19], v4 offset:0
    v_mfma_f32_16x16x32_bf16 v[192:195], v[96:99], v[80:83], v[192:195]
    ds_read_b64_tr_b16 v[52:53], v7 offset:0
    v_mfma_f32_16x16x32_bf16 v[208:211], v[96:99], v[84:87], v[208:211]
    ds_read_b64_tr_b16 v[54:55], v7 offset:2048
    v_mfma_f32_16x16x32_bf16 v[224:227], v[96:99], v[88:91], v[224:227]
    ds_read_b128 v[20:23], v4 offset:2048
    v_mfma_f32_16x16x32_bf16 v[240:243], v[96:99], v[92:95], v[240:243]
    ds_read_b64_tr_b16 v[56:57], v12 offset:0
    v_mfma_f32_16x16x32_bf16 v[244:247], v[100:103], v[92:95], v[244:247]
    ds_read_b64_tr_b16 v[58:59], v12 offset:2048
    v_mfma_f32_16x16x32_bf16 v[228:231], v[100:103], v[88:91], v[228:231]
    ds_read_b128 v[24:27], v4 offset:4096
    v_mfma_f32_16x16x32_bf16 v[212:215], v[100:103], v[84:87], v[212:215]
    ds_read_b64_tr_b16 v[60:61], v13 offset:0
    v_mfma_f32_16x16x32_bf16 v[196:199], v[100:103], v[80:83], v[196:199]
    ds_read_b64_tr_b16 v[62:63], v13 offset:2048
    v_mfma_f32_16x16x32_bf16 v[180:183], v[100:103], v[76:79], v[180:183]
    ds_read_b128 v[28:31], v4 offset:6144
    v_mfma_f32_16x16x32_bf16 v[164:167], v[100:103], v[72:75], v[164:167]
    ds_read_b128 v[32:35], v4 offset:8192
    v_mfma_f32_16x16x32_bf16 v[148:151], v[100:103], v[68:71], v[148:151]
    ds_read_b128 v[36:39], v4 offset:10240
    v_mfma_f32_16x16x32_bf16 v[132:135], v[100:103], v[64:67], v[132:135]
    ds_read_b128 v[40:43], v4 offset:12288
    v_mfma_f32_16x16x32_bf16 v[136:139], v[104:107], v[64:67], v[136:139]
    ds_read_b128 v[44:47], v4 offset:14336
    v_mfma_f32_16x16x32_bf16 v[152:155], v[104:107], v[68:71], v[152:155]
    v_mfma_f32_16x16x32_bf16 v[168:171], v[104:107], v[72:75], v[168:171]
    v_mfma_f32_16x16x32_bf16 v[184:187], v[104:107], v[76:79], v[184:187]
    v_mfma_f32_16x16x32_bf16 v[200:203], v[104:107], v[80:83], v[200:203]
    v_mfma_f32_16x16x32_bf16 v[216:219], v[104:107], v[84:87], v[216:219]
    v_mfma_f32_16x16x32_bf16 v[232:235], v[104:107], v[88:91], v[232:235]
    v_mfma_f32_16x16x32_bf16 v[248:251], v[104:107], v[92:95], v[248:251]
    v_mfma_f32_16x16x32_bf16 v[252:255], v[108:111], v[92:95], v[252:255]
    v_mfma_f32_16x16x32_bf16 v[236:239], v[108:111], v[88:91], v[236:239]
    v_mfma_f32_16x16x32_bf16 v[220:223], v[108:111], v[84:87], v[220:223]
    v_mfma_f32_16x16x32_bf16 v[204:207], v[108:111], v[80:83], v[204:207]
    v_mfma_f32_16x16x32_bf16 v[188:191], v[108:111], v[76:79], v[188:191]
    v_mfma_f32_16x16x32_bf16 v[172:175], v[108:111], v[72:75], v[172:175]
    v_mfma_f32_16x16x32_bf16 v[156:159], v[108:111], v[68:71], v[156:159]
    v_mfma_f32_16x16x32_bf16 v[140:143], v[108:111], v[64:67], v[140:143]
    s_sub_u32 s67, s67, 1
    s_cmp_lg_u32 s67, 0
    s_cbranch_scc1 L_sl_65
    s_cmp_lg_u32 s81, 0
    s_cbranch_scc1 L_sn_66
    s_cmp_lg_u32 s60, 0
    s_cbranch_scc1 L_w0_67
    s_add_u32 s48, s26, 0x2700000
    s_addc_u32 s49, s27, 0
    s_mov_b32 s50, 0x8000
    s_mov_b32 s51, 0x20000
    s_lshl_b32 s71, s77, 7
    s_add_u32 s71, s71, 12288
    v_mov_b32 v2, s71
    v_mov_b32 v3, 1
    s_mov_b64 exec, 1
    buffer_atomic_add v3, v2, s[48:51], 0 offen sc1
    s_mov_b64 exec, -1
L_w0_67:
    s_mov_b32 s81, 1
    s_mov_b32 s67, 14
    s_branch L_sl_65
L_sn_66:
    s_waitcnt lgkmcnt(0)
    v_and_b32 v2, 15, v1
    v_lshlrev_b32 v3, 4, v2
    v_add_u32 v3, 150080, v3
    ds_read_b128 v[16:19], v3 offset:0
    ds_read_b128 v[20:23], v3 offset:256
    ds_read_b128 v[24:27], v3 offset:512
    ds_read_b128 v[28:31], v3 offset:768
    ds_read_b128 v[32:35], v3 offset:1024
    ds_read_b128 v[36:39], v3 offset:1280
    ds_read_b128 v[40:43], v3 offset:1536
    ds_read_b128 v[44:47], v3 offset:1792
    v_lshrrev_b32 v2, 4, v1
    v_lshlrev_b32 v3, 4, v2
    s_lshl_b32 s71, s60, 8
    s_add_u32 s71, s71, 148480
    v_add_u32 v3, s71, v3
    ds_read_b128 v[48:51], v3 offset:0
    ds_read_b128 v[52:55], v3 offset:64
    ds_read_b128 v[56:59], v3 offset:128
    ds_read_b128 v[60:63], v3 offset:192
    s_lshr_b32 s72, s79, 2
    s_lshl_b32 s72, s72, 12
    s_lshl_b32 s71, s60, 15
    s_add_u32 s71, s71, s72
    v_lshrrev_b32 v14, 4, v1
    v_and_b32 v2, 15, v1
    v_lshrrev_b32 v3, 1, v2
    v_lshrrev_b32 v15, 1, v14
    v_xor_b32 v3, v3, v15
    v_and_b32 v15, 1, v14
    v_lshlrev_b32 v15, 3, v15
    v_lshl_add_u32 v15, v2, 7, v15
    v_add_u32 v15, s71, v15
    v_xor_b32 v4, 0, v3
    v_lshl_add_u32 v4, v4, 4, v15
    v_xor_b32 v5, 2, v3
    v_lshl_add_u32 v5, v5, 4, v15
    v_xor_b32 v6, 4, v3
    v_lshl_add_u32 v6, v6, 4, v15
    v_xor_b32 v7, 6, v3
    v_lshl_add_u32 v7, v7, 4, v15
    v_lshrrev_b32 v2, 3, v1
    v_and_b32 v3, 7, v1
    v_xor_b32 v15, v3, v14
    v_lshlrev_b32 v15, 4, v15
    v_lshl_add_u32 v15, v2, 7, v15
    v_add_u32 v8, s71, v15
    v_xor_b32 v9, 64, v8
    s_add_u32 s73, s61, 0
    v_add_u32 v2, s73, v2
    s_mov_b32 s72, 7168
    v_mul_lo_u32 v2, v2, s72
    v_lshl_add_u32 v2, v3, 4, v2
    s_lshl_b32 s74, s60, 6
    s_add_u32 s74, s74, s62
    s_lshl_b32 s74, s74, 1
    v_add_u32 v10, s74, v2
    s_waitcnt lgkmcnt(0)
    v_pk_fma_f32 v[128:129], v[48:49], v[16:17], v[128:129] op_sel:[0,0,0] op_sel_hi:[1,0,1]
    v_pk_fma_f32 v[130:131], v[50:51], v[16:17], v[130:131] op_sel:[0,0,0] op_sel_hi:[1,0,1]
    v_pk_fma_f32 v[132:133], v[52:53], v[16:17], v[132:133] op_sel:[0,0,0] op_sel_hi:[1,0,1]
    v_pk_fma_f32 v[134:135], v[54:55], v[16:17], v[134:135] op_sel:[0,0,0] op_sel_hi:[1,0,1]
    v_pk_fma_f32 v[136:137], v[56:57], v[16:17], v[136:137] op_sel:[0,0,0] op_sel_hi:[1,0,1]
    v_pk_fma_f32 v[138:139], v[58:59], v[16:17], v[138:139] op_sel:[0,0,0] op_sel_hi:[1,0,1]
    v_pk_fma_f32 v[140:141], v[60:61], v[16:17], v[140:141] op_sel:[0,0,0] op_sel_hi:[1,0,1]
    v_pk_fma_f32 v[142:143], v[62:63], v[16:17], v[142:143] op_sel:[0,0,0] op_sel_hi:[1,0,1]
    v_pk_mul_f32 v[64:65], v[128:129], v[128:129]
    v_pk_mul_f32 v[66:67], v[130:131], v[130:131]
    v_pk_mul_f32 v[68:69], v[132:133], v[132:133]
    v_pk_mul_f32 v[70:71], v[134:135], v[134:135]
    v_pk_mul_f32 v[72:73], v[136:137], v[136:137]
    v_pk_mul_f32 v[74:75], v[138:139], v[138:139]
    v_pk_mul_f32 v[76:77], v[140:141], v[140:141]
    v_pk_mul_f32 v[78:79], v[142:143], v[142:143]
    v_pk_fma_f32 v[64:65], v[64:65], v[16:17], v[18:19] op_sel:[0,1,0] op_sel_hi:[1,1,0]
    v_pk_fma_f32 v[66:67], v[66:67], v[16:17], v[18:19] op_sel:[0,1,0] op_sel_hi:[1,1,0]
    v_pk_fma_f32 v[68:69], v[68:69], v[16:17], v[18:19] op_sel:[0,1,0] op_sel_hi:[1,1,0]
    v_pk_fma_f32 v[70:71], v[70:71], v[16:17], v[18:19] op_sel:[0,1,0] op_sel_hi:[1,1,0]
    v_pk_fma_f32 v[72:73], v[72:73], v[16:17], v[18:19] op_sel:[0,1,0] op_sel_hi:[1,1,0]
    v_pk_fma_f32 v[74:75], v[74:75], v[16:17], v[18:19] op_sel:[0,1,0] op_sel_hi:[1,1,0]
    v_pk_fma_f32 v[76:77], v[76:77], v[16:17], v[18:19] op_sel:[0,1,0] op_sel_hi:[1,1,0]
    v_pk_fma_f32 v[78:79], v[78:79], v[16:17], v[18:19] op_sel:[0,1,0] op_sel_hi:[1,1,0]
    v_pk_mul_f32 v[64:65], v[64:65], v[128:129]
    v_pk_mul_f32 v[66:67], v[66:67], v[130:131]
    v_pk_mul_f32 v[68:69], v[68:69], v[132:133]
    v_pk_mul_f32 v[70:71], v[70:71], v[134:135]
    v_pk_mul_f32 v[72:73], v[72:73], v[136:137]
    v_pk_mul_f32 v[74:75], v[74:75], v[138:139]
    v_pk_mul_f32 v[76:77], v[76:77], v[140:141]
    v_pk_mul_f32 v[78:79], v[78:79], v[142:143]
    v_exp_f32 v64, v64
    v_exp_f32 v65, v65
    v_exp_f32 v66, v66
    v_exp_f32 v67, v67
    v_exp_f32 v68, v68
    v_exp_f32 v69, v69
    v_exp_f32 v70, v70
    v_exp_f32 v71, v71
    v_exp_f32 v72, v72
    v_exp_f32 v73, v73
    v_exp_f32 v74, v74
    v_exp_f32 v75, v75
    v_exp_f32 v76, v76
    v_exp_f32 v77, v77
    v_exp_f32 v78, v78
    v_exp_f32 v79, v79
    v_pk_fma_f32 v[64:65], v[64:65], v[18:19], v[18:19] op_sel:[0,1,1] op_sel_hi:[1,1,1]
    v_pk_fma_f32 v[66:67], v[66:67], v[18:19], v[18:19] op_sel:[0,1,1] op_sel_hi:[1,1,1]
    v_pk_fma_f32 v[68:69], v[68:69], v[18:19], v[18:19] op_sel:[0,1,1] op_sel_hi:[1,1,1]
    v_pk_fma_f32 v[70:71], v[70:71], v[18:19], v[18:19] op_sel:[0,1,1] op_sel_hi:[1,1,1]
    v_pk_fma_f32 v[72:73], v[72:73], v[18:19], v[18:19] op_sel:[0,1,1] op_sel_hi:[1,1,1]
    v_pk_fma_f32 v[74:75], v[74:75], v[18:19], v[18:19] op_sel:[0,1,1] op_sel_hi:[1,1,1]
    v_pk_fma_f32 v[76:77], v[76:77], v[18:19], v[18:19] op_sel:[0,1,1] op_sel_hi:[1,1,1]
    v_pk_fma_f32 v[78:79], v[78:79], v[18:19], v[18:19] op_sel:[0,1,1] op_sel_hi:[1,1,1]
    v_rcp_f32 v64, v64
    v_rcp_f32 v65, v65
    v_rcp_f32 v66, v66
    v_rcp_f32 v67, v67
    v_rcp_f32 v68, v68
    v_rcp_f32 v69, v69
    v_rcp_f32 v70, v70
    v_rcp_f32 v71, v71
    v_rcp_f32 v72, v72
    v_rcp_f32 v73, v73
    v_rcp_f32 v74, v74
    v_rcp_f32 v75, v75
    v_rcp_f32 v76, v76
    v_rcp_f32 v77, v77
    v_rcp_f32 v78, v78
    v_rcp_f32 v79, v79
    v_pk_mul_f32 v[128:129], v[128:129], v[64:65]
    v_pk_mul_f32 v[130:131], v[130:131], v[66:67]
    v_pk_mul_f32 v[132:133], v[132:133], v[68:69]
    v_pk_mul_f32 v[134:135], v[134:135], v[70:71]
    v_pk_mul_f32 v[136:137], v[136:137], v[72:73]
    v_pk_mul_f32 v[138:139], v[138:139], v[74:75]
    v_pk_mul_f32 v[140:141], v[140:141], v[76:77]
    v_pk_mul_f32 v[142:143], v[142:143], v[78:79]
    v_cvt_pk_bf16_f32 v96, v128, v129
    v_cvt_pk_bf16_f32 v97, v130, v131
    v_cvt_pk_bf16_f32 v98, v132, v133
    v_cvt_pk_bf16_f32 v99, v134, v135
    v_cvt_pk_bf16_f32 v100, v136, v137
    v_cvt_pk_bf16_f32 v101, v138, v139
    v_cvt_pk_bf16_f32 v102, v140, v141
    v_cvt_pk_bf16_f32 v103, v142, v143
    ds_write_b64 v4, v[96:97] offset:0
    ds_write_b64 v5, v[98:99] offset:0
    ds_write_b64 v6, v[100:101] offset:0
    ds_write_b64 v7, v[102:103] offset:0
    ds_read_b128 v[80:83], v8 offset:0
    ds_read_b128 v[84:87], v9 offset:1024
    v_pk_fma_f32 v[144:145], v[48:49], v[20:21], v[144:145] op_sel:[0,0,0] op_sel_hi:[1,0,1]
    v_pk_fma_f32 v[146:147], v[50:51], v[20:21], v[146:147] op_sel:[0,0,0] op_sel_hi:[1,0,1]
    v_pk_fma_f32 v[148:149], v[52:53], v[20:21], v[148:149] op_sel:[0,0,0] op_sel_hi:[1,0,1]
    v_pk_fma_f32 v[150:151], v[54:55], v[20:21], v[150:151] op_sel:[0,0,0] op_sel_hi:[1,0,1]
    v_pk_fma_f32 v[152:153], v[56:57], v[20:21], v[152:153] op_sel:[0,0,0] op_sel_hi:[1,0,1]
    v_pk_fma_f32 v[154:155], v[58:59], v[20:21], v[154:155] op_sel:[0,0,0] op_sel_hi:[1,0,1]
    v_pk_fma_f32 v[156:157], v[60:61], v[20:21], v[156:157] op_sel:[0,0,0] op_sel_hi:[1,0,1]
    v_pk_fma_f32 v[158:159], v[62:63], v[20:21], v[158:159] op_sel:[0,0,0] op_sel_hi:[1,0,1]
    v_pk_mul_f32 v[64:65], v[144:145], v[144:145]
    v_pk_mul_f32 v[66:67], v[146:147], v[146:147]
    v_pk_mul_f32 v[68:69], v[148:149], v[148:149]
    v_pk_mul_f32 v[70:71], v[150:151], v[150:151]
    v_pk_mul_f32 v[72:73], v[152:153], v[152:153]
    v_pk_mul_f32 v[74:75], v[154:155], v[154:155]
    v_pk_mul_f32 v[76:77], v[156:157], v[156:157]
    v_pk_mul_f32 v[78:79], v[158:159], v[158:159]
    s_waitcnt lgkmcnt(0)
    v_add_u32 v12, 0x0, v10
    v_add_u32 v13, 0xe000, v10
    buffer_store_dwordx4 v[80:83], v12, s[36:39], 0 offen sc1
    buffer_store_dwordx4 v[84:87], v13, s[36:39], 0 offen sc1
    v_pk_fma_f32 v[64:65], v[64:65], v[20:21], v[22:23] op_sel:[0,1,0] op_sel_hi:[1,1,0]
    v_pk_fma_f32 v[66:67], v[66:67], v[20:21], v[22:23] op_sel:[0,1,0] op_sel_hi:[1,1,0]
    v_pk_fma_f32 v[68:69], v[68:69], v[20:21], v[22:23] op_sel:[0,1,0] op_sel_hi:[1,1,0]
    v_pk_fma_f32 v[70:71], v[70:71], v[20:21], v[22:23] op_sel:[0,1,0] op_sel_hi:[1,1,0]
    v_pk_fma_f32 v[72:73], v[72:73], v[20:21], v[22:23] op_sel:[0,1,0] op_sel_hi:[1,1,0]
    v_pk_fma_f32 v[74:75], v[74:75], v[20:21], v[22:23] op_sel:[0,1,0] op_sel_hi:[1,1,0]
    v_pk_fma_f32 v[76:77], v[76:77], v[20:21], v[22:23] op_sel:[0,1,0] op_sel_hi:[1,1,0]
    v_pk_fma_f32 v[78:79], v[78:79], v[20:21], v[22:23] op_sel:[0,1,0] op_sel_hi:[1,1,0]
    v_pk_mul_f32 v[64:65], v[64:65], v[144:145]
    v_pk_mul_f32 v[66:67], v[66:67], v[146:147]
    v_pk_mul_f32 v[68:69], v[68:69], v[148:149]
    v_pk_mul_f32 v[70:71], v[70:71], v[150:151]
    v_pk_mul_f32 v[72:73], v[72:73], v[152:153]
    v_pk_mul_f32 v[74:75], v[74:75], v[154:155]
    v_pk_mul_f32 v[76:77], v[76:77], v[156:157]
    v_pk_mul_f32 v[78:79], v[78:79], v[158:159]
    v_exp_f32 v64, v64
    v_exp_f32 v65, v65
    v_exp_f32 v66, v66
    v_exp_f32 v67, v67
    v_exp_f32 v68, v68
    v_exp_f32 v69, v69
    v_exp_f32 v70, v70
    v_exp_f32 v71, v71
    v_exp_f32 v72, v72
    v_exp_f32 v73, v73
    v_exp_f32 v74, v74
    v_exp_f32 v75, v75
    v_exp_f32 v76, v76
    v_exp_f32 v77, v77
    v_exp_f32 v78, v78
    v_exp_f32 v79, v79
    v_pk_fma_f32 v[64:65], v[64:65], v[22:23], v[22:23] op_sel:[0,1,1] op_sel_hi:[1,1,1]
    v_pk_fma_f32 v[66:67], v[66:67], v[22:23], v[22:23] op_sel:[0,1,1] op_sel_hi:[1,1,1]
    v_pk_fma_f32 v[68:69], v[68:69], v[22:23], v[22:23] op_sel:[0,1,1] op_sel_hi:[1,1,1]
    v_pk_fma_f32 v[70:71], v[70:71], v[22:23], v[22:23] op_sel:[0,1,1] op_sel_hi:[1,1,1]
    v_pk_fma_f32 v[72:73], v[72:73], v[22:23], v[22:23] op_sel:[0,1,1] op_sel_hi:[1,1,1]
    v_pk_fma_f32 v[74:75], v[74:75], v[22:23], v[22:23] op_sel:[0,1,1] op_sel_hi:[1,1,1]
    v_pk_fma_f32 v[76:77], v[76:77], v[22:23], v[22:23] op_sel:[0,1,1] op_sel_hi:[1,1,1]
    v_pk_fma_f32 v[78:79], v[78:79], v[22:23], v[22:23] op_sel:[0,1,1] op_sel_hi:[1,1,1]
    v_rcp_f32 v64, v64
    v_rcp_f32 v65, v65
    v_rcp_f32 v66, v66
    v_rcp_f32 v67, v67
    v_rcp_f32 v68, v68
    v_rcp_f32 v69, v69
    v_rcp_f32 v70, v70
    v_rcp_f32 v71, v71
    v_rcp_f32 v72, v72
    v_rcp_f32 v73, v73
    v_rcp_f32 v74, v74
    v_rcp_f32 v75, v75
    v_rcp_f32 v76, v76
    v_rcp_f32 v77, v77
    v_rcp_f32 v78, v78
    v_rcp_f32 v79, v79
    v_pk_mul_f32 v[144:145], v[144:145], v[64:65]
    v_pk_mul_f32 v[146:147], v[146:147], v[66:67]
    v_pk_mul_f32 v[148:149], v[148:149], v[68:69]
    v_pk_mul_f32 v[150:151], v[150:151], v[70:71]
    v_pk_mul_f32 v[152:153], v[152:153], v[72:73]
    v_pk_mul_f32 v[154:155], v[154:155], v[74:75]
    v_pk_mul_f32 v[156:157], v[156:157], v[76:77]
    v_pk_mul_f32 v[158:159], v[158:159], v[78:79]
    v_cvt_pk_bf16_f32 v104, v144, v145
    v_cvt_pk_bf16_f32 v105, v146, v147
    v_cvt_pk_bf16_f32 v106, v148, v149
    v_cvt_pk_bf16_f32 v107, v150, v151
    v_cvt_pk_bf16_f32 v108, v152, v153
    v_cvt_pk_bf16_f32 v109, v154, v155
    v_cvt_pk_bf16_f32 v110, v156, v157
    v_cvt_pk_bf16_f32 v111, v158, v159
    ds_write_b64 v4, v[104:105] offset:2048
    ds_write_b64 v5, v[106:107] offset:2048
    ds_write_b64 v6, v[108:109] offset:2048
    ds_write_b64 v7, v[110:111] offset:2048
    ds_read_b128 v[88:91], v8 offset:2048
    ds_read_b128 v[92:95], v9 offset:3072
    v_pk_fma_f32 v[160:161], v[48:49], v[24:25], v[160:161] op_sel:[0,0,0] op_sel_hi:[1,0,1]
    v_pk_fma_f32 v[162:163], v[50:51], v[24:25], v[162:163] op_sel:[0,0,0] op_sel_hi:[1,0,1]
    v_pk_fma_f32 v[164:165], v[52:53], v[24:25], v[164:165] op_sel:[0,0,0] op_sel_hi:[1,0,1]
    v_pk_fma_f32 v[166:167], v[54:55], v[24:25], v[166:167] op_sel:[0,0,0] op_sel_hi:[1,0,1]
    v_pk_fma_f32 v[168:169], v[56:57], v[24:25], v[168:169] op_sel:[0,0,0] op_sel_hi:[1,0,1]
    v_pk_fma_f32 v[170:171], v[58:59], v[24:25], v[170:171] op_sel:[0,0,0] op_sel_hi:[1,0,1]
    v_pk_fma_f32 v[172:173], v[60:61], v[24:25], v[172:173] op_sel:[0,0,0] op_sel_hi:[1,0,1]
    v_pk_fma_f32 v[174:175], v[62:63], v[24:25], v[174:175] op_sel:[0,0,0] op_sel_hi:[1,0,1]
    v_pk_mul_f32 v[64:65], v[160:161], v[160:161]
    v_pk_mul_f32 v[66:67], v[162:163], v[162:163]
    v_pk_mul_f32 v[68:69], v[164:165], v[164:165]
    v_pk_mul_f32 v[70:71], v[166:167], v[166:167]
    v_pk_mul_f32 v[72:73], v[168:169], v[168:169]
    v_pk_mul_f32 v[74:75], v[170:171], v[170:171]
    v_pk_mul_f32 v[76:77], v[172:173], v[172:173]
    v_pk_mul_f32 v[78:79], v[174:175], v[174:175]
    s_waitcnt lgkmcnt(0)
    v_add_u32 v14, 0x1c000, v10
    v_add_u32 v15, 0x2a000, v10
    buffer_store_dwordx4 v[88:91], v14, s[36:39], 0 offen sc1
    buffer_store_dwordx4 v[92:95], v15, s[36:39], 0 offen sc1
    v_pk_fma_f32 v[64:65], v[64:65], v[24:25], v[26:27] op_sel:[0,1,0] op_sel_hi:[1,1,0]
    v_pk_fma_f32 v[66:67], v[66:67], v[24:25], v[26:27] op_sel:[0,1,0] op_sel_hi:[1,1,0]
    v_pk_fma_f32 v[68:69], v[68:69], v[24:25], v[26:27] op_sel:[0,1,0] op_sel_hi:[1,1,0]
    v_pk_fma_f32 v[70:71], v[70:71], v[24:25], v[26:27] op_sel:[0,1,0] op_sel_hi:[1,1,0]
    v_pk_fma_f32 v[72:73], v[72:73], v[24:25], v[26:27] op_sel:[0,1,0] op_sel_hi:[1,1,0]
    v_pk_fma_f32 v[74:75], v[74:75], v[24:25], v[26:27] op_sel:[0,1,0] op_sel_hi:[1,1,0]
    v_pk_fma_f32 v[76:77], v[76:77], v[24:25], v[26:27] op_sel:[0,1,0] op_sel_hi:[1,1,0]
    v_pk_fma_f32 v[78:79], v[78:79], v[24:25], v[26:27] op_sel:[0,1,0] op_sel_hi:[1,1,0]
    v_pk_mul_f32 v[64:65], v[64:65], v[160:161]
    v_pk_mul_f32 v[66:67], v[66:67], v[162:163]
    v_pk_mul_f32 v[68:69], v[68:69], v[164:165]
    v_pk_mul_f32 v[70:71], v[70:71], v[166:167]
    v_pk_mul_f32 v[72:73], v[72:73], v[168:169]
    v_pk_mul_f32 v[74:75], v[74:75], v[170:171]
    v_pk_mul_f32 v[76:77], v[76:77], v[172:173]
    v_pk_mul_f32 v[78:79], v[78:79], v[174:175]
    v_exp_f32 v64, v64
    v_exp_f32 v65, v65
    v_exp_f32 v66, v66
    v_exp_f32 v67, v67
    v_exp_f32 v68, v68
    v_exp_f32 v69, v69
    v_exp_f32 v70, v70
    v_exp_f32 v71, v71
    v_exp_f32 v72, v72
    v_exp_f32 v73, v73
    v_exp_f32 v74, v74
    v_exp_f32 v75, v75
    v_exp_f32 v76, v76
    v_exp_f32 v77, v77
    v_exp_f32 v78, v78
    v_exp_f32 v79, v79
    v_pk_fma_f32 v[64:65], v[64:65], v[26:27], v[26:27] op_sel:[0,1,1] op_sel_hi:[1,1,1]
    v_pk_fma_f32 v[66:67], v[66:67], v[26:27], v[26:27] op_sel:[0,1,1] op_sel_hi:[1,1,1]
    v_pk_fma_f32 v[68:69], v[68:69], v[26:27], v[26:27] op_sel:[0,1,1] op_sel_hi:[1,1,1]
    v_pk_fma_f32 v[70:71], v[70:71], v[26:27], v[26:27] op_sel:[0,1,1] op_sel_hi:[1,1,1]
    v_pk_fma_f32 v[72:73], v[72:73], v[26:27], v[26:27] op_sel:[0,1,1] op_sel_hi:[1,1,1]
    v_pk_fma_f32 v[74:75], v[74:75], v[26:27], v[26:27] op_sel:[0,1,1] op_sel_hi:[1,1,1]
    v_pk_fma_f32 v[76:77], v[76:77], v[26:27], v[26:27] op_sel:[0,1,1] op_sel_hi:[1,1,1]
    v_pk_fma_f32 v[78:79], v[78:79], v[26:27], v[26:27] op_sel:[0,1,1] op_sel_hi:[1,1,1]
    v_rcp_f32 v64, v64
    v_rcp_f32 v65, v65
    v_rcp_f32 v66, v66
    v_rcp_f32 v67, v67
    v_rcp_f32 v68, v68
    v_rcp_f32 v69, v69
    v_rcp_f32 v70, v70
    v_rcp_f32 v71, v71
    v_rcp_f32 v72, v72
    v_rcp_f32 v73, v73
    v_rcp_f32 v74, v74
    v_rcp_f32 v75, v75
    v_rcp_f32 v76, v76
    v_rcp_f32 v77, v77
    v_rcp_f32 v78, v78
    v_rcp_f32 v79, v79
    v_pk_mul_f32 v[160:161], v[160:161], v[64:65]
    v_pk_mul_f32 v[162:163], v[162:163], v[66:67]
    v_pk_mul_f32 v[164:165], v[164:165], v[68:69]
    v_pk_mul_f32 v[166:167], v[166:167], v[70:71]
    v_pk_mul_f32 v[168:169], v[168:169], v[72:73]
    v_pk_mul_f32 v[170:171], v[170:171], v[74:75]
    v_pk_mul_f32 v[172:173], v[172:173], v[76:77]
    v_pk_mul_f32 v[174:175], v[174:175], v[78:79]
    v_xor_b32 v4, 0x1000, v4
    v_xor_b32 v5, 0x1000, v5
    v_xor_b32 v6, 0x1000, v6
    v_xor_b32 v7, 0x1000, v7
    v_xor_b32 v8, 0x1000, v8
    v_xor_b32 v9, 0x1000, v9
    v_cvt_pk_bf16_f32 v96, v160, v161
    v_cvt_pk_bf16_f32 v97, v162, v163
    v_cvt_pk_bf16_f32 v98, v164, v165
    v_cvt_pk_bf16_f32 v99, v166, v167
    v_cvt_pk_bf16_f32 v100, v168, v169
    v_cvt_pk_bf16_f32 v101, v170, v171
    v_cvt_pk_bf16_f32 v102, v172, v173
    v_cvt_pk_bf16_f32 v103, v174, v175
    ds_write_b64 v4, v[96:97] offset:0
    ds_write_b64 v5, v[98:99] offset:0
    ds_write_b64 v6, v[100:101] offset:0
    ds_write_b64 v7, v[102:103] offset:0
    ds_read_b128 v[80:83], v8 offset:0
    ds_read_b128 v[84:87], v9 offset:1024
    v_pk_fma_f32 v[176:177], v[48:49], v[28:29], v[176:177] op_sel:[0,0,0] op_sel_hi:[1,0,1]
    v_pk_fma_f32 v[178:179], v[50:51], v[28:29], v[178:179] op_sel:[0,0,0] op_sel_hi:[1,0,1]
    v_pk_fma_f32 v[180:181], v[52:53], v[28:29], v[180:181] op_sel:[0,0,0] op_sel_hi:[1,0,1]
    v_pk_fma_f32 v[182:183], v[54:55], v[28:29], v[182:183] op_sel:[0,0,0] op_sel_hi:[1,0,1]
    v_pk_fma_f32 v[184:185], v[56:57], v[28:29], v[184:185] op_sel:[0,0,0] op_sel_hi:[1,0,1]
    v_pk_fma_f32 v[186:187], v[58:59], v[28:29], v[186:187] op_sel:[0,0,0] op_sel_hi:[1,0,1]
    v_pk_fma_f32 v[188:189], v[60:61], v[28:29], v[188:189] op_sel:[0,0,0] op_sel_hi:[1,0,1]
    v_pk_fma_f32 v[190:191], v[62:63], v[28:29], v[190:191] op_sel:[0,0,0] op_sel_hi:[1,0,1]
    v_pk_mul_f32 v[64:65], v[176:177], v[176:177]
    v_pk_mul_f32 v[66:67], v[178:179], v[178:179]
    v_pk_mul_f32 v[68:69], v[180:181], v[180:181]
    v_pk_mul_f32 v[70:71], v[182:183], v[182:183]
    v_pk_mul_f32 v[72:73], v[184:185], v[184:185]
    v_pk_mul_f32 v[74:75], v[186:187], v[186:187]
    v_pk_mul_f32 v[76:77], v[188:189], v[188:189]
    v_pk_mul_f32 v[78:79], v[190:191], v[190:191]
    s_waitcnt lgkmcnt(0)
    v_add_u32 v12, 0x38000, v10
    v_add_u32 v13, 0x46000, v10
    buffer_store_dwordx4 v[80:83], v12, s[36:39], 0 offen sc1
    buffer_store_dwordx4 v[84:87], v13, s[36:39], 0 offen sc1
    v_pk_fma_f32 v[64:65], v[64:65], v[28:29], v[30:31] op_sel:[0,1,0] op_sel_hi:[1,1,0]
    v_pk_fma_f32 v[66:67], v[66:67], v[28:29], v[30:31] op_sel:[0,1,0] op_sel_hi:[1,1,0]
    v_pk_fma_f32 v[68:69], v[68:69], v[28:29], v[30:31] op_sel:[0,1,0] op_sel_hi:[1,1,0]
    v_pk_fma_f32 v[70:71], v[70:71], v[28:29], v[30:31] op_sel:[0,1,0] op_sel_hi:[1,1,0]
    v_pk_fma_f32 v[72:73], v[72:73], v[28:29], v[30:31] op_sel:[0,1,0] op_sel_hi:[1,1,0]
    v_pk_fma_f32 v[74:75], v[74:75], v[28:29], v[30:31] op_sel:[0,1,0] op_sel_hi:[1,1,0]
    v_pk_fma_f32 v[76:77], v[76:77], v[28:29], v[30:31] op_sel:[0,1,0] op_sel_hi:[1,1,0]
    v_pk_fma_f32 v[78:79], v[78:79], v[28:29], v[30:31] op_sel:[0,1,0] op_sel_hi:[1,1,0]
    v_pk_mul_f32 v[64:65], v[64:65], v[176:177]
    v_pk_mul_f32 v[66:67], v[66:67], v[178:179]
    v_pk_mul_f32 v[68:69], v[68:69], v[180:181]
    v_pk_mul_f32 v[70:71], v[70:71], v[182:183]
    v_pk_mul_f32 v[72:73], v[72:73], v[184:185]
    v_pk_mul_f32 v[74:75], v[74:75], v[186:187]
    v_pk_mul_f32 v[76:77], v[76:77], v[188:189]
    v_pk_mul_f32 v[78:79], v[78:79], v[190:191]
    v_exp_f32 v64, v64
    v_exp_f32 v65, v65
    v_exp_f32 v66, v66
    v_exp_f32 v67, v67
    v_exp_f32 v68, v68
    v_exp_f32 v69, v69
    v_exp_f32 v70, v70
    v_exp_f32 v71, v71
    v_exp_f32 v72, v72
    v_exp_f32 v73, v73
    v_exp_f32 v74, v74
    v_exp_f32 v75, v75
    v_exp_f32 v76, v76
    v_exp_f32 v77, v77
    v_exp_f32 v78, v78
    v_exp_f32 v79, v79
    v_pk_fma_f32 v[64:65], v[64:65], v[30:31], v[30:31] op_sel:[0,1,1] op_sel_hi:[1,1,1]
    v_pk_fma_f32 v[66:67], v[66:67], v[30:31], v[30:31] op_sel:[0,1,1] op_sel_hi:[1,1,1]
    v_pk_fma_f32 v[68:69], v[68:69], v[30:31], v[30:31] op_sel:[0,1,1] op_sel_hi:[1,1,1]
    v_pk_fma_f32 v[70:71], v[70:71], v[30:31], v[30:31] op_sel:[0,1,1] op_sel_hi:[1,1,1]
    v_pk_fma_f32 v[72:73], v[72:73], v[30:31], v[30:31] op_sel:[0,1,1] op_sel_hi:[1,1,1]
    v_pk_fma_f32 v[74:75], v[74:75], v[30:31], v[30:31] op_sel:[0,1,1] op_sel_hi:[1,1,1]
    v_pk_fma_f32 v[76:77], v[76:77], v[30:31], v[30:31] op_sel:[0,1,1] op_sel_hi:[1,1,1]
    v_pk_fma_f32 v[78:79], v[78:79], v[30:31], v[30:31] op_sel:[0,1,1] op_sel_hi:[1,1,1]
    v_rcp_f32 v64, v64
    v_rcp_f32 v65, v65
    v_rcp_f32 v66, v66
    v_rcp_f32 v67, v67
    v_rcp_f32 v68, v68
    v_rcp_f32 v69, v69
    v_rcp_f32 v70, v70
    v_rcp_f32 v71, v71
    v_rcp_f32 v72, v72
    v_rcp_f32 v73, v73
    v_rcp_f32 v74, v74
    v_rcp_f32 v75, v75
    v_rcp_f32 v76, v76
    v_rcp_f32 v77, v77
    v_rcp_f32 v78, v78
    v_rcp_f32 v79, v79
    v_pk_mul_f32 v[176:177], v[176:177], v[64:65]
    v_pk_mul_f32 v[178:179], v[178:179], v[66:67]
    v_pk_mul_f32 v[180:181], v[180:181], v[68:69]
    v_pk_mul_f32 v[182:183], v[182:183], v[70:71]
    v_pk_mul_f32 v[184:185], v[184:185], v[72:73]
    v_pk_mul_f32 v[186:187], v[186:187], v[74:75]
    v_pk_mul_f32 v[188:189], v[188:189], v[76:77]
    v_pk_mul_f32 v[190:191], v[190:191], v[78:79]
    v_cvt_pk_bf16_f32 v104, v176, v177
    v_cvt_pk_bf16_f32 v105, v178, v179
    v_cvt_pk_bf16_f32 v106, v180, v181
    v_cvt_pk_bf16_f32 v107, v182, v183
    v_cvt_pk_bf16_f32 v108, v184, v185
    v_cvt_pk_bf16_f32 v109, v186, v187
    v_cvt_pk_bf16_f32 v110, v188, v189
    v_cvt_pk_bf16_f32 v111, v190, v191
    ds_write_b64 v4, v[104:105] offset:2048
    ds_write_b64 v5, v[106:107] offset:2048
    ds_write_b64 v6, v[108:109] offset:2048
    ds_write_b64 v7, v[110:111] offset:2048
    ds_read_b128 v[88:91], v8 offset:2048
    ds_read_b128 v[92:95], v9 offset:3072
    v_pk_fma_f32 v[192:193], v[48:49], v[32:33], v[192:193] op_sel:[0,0,0] op_sel_hi:[1,0,1]
    v_pk_fma_f32 v[194:195], v[50:51], v[32:33], v[194:195] op_sel:[0,0,0] op_sel_hi:[1,0,1]
    v_pk_fma_f32 v[196:197], v[52:53], v[32:33], v[196:197] op_sel:[0,0,0] op_sel_hi:[1,0,1]
    v_pk_fma_f32 v[198:199], v[54:55], v[32:33], v[198:199] op_sel:[0,0,0] op_sel_hi:[1,0,1]
    v_pk_fma_f32 v[200:201], v[56:57], v[32:33], v[200:201] op_sel:[0,0,0] op_sel_hi:[1,0,1]
    v_pk_fma_f32 v[202:203], v[58:59], v[32:33], v[202:203] op_sel:[0,0,0] op_sel_hi:[1,0,1]
    v_pk_fma_f32 v[204:205], v[60:61], v[32:33], v[204:205] op_sel:[0,0,0] op_sel_hi:[1,0,1]
    v_pk_fma_f32 v[206:207], v[62:63], v[32:33], v[206:207] op_sel:[0,0,0] op_sel_hi:[1,0,1]
    v_pk_mul_f32 v[64:65], v[192:193], v[192:193]
    v_pk_mul_f32 v[66:67], v[194:195], v[194:195]
    v_pk_mul_f32 v[68:69], v[196:197], v[196:197]
    v_pk_mul_f32 v[70:71], v[198:199], v[198:199]
    v_pk_mul_f32 v[72:73], v[200:201], v[200:201]
    v_pk_mul_f32 v[74:75], v[202:203], v[202:203]
    v_pk_mul_f32 v[76:77], v[204:205], v[204:205]
    v_pk_mul_f32 v[78:79], v[206:207], v[206:207]
    s_waitcnt lgkmcnt(0)
    v_add_u32 v14, 0x54000, v10
    v_add_u32 v15, 0x62000, v10
    buffer_store_dwordx4 v[88:91], v14, s[36:39], 0 offen sc1
    buffer_store_dwordx4 v[92:95], v15, s[36:39], 0 offen sc1
    v_pk_fma_f32 v[64:65], v[64:65], v[32:33], v[34:35] op_sel:[0,1,0] op_sel_hi:[1,1,0]
    v_pk_fma_f32 v[66:67], v[66:67], v[32:33], v[34:35] op_sel:[0,1,0] op_sel_hi:[1,1,0]
    v_pk_fma_f32 v[68:69], v[68:69], v[32:33], v[34:35] op_sel:[0,1,0] op_sel_hi:[1,1,0]
    v_pk_fma_f32 v[70:71], v[70:71], v[32:33], v[34:35] op_sel:[0,1,0] op_sel_hi:[1,1,0]
    v_pk_fma_f32 v[72:73], v[72:73], v[32:33], v[34:35] op_sel:[0,1,0] op_sel_hi:[1,1,0]
    v_pk_fma_f32 v[74:75], v[74:75], v[32:33], v[34:35] op_sel:[0,1,0] op_sel_hi:[1,1,0]
    v_pk_fma_f32 v[76:77], v[76:77], v[32:33], v[34:35] op_sel:[0,1,0] op_sel_hi:[1,1,0]
    v_pk_fma_f32 v[78:79], v[78:79], v[32:33], v[34:35] op_sel:[0,1,0] op_sel_hi:[1,1,0]
    v_pk_mul_f32 v[64:65], v[64:65], v[192:193]
    v_pk_mul_f32 v[66:67], v[66:67], v[194:195]
    v_pk_mul_f32 v[68:69], v[68:69], v[196:197]
    v_pk_mul_f32 v[70:71], v[70:71], v[198:199]
    v_pk_mul_f32 v[72:73], v[72:73], v[200:201]
    v_pk_mul_f32 v[74:75], v[74:75], v[202:203]
    v_pk_mul_f32 v[76:77], v[76:77], v[204:205]
    v_pk_mul_f32 v[78:79], v[78:79], v[206:207]
    v_exp_f32 v64, v64
    v_exp_f32 v65, v65
    v_exp_f32 v66, v66
    v_exp_f32 v67, v67
    v_exp_f32 v68, v68
    v_exp_f32 v69, v69
    v_exp_f32 v70, v70
    v_exp_f32 v71, v71
    v_exp_f32 v72, v72
    v_exp_f32 v73, v73
    v_exp_f32 v74, v74
    v_exp_f32 v75, v75
    v_exp_f32 v76, v76
    v_exp_f32 v77, v77
    v_exp_f32 v78, v78
    v_exp_f32 v79, v79
    v_pk_fma_f32 v[64:65], v[64:65], v[34:35], v[34:35] op_sel:[0,1,1] op_sel_hi:[1,1,1]
    v_pk_fma_f32 v[66:67], v[66:67], v[34:35], v[34:35] op_sel:[0,1,1] op_sel_hi:[1,1,1]
    v_pk_fma_f32 v[68:69], v[68:69], v[34:35], v[34:35] op_sel:[0,1,1] op_sel_hi:[1,1,1]
    v_pk_fma_f32 v[70:71], v[70:71], v[34:35], v[34:35] op_sel:[0,1,1] op_sel_hi:[1,1,1]
    v_pk_fma_f32 v[72:73], v[72:73], v[34:35], v[34:35] op_sel:[0,1,1] op_sel_hi:[1,1,1]
    v_pk_fma_f32 v[74:75], v[74:75], v[34:35], v[34:35] op_sel:[0,1,1] op_sel_hi:[1,1,1]
    v_pk_fma_f32 v[76:77], v[76:77], v[34:35], v[34:35] op_sel:[0,1,1] op_sel_hi:[1,1,1]
    v_pk_fma_f32 v[78:79], v[78:79], v[34:35], v[34:35] op_sel:[0,1,1] op_sel_hi:[1,1,1]
    v_rcp_f32 v64, v64
    v_rcp_f32 v65, v65
    v_rcp_f32 v66, v66
    v_rcp_f32 v67, v67
    v_rcp_f32 v68, v68
    v_rcp_f32 v69, v69
    v_rcp_f32 v70, v70
    v_rcp_f32 v71, v71
    v_rcp_f32 v72, v72
    v_rcp_f32 v73, v73
    v_rcp_f32 v74, v74
    v_rcp_f32 v75, v75
    v_rcp_f32 v76, v76
    v_rcp_f32 v77, v77
    v_rcp_f32 v78, v78
    v_rcp_f32 v79, v79
    v_pk_mul_f32 v[192:193], v[192:193], v[64:65]
    v_pk_mul_f32 v[194:195], v[194:195], v[66:67]
    v_pk_mul_f32 v[196:197], v[196:197], v[68:69]
    v_pk_mul_f32 v[198:199], v[198:199], v[70:71]
    v_pk_mul_f32 v[200:201], v[200:201], v[72:73]
    v_pk_mul_f32 v[202:203], v[202:203], v[74:75]
    v_pk_mul_f32 v[204:205], v[204:205], v[76:77]
    v_pk_mul_f32 v[206:207], v[206:207], v[78:79]
    v_xor_b32 v4, 0x3000, v4
    v_xor_b32 v5, 0x3000, v5
    v_xor_b32 v6, 0x3000, v6
    v_xor_b32 v7, 0x3000, v7
    v_xor_b32 v8, 0x3000, v8
    v_xor_b32 v9, 0x3000, v9
    v_cvt_pk_bf16_f32 v96, v192, v193
    v_cvt_pk_bf16_f32 v97, v194, v195
    v_cvt_pk_bf16_f32 v98, v196, v197
    v_cvt_pk_bf16_f32 v99, v198, v199
    v_cvt_pk_bf16_f32 v100, v200, v201
    v_cvt_pk_bf16_f32 v101, v202, v203
    v_cvt_pk_bf16_f32 v102, v204, v205
    v_cvt_pk_bf16_f32 v103, v206, v207
    ds_write_b64 v4, v[96:97] offset:0
    ds_write_b64 v5, v[98:99] offset:0
    ds_write_b64 v6, v[100:101] offset:0
    ds_write_b64 v7, v[102:103] offset:0
    ds_read_b128 v[80:83], v8 offset:0
    ds_read_b128 v[84:87], v9 offset:1024
    v_pk_fma_f32 v[208:209], v[48:49], v[36:37], v[208:209] op_sel:[0,0,0] op_sel_hi:[1,0,1]
    v_pk_fma_f32 v[210:211], v[50:51], v[36:37], v[210:211] op_sel:[0,0,0] op_sel_hi:[1,0,1]
    v_pk_fma_f32 v[212:213], v[52:53], v[36:37], v[212:213] op_sel:[0,0,0] op_sel_hi:[1,0,1]
    v_pk_fma_f32 v[214:215], v[54:55], v[36:37], v[214:215] op_sel:[0,0,0] op_sel_hi:[1,0,1]
    v_pk_fma_f32 v[216:217], v[56:57], v[36:37], v[216:217] op_sel:[0,0,0] op_sel_hi:[1,0,1]
    v_pk_fma_f32 v[218:219], v[58:59], v[36:37], v[218:219] op_sel:[0,0,0] op_sel_hi:[1,0,1]
    v_pk_fma_f32 v[220:221], v[60:61], v[36:37], v[220:221] op_sel:[0,0,0] op_sel_hi:[1,0,1]
    v_pk_fma_f32 v[222:223], v[62:63], v[36:37], v[222:223] op_sel:[0,0,0] op_sel_hi:[1,0,1]
    v_pk_mul_f32 v[64:65], v[208:209], v[208:209]
    v_pk_mul_f32 v[66:67], v[210:211], v[210:211]
    v_pk_mul_f32 v[68:69], v[212:213], v[212:213]
    v_pk_mul_f32 v[70:71], v[214:215], v[214:215]
    v_pk_mul_f32 v[72:73], v[216:217], v[216:217]
    v_pk_mul_f32 v[74:75], v[218:219], v[218:219]
    v_pk_mul_f32 v[76:77], v[220:221], v[220:221]
    v_pk_mul_f32 v[78:79], v[222:223], v[222:223]
    s_waitcnt lgkmcnt(0)
    v_add_u32 v12, 0x70000, v10
    v_add_u32 v13, 0x7e000, v10
    buffer_store_dwordx4 v[80:83], v12, s[36:39], 0 offen sc1
    buffer_store_dwordx4 v[84:87], v13, s[36:39], 0 offen sc1
    v_pk_fma_f32 v[64:65], v[64:65], v[36:37], v[38:39] op_sel:[0,1,0] op_sel_hi:[1,1,0]
    v_pk_fma_f32 v[66:67], v[66:67], v[36:37], v[38:39] op_sel:[0,1,0] op_sel_hi:[1,1,0]
    v_pk_fma_f32 v[68:69], v[68:69], v[36:37], v[38:39] op_sel:[0,1,0] op_sel_hi:[1,1,0]
    v_pk_fma_f32 v[70:71], v[70:71], v[36:37], v[38:39] op_sel:[0,1,0] op_sel_hi:[1,1,0]
    v_pk_fma_f32 v[72:73], v[72:73], v[36:37], v[38:39] op_sel:[0,1,0] op_sel_hi:[1,1,0]
    v_pk_fma_f32 v[74:75], v[74:75], v[36:37], v[38:39] op_sel:[0,1,0] op_sel_hi:[1,1,0]
    v_pk_fma_f32 v[76:77], v[76:77], v[36:37], v[38:39] op_sel:[0,1,0] op_sel_hi:[1,1,0]
    v_pk_fma_f32 v[78:79], v[78:79], v[36:37], v[38:39] op_sel:[0,1,0] op_sel_hi:[1,1,0]
    v_pk_mul_f32 v[64:65], v[64:65], v[208:209]
    v_pk_mul_f32 v[66:67], v[66:67], v[210:211]
    v_pk_mul_f32 v[68:69], v[68:69], v[212:213]
    v_pk_mul_f32 v[70:71], v[70:71], v[214:215]
    v_pk_mul_f32 v[72:73], v[72:73], v[216:217]
    v_pk_mul_f32 v[74:75], v[74:75], v[218:219]
    v_pk_mul_f32 v[76:77], v[76:77], v[220:221]
    v_pk_mul_f32 v[78:79], v[78:79], v[222:223]
    v_exp_f32 v64, v64
    v_exp_f32 v65, v65
    v_exp_f32 v66, v66
    v_exp_f32 v67, v67
    v_exp_f32 v68, v68
    v_exp_f32 v69, v69
    v_exp_f32 v70, v70
    v_exp_f32 v71, v71
    v_exp_f32 v72, v72
    v_exp_f32 v73, v73
    v_exp_f32 v74, v74
    v_exp_f32 v75, v75
    v_exp_f32 v76, v76
    v_exp_f32 v77, v77
    v_exp_f32 v78, v78
    v_exp_f32 v79, v79
    v_pk_fma_f32 v[64:65], v[64:65], v[38:39], v[38:39] op_sel:[0,1,1] op_sel_hi:[1,1,1]
    v_pk_fma_f32 v[66:67], v[66:67], v[38:39], v[38:39] op_sel:[0,1,1] op_sel_hi:[1,1,1]
    v_pk_fma_f32 v[68:69], v[68:69], v[38:39], v[38:39] op_sel:[0,1,1] op_sel_hi:[1,1,1]
    v_pk_fma_f32 v[70:71], v[70:71], v[38:39], v[38:39] op_sel:[0,1,1] op_sel_hi:[1,1,1]
    v_pk_fma_f32 v[72:73], v[72:73], v[38:39], v[38:39] op_sel:[0,1,1] op_sel_hi:[1,1,1]
    v_pk_fma_f32 v[74:75], v[74:75], v[38:39], v[38:39] op_sel:[0,1,1] op_sel_hi:[1,1,1]
    v_pk_fma_f32 v[76:77], v[76:77], v[38:39], v[38:39] op_sel:[0,1,1] op_sel_hi:[1,1,1]
    v_pk_fma_f32 v[78:79], v[78:79], v[38:39], v[38:39] op_sel:[0,1,1] op_sel_hi:[1,1,1]
    v_rcp_f32 v64, v64
    v_rcp_f32 v65, v65
    v_rcp_f32 v66, v66
    v_rcp_f32 v67, v67
    v_rcp_f32 v68, v68
    v_rcp_f32 v69, v69
    v_rcp_f32 v70, v70
    v_rcp_f32 v71, v71
    v_rcp_f32 v72, v72
    v_rcp_f32 v73, v73
    v_rcp_f32 v74, v74
    v_rcp_f32 v75, v75
    v_rcp_f32 v76, v76
    v_rcp_f32 v77, v77
    v_rcp_f32 v78, v78
    v_rcp_f32 v79, v79
    v_pk_mul_f32 v[208:209], v[208:209], v[64:65]
    v_pk_mul_f32 v[210:211], v[210:211], v[66:67]
    v_pk_mul_f32 v[212:213], v[212:213], v[68:69]
    v_pk_mul_f32 v[214:215], v[214:215], v[70:71]
    v_pk_mul_f32 v[216:217], v[216:217], v[72:73]
    v_pk_mul_f32 v[218:219], v[218:219], v[74:75]
    v_pk_mul_f32 v[220:221], v[220:221], v[76:77]
    v_pk_mul_f32 v[222:223], v[222:223], v[78:79]
    v_cvt_pk_bf16_f32 v104, v208, v209
    v_cvt_pk_bf16_f32 v105, v210, v211
    v_cvt_pk_bf16_f32 v106, v212, v213
    v_cvt_pk_bf16_f32 v107, v214, v215
    v_cvt_pk_bf16_f32 v108, v216, v217
    v_cvt_pk_bf16_f32 v109, v218, v219
    v_cvt_pk_bf16_f32 v110, v220, v221
    v_cvt_pk_bf16_f32 v111, v222, v223
    ds_write_b64 v4, v[104:105] offset:2048
    ds_write_b64 v5, v[106:107] offset:2048
    ds_write_b64 v6, v[108:109] offset:2048
    ds_write_b64 v7, v[110:111] offset:2048
    ds_read_b128 v[88:91], v8 offset:2048
    ds_read_b128 v[92:95], v9 offset:3072
    v_pk_fma_f32 v[224:225], v[48:49], v[40:41], v[224:225] op_sel:[0,0,0] op_sel_hi:[1,0,1]
    v_pk_fma_f32 v[226:227], v[50:51], v[40:41], v[226:227] op_sel:[0,0,0] op_sel_hi:[1,0,1]
    v_pk_fma_f32 v[228:229], v[52:53], v[40:41], v[228:229] op_sel:[0,0,0] op_sel_hi:[1,0,1]
    v_pk_fma_f32 v[230:231], v[54:55], v[40:41], v[230:231] op_sel:[0,0,0] op_sel_hi:[1,0,1]
    v_pk_fma_f32 v[232:233], v[56:57], v[40:41], v[232:233] op_sel:[0,0,0] op_sel_hi:[1,0,1]
    v_pk_fma_f32 v[234:235], v[58:59], v[40:41], v[234:235] op_sel:[0,0,0] op_sel_hi:[1,0,1]
    v_pk_fma_f32 v[236:237], v[60:61], v[40:41], v[236:237] op_sel:[0,0,0] op_sel_hi:[1,0,1]
    v_pk_fma_f32 v[238:239], v[62:63], v[40:41], v[238:239] op_sel:[0,0,0] op_sel_hi:[1,0,1]
    v_pk_mul_f32 v[64:65], v[224:225], v[224:225]
    v_pk_mul_f32 v[66:67], v[226:227], v[226:227]
    v_pk_mul_f32 v[68:69], v[228:229], v[228:229]
    v_pk_mul_f32 v[70:71], v[230:231], v[230:231]
    v_pk_mul_f32 v[72:73], v[232:233], v[232:233]
    v_pk_mul_f32 v[74:75], v[234:235], v[234:235]
    v_pk_mul_f32 v[76:77], v[236:237], v[236:237]
    v_pk_mul_f32 v[78:79], v[238:239], v[238:239]
    s_waitcnt lgkmcnt(0)
    v_add_u32 v14, 0x8c000, v10
    v_add_u32 v15, 0x9a000, v10
    buffer_store_dwordx4 v[88:91], v14, s[36:39], 0 offen sc1
    buffer_store_dwordx4 v[92:95], v15, s[36:39], 0 offen sc1
    v_pk_fma_f32 v[64:65], v[64:65], v[40:41], v[42:43] op_sel:[0,1,0] op_sel_hi:[1,1,0]
    v_pk_fma_f32 v[66:67], v[66:67], v[40:41], v[42:43] op_sel:[0,1,0] op_sel_hi:[1,1,0]
    v_pk_fma_f32 v[68:69], v[68:69], v[40:41], v[42:43] op_sel:[0,1,0] op_sel_hi:[1,1,0]
    v_pk_fma_f32 v[70:71], v[70:71], v[40:41], v[42:43] op_sel:[0,1,0] op_sel_hi:[1,1,0]
    v_pk_fma_f32 v[72:73], v[72:73], v[40:41], v[42:43] op_sel:[0,1,0] op_sel_hi:[1,1,0]
    v_pk_fma_f32 v[74:75], v[74:75], v[40:41], v[42:43] op_sel:[0,1,0] op_sel_hi:[1,1,0]
    v_pk_fma_f32 v[76:77], v[76:77], v[40:41], v[42:43] op_sel:[0,1,0] op_sel_hi:[1,1,0]
    v_pk_fma_f32 v[78:79], v[78:79], v[40:41], v[42:43] op_sel:[0,1,0] op_sel_hi:[1,1,0]
    v_pk_mul_f32 v[64:65], v[64:65], v[224:225]
    v_pk_mul_f32 v[66:67], v[66:67], v[226:227]
    v_pk_mul_f32 v[68:69], v[68:69], v[228:229]
    v_pk_mul_f32 v[70:71], v[70:71], v[230:231]
    v_pk_mul_f32 v[72:73], v[72:73], v[232:233]
    v_pk_mul_f32 v[74:75], v[74:75], v[234:235]
    v_pk_mul_f32 v[76:77], v[76:77], v[236:237]
    v_pk_mul_f32 v[78:79], v[78:79], v[238:239]
    v_exp_f32 v64, v64
    v_exp_f32 v65, v65
    v_exp_f32 v66, v66
    v_exp_f32 v67, v67
    v_exp_f32 v68, v68
    v_exp_f32 v69, v69
    v_exp_f32 v70, v70
    v_exp_f32 v71, v71
    v_exp_f32 v72, v72
    v_exp_f32 v73, v73
    v_exp_f32 v74, v74
    v_exp_f32 v75, v75
    v_exp_f32 v76, v76
    v_exp_f32 v77, v77
    v_exp_f32 v78, v78
    v_exp_f32 v79, v79
    v_pk_fma_f32 v[64:65], v[64:65], v[42:43], v[42:43] op_sel:[0,1,1] op_sel_hi:[1,1,1]
    v_pk_fma_f32 v[66:67], v[66:67], v[42:43], v[42:43] op_sel:[0,1,1] op_sel_hi:[1,1,1]
    v_pk_fma_f32 v[68:69], v[68:69], v[42:43], v[42:43] op_sel:[0,1,1] op_sel_hi:[1,1,1]
    v_pk_fma_f32 v[70:71], v[70:71], v[42:43], v[42:43] op_sel:[0,1,1] op_sel_hi:[1,1,1]
    v_pk_fma_f32 v[72:73], v[72:73], v[42:43], v[42:43] op_sel:[0,1,1] op_sel_hi:[1,1,1]
    v_pk_fma_f32 v[74:75], v[74:75], v[42:43], v[42:43] op_sel:[0,1,1] op_sel_hi:[1,1,1]
    v_pk_fma_f32 v[76:77], v[76:77], v[42:43], v[42:43] op_sel:[0,1,1] op_sel_hi:[1,1,1]
    v_pk_fma_f32 v[78:79], v[78:79], v[42:43], v[42:43] op_sel:[0,1,1] op_sel_hi:[1,1,1]
    v_rcp_f32 v64, v64
    v_rcp_f32 v65, v65
    v_rcp_f32 v66, v66
    v_rcp_f32 v67, v67
    v_rcp_f32 v68, v68
    v_rcp_f32 v69, v69
    v_rcp_f32 v70, v70
    v_rcp_f32 v71, v71
    v_rcp_f32 v72, v72
    v_rcp_f32 v73, v73
    v_rcp_f32 v74, v74
    v_rcp_f32 v75, v75
    v_rcp_f32 v76, v76
    v_rcp_f32 v77, v77
    v_rcp_f32 v78, v78
    v_rcp_f32 v79, v79
    v_pk_mul_f32 v[224:225], v[224:225], v[64:65]
    v_pk_mul_f32 v[226:227], v[226:227], v[66:67]
    v_pk_mul_f32 v[228:229], v[228:229], v[68:69]
    v_pk_mul_f32 v[230:231], v[230:231], v[70:71]
    v_pk_mul_f32 v[232:233], v[232:233], v[72:73]
    v_pk_mul_f32 v[234:235], v[234:235], v[74:75]
    v_pk_mul_f32 v[236:237], v[236:237], v[76:77]
    v_pk_mul_f32 v[238:239], v[238:239], v[78:79]
    v_xor_b32 v4, 0x1000, v4
    v_xor_b32 v5, 0x1000, v5
    v_xor_b32 v6, 0x1000, v6
    v_xor_b32 v7, 0x1000, v7
    v_xor_b32 v8, 0x1000, v8
    v_xor_b32 v9, 0x1000, v9
    v_cvt_pk_bf16_f32 v96, v224, v225
    v_cvt_pk_bf16_f32 v97, v226, v227
    v_cvt_pk_bf16_f32 v98, v228, v229
    v_cvt_pk_bf16_f32 v99, v230, v231
    v_cvt_pk_bf16_f32 v100, v232, v233
    v_cvt_pk_bf16_f32 v101, v234, v235
    v_cvt_pk_bf16_f32 v102, v236, v237
    v_cvt_pk_bf16_f32 v103, v238, v239
    ds_write_b64 v4, v[96:97] offset:0
    ds_write_b64 v5, v[98:99] offset:0
    ds_write_b64 v6, v[100:101] offset:0
    ds_write_b64 v7, v[102:103] offset:0
    ds_read_b128 v[80:83], v8 offset:0
    ds_read_b128 v[84:87], v9 offset:1024
    v_pk_fma_f32 v[240:241], v[48:49], v[44:45], v[240:241] op_sel:[0,0,0] op_sel_hi:[1,0,1]
    v_pk_fma_f32 v[242:243], v[50:51], v[44:45], v[242:243] op_sel:[0,0,0] op_sel_hi:[1,0,1]
    v_pk_fma_f32 v[244:245], v[52:53], v[44:45], v[244:245] op_sel:[0,0,0] op_sel_hi:[1,0,1]
    v_pk_fma_f32 v[246:247], v[54:55], v[44:45], v[246:247] op_sel:[0,0,0] op_sel_hi:[1,0,1]
    v_pk_fma_f32 v[248:249], v[56:57], v[44:45], v[248:249] op_sel:[0,0,0] op_sel_hi:[1,0,1]
    v_pk_fma_f32 v[250:251], v[58:59], v[44:45], v[250:251] op_sel:[0,0,0] op_sel_hi:[1,0,1]
    v_pk_fma_f32 v[252:253], v[60:61], v[44:45], v[252:253] op_sel:[0,0,0] op_sel_hi:[1,0,1]
    v_pk_fma_f32 v[254:255], v[62:63], v[44:45], v[254:255] op_sel:[0,0,0] op_sel_hi:[1,0,1]
    v_pk_mul_f32 v[64:65], v[240:241], v[240:241]
    v_pk_mul_f32 v[66:67], v[242:243], v[242:243]
    v_pk_mul_f32 v[68:69], v[244:245], v[244:245]
    v_pk_mul_f32 v[70:71], v[246:247], v[246:247]
    v_pk_mul_f32 v[72:73], v[248:249], v[248:249]
    v_pk_mul_f32 v[74:75], v[250:251], v[250:251]
    v_pk_mul_f32 v[76:77], v[252:253], v[252:253]
    v_pk_mul_f32 v[78:79], v[254:255], v[254:255]
    s_waitcnt lgkmcnt(0)
    v_add_u32 v12, 0xa8000, v10
    v_add_u32 v13, 0xb6000, v10
    buffer_store_dwordx4 v[80:83], v12, s[36:39], 0 offen sc1
    buffer_store_dwordx4 v[84:87], v13, s[36:39], 0 offen sc1
    v_pk_fma_f32 v[64:65], v[64:65], v[44:45], v[46:47] op_sel:[0,1,0] op_sel_hi:[1,1,0]
    v_pk_fma_f32 v[66:67], v[66:67], v[44:45], v[46:47] op_sel:[0,1,0] op_sel_hi:[1,1,0]
    v_pk_fma_f32 v[68:69], v[68:69], v[44:45], v[46:47] op_sel:[0,1,0] op_sel_hi:[1,1,0]
    v_pk_fma_f32 v[70:71], v[70:71], v[44:45], v[46:47] op_sel:[0,1,0] op_sel_hi:[1,1,0]
    v_pk_fma_f32 v[72:73], v[72:73], v[44:45], v[46:47] op_sel:[0,1,0] op_sel_hi:[1,1,0]
    v_pk_fma_f32 v[74:75], v[74:75], v[44:45], v[46:47] op_sel:[0,1,0] op_sel_hi:[1,1,0]
    v_pk_fma_f32 v[76:77], v[76:77], v[44:45], v[46:47] op_sel:[0,1,0] op_sel_hi:[1,1,0]
    v_pk_fma_f32 v[78:79], v[78:79], v[44:45], v[46:47] op_sel:[0,1,0] op_sel_hi:[1,1,0]
    v_pk_mul_f32 v[64:65], v[64:65], v[240:241]
    v_pk_mul_f32 v[66:67], v[66:67], v[242:243]
    v_pk_mul_f32 v[68:69], v[68:69], v[244:245]
    v_pk_mul_f32 v[70:71], v[70:71], v[246:247]
    v_pk_mul_f32 v[72:73], v[72:73], v[248:249]
    v_pk_mul_f32 v[74:75], v[74:75], v[250:251]
    v_pk_mul_f32 v[76:77], v[76:77], v[252:253]
    v_pk_mul_f32 v[78:79], v[78:79], v[254:255]
    v_exp_f32 v64, v64
    v_exp_f32 v65, v65
    v_exp_f32 v66, v66
    v_exp_f32 v67, v67
    v_exp_f32 v68, v68
    v_exp_f32 v69, v69
    v_exp_f32 v70, v70
    v_exp_f32 v71, v71
    v_exp_f32 v72, v72
    v_exp_f32 v73, v73
    v_exp_f32 v74, v74
    v_exp_f32 v75, v75
    v_exp_f32 v76, v76
    v_exp_f32 v77, v77
    v_exp_f32 v78, v78
    v_exp_f32 v79, v79
    v_pk_fma_f32 v[64:65], v[64:65], v[46:47], v[46:47] op_sel:[0,1,1] op_sel_hi:[1,1,1]
    v_pk_fma_f32 v[66:67], v[66:67], v[46:47], v[46:47] op_sel:[0,1,1] op_sel_hi:[1,1,1]
    v_pk_fma_f32 v[68:69], v[68:69], v[46:47], v[46:47] op_sel:[0,1,1] op_sel_hi:[1,1,1]
    v_pk_fma_f32 v[70:71], v[70:71], v[46:47], v[46:47] op_sel:[0,1,1] op_sel_hi:[1,1,1]
    v_pk_fma_f32 v[72:73], v[72:73], v[46:47], v[46:47] op_sel:[0,1,1] op_sel_hi:[1,1,1]
    v_pk_fma_f32 v[74:75], v[74:75], v[46:47], v[46:47] op_sel:[0,1,1] op_sel_hi:[1,1,1]
    v_pk_fma_f32 v[76:77], v[76:77], v[46:47], v[46:47] op_sel:[0,1,1] op_sel_hi:[1,1,1]
    v_pk_fma_f32 v[78:79], v[78:79], v[46:47], v[46:47] op_sel:[0,1,1] op_sel_hi:[1,1,1]
    v_rcp_f32 v64, v64
    v_rcp_f32 v65, v65
    v_rcp_f32 v66, v66
    v_rcp_f32 v67, v67
    v_rcp_f32 v68, v68
    v_rcp_f32 v69, v69
    v_rcp_f32 v70, v70
    v_rcp_f32 v71, v71
    v_rcp_f32 v72, v72
    v_rcp_f32 v73, v73
    v_rcp_f32 v74, v74
    v_rcp_f32 v75, v75
    v_rcp_f32 v76, v76
    v_rcp_f32 v77, v77
    v_rcp_f32 v78, v78
    v_rcp_f32 v79, v79
    v_pk_mul_f32 v[240:241], v[240:241], v[64:65]
    v_pk_mul_f32 v[242:243], v[242:243], v[66:67]
    v_pk_mul_f32 v[244:245], v[244:245], v[68:69]
    v_pk_mul_f32 v[246:247], v[246:247], v[70:71]
    v_pk_mul_f32 v[248:249], v[248:249], v[72:73]
    v_pk_mul_f32 v[250:251], v[250:251], v[74:75]
    v_pk_mul_f32 v[252:253], v[252:253], v[76:77]
    v_pk_mul_f32 v[254:255], v[254:255], v[78:79]
    v_cvt_pk_bf16_f32 v104, v240, v241
    v_cvt_pk_bf16_f32 v105, v242, v243
    v_cvt_pk_bf16_f32 v106, v244, v245
    v_cvt_pk_bf16_f32 v107, v246, v247
    v_cvt_pk_bf16_f32 v108, v248, v249
    v_cvt_pk_bf16_f32 v109, v250, v251
    v_cvt_pk_bf16_f32 v110, v252, v253
    v_cvt_pk_bf16_f32 v111, v254, v255
    ds_write_b64 v4, v[104:105] offset:2048
    ds_write_b64 v5, v[106:107] offset:2048
    ds_write_b64 v6, v[108:109] offset:2048
    ds_write_b64 v7, v[110:111] offset:2048
    ds_read_b128 v[88:91], v8 offset:2048
    ds_read_b128 v[92:95], v9 offset:3072
    s_waitcnt lgkmcnt(0)
    v_add_u32 v14, 0xc4000, v10
    v_add_u32 v15, 0xd2000, v10
    buffer_store_dwordx4 v[88:91], v14, s[36:39], 0 offen sc1
    buffer_store_dwordx4 v[92:95], v15, s[36:39], 0 offen sc1
L_c4:
    s_cmp_eq_u32 s76, 0
    s_mov_b32 s78, 0x51743260
    s_cselect_b32 s78, 0x76543210, s78
    s_lshl_b32 s71, s63, 2
    s_lshr_b32 s78, s78, s71
    s_and_b32 s78, s78, 7
    s_lshl_b32 s62, s78, 7
    s_mov_b32 s28, s26
    s_mov_b32 s29, s27
    s_mov_b32 s30, 0x400000
    s_mov_b32 s31, 0x20000
    s_mov_b32 s32, s8
    s_mov_b32 s33, s9
    s_mov_b32 s34, 0x200000
    s_mov_b32 s35, 0x20000
    s_add_u32 s44, s26, 0x1000000
    s_addc_u32 s45, s27, 0
    s_mov_b32 s46, 0xe00000
    s_mov_b32 s47, 0x20000
    s_mov_b32 s36, s22
    s_mov_b32 s37, s23
    s_mov_b32 s38, 0x400000
    s_mov_b32 s39, 0x20000
    s_add_u32 s40, s26, 0x800000
    s_addc_u32 s41, s27, 0
    s_mov_b32 s42, 0x400000
    s_mov_b32 s43, 0x20000
    s_add_u32 s52, s26, 0x2300000
    s_addc_u32 s53, s27, 0
    s_mov_b32 s54, 0x2000
    s_mov_b32 s55, 0x20000
    s_cmp_ge_u32 s80, 24
    s_cselect_b32 s69, s76, 0
    s_and_b32 s71, s78, 3
    s_cmp_eq_u32 s71, 1
    s_cselect_b32 s68, 4, 4
    s_cselect_b32 s71, 6, 8
    s_bitcmp0_b32 s79, 0
    s_cselect_b32 s68, s71, s68
    s_sub_u32 s71, 16, s68
    s_cmp_eq_u32 s76, 0
    s_cselect_b32 s68, s68, s71
    s_lshl_b32 s71, s76, 3
    s_sub_u32 s84, s68, s71
    s_add_u32 s84, s84, 32
    s_lshl_b32 s71, s69, 2
    s_sub_u32 s68, s68, s71
    s_lshr_b32 s73, s60, 1
    s_lshl_b32 s73, s73, 6
    s_add_u32 s73, s73, s61
    s_and_b32 s74, s60, 1
    s_lshl_b32 s74, s74, 6
    s_add_u32 s74, s74, s62
    s_lshl_b32 s74, s74, 1
    s_lshl_b32 s71, s76, 5
    s_add_u32 s73, s73, s71
    s_and_b32 s71, s84, 3
    s_lshl_b32 s71, s71, 1
    s_and_b32 s72, s60, 1
    s_add_u32 s71, s71, s72
    s_lshl_b32 s71, s71, 14
    s_lshr_b32 s72, s60, 1
    s_lshl_b32 s72, s72, 13
    s_add_u32 s71, s71, s72
    v_lshrrev_b32 v120, 4, v1
    v_and_b32 v2, 15, v1
    v_lshrrev_b32 v3, 1, v2
    v_lshrrev_b32 v118, 1, v120
    v_xor_b32 v3, v3, v118
    v_and_b32 v118, 1, v120
    v_lshlrev_b32 v118, 3, v118
    v_lshl_add_u32 v118, v2, 7, v118
    v_add_u32 v118, s71, v118
    v_xor_b32 v112, 0, v3
    v_lshl_add_u32 v112, v112, 4, v118
    v_xor_b32 v113, 2, v3
    v_lshl_add_u32 v113, v113, 4, v118
    v_xor_b32 v114, 4, v3
    v_lshl_add_u32 v114, v114, 4, v118
    v_xor_b32 v115, 6, v3
    v_lshl_add_u32 v115, v115, 4, v118
    v_lshrrev_b32 v2, 3, v1
    v_and_b32 v3, 7, v1
    v_xor_b32 v118, v3, v120
    v_lshlrev_b32 v118, 4, v118
    v_lshl_add_u32 v118, v2, 7, v118
    v_add_u32 v118, s71, v118
    v_xor_b32 v119, 64, v118
    v_add_u32 v2, s73, v2
    v_lshlrev_b32 v2, 11, v2
    v_lshl_add_u32 v2, v3, 4, v2
    v_add_u32 v120, s74, v2
    v_and_b32 v2, 15, v1
    v_add_u32 v2, s73, v2
    v_lshlrev_b32 v3, 2, v2
    buffer_load_dword v104, v3, s[52:55], 0 offen offset:0 sc1
    buffer_load_dword v106, v3, s[52:55], 0 offen offset:64 sc1
    s_add_u32 s56, s26, 0x3000000
    s_addc_u32 s57, s27, 0
    s_mov_b32 s58, 0x1000000
    s_mov_b32 s59, 0x20000
    s_lshl_b32 s65, s77, 3
    s_add_u32 s65, s65, s78
    s_lshl_b32 s65, s65, 1
    s_add_u32 s66, s65, s76
    s_xor_b32 s65, s66, 1
    s_lshl_b32 s71, s66, 2
    s_add_u32 s71, s71, s60
    s_lshl_b32 s71, s71, 14
    v_lshlrev_b32 v2, 4, v1
    v_add_u32 v117, s71, v2
    v_xor_b32 v116, 0x10000, v117
    s_lshl_b32 s65, s65, 5
    s_lshl_b32 s66, s66, 5
    v_and_b32 v2, 15, v1
    s_lshr_b32 s71, s60, 1
    s_lshl_b32 s71, s71, 6
    v_add_u32 v2, s71, v2
    v_lshlrev_b32 v2, 7, v2
    v_bfe_u32 v3, v1, 1, 3
    v_lshrrev_b32 v16, 4, v1
    v_xor_b32 v3, v3, v16
    v_xor_b32 v17, 0, v3
    v_lshl_add_u32 v8, v17, 4, v2
    v_mov_b32 v4, v8
    v_xor_b32 v17, 4, v3
    v_lshl_add_u32 v9, v17, 4, v2
    v_mov_b32 v5, v9
    v_bfe_u32 v2, v1, 2, 2
    v_lshl_add_u32 v18, v16, 3, v2
    v_and_b32 v3, 1, v1
    v_lshlrev_b32 v3, 3, v3
    v_lshl_add_u32 v3, v18, 8, v3
    v_bfe_u32 v17, v1, 1, 1
    s_and_b32 s71, s60, 1
    s_lshl_b32 s71, s71, 3
    v_add_u32 v17, s71, v17
    v_lshlrev_b32 v2, 2, v2
    v_xor_b32 v17, v17, v2
    v_and_b32 v2, 1, v16
    v_lshlrev_b32 v2, 1, v2
    v_xor_b32 v17, v17, v2
    v_xor_b32 v19, 0, v17
    v_lshl_add_u32 v19, v19, 4, v3
    v_add_u32 v10, 16384, v19
    v_mov_b32 v6, v10
    v_xor_b32 v19, 2, v17
    v_lshl_add_u32 v19, v19, 4, v3
    v_add_u32 v11, 16384, v19
    v_mov_b32 v7, v11
    v_xor_b32 v19, 4, v17
    v_lshl_add_u32 v19, v19, 4, v3
    v_add_u32 v14, 16384, v19
    v_mov_b32 v12, v14
    v_xor_b32 v19, 6, v17
    v_lshl_add_u32 v19, v19, 4, v3
    v_add_u32 v15, 16384, v19
    v_mov_b32 v13, v15
    s_mov_b32 s70, 0
    s_barrier
    ds_read_b64_tr_b16 v[32:33], v6 offset:0
    ds_read_b64_tr_b16 v[34:35], v6 offset:1024
    ds_read_b128 v[16:19], v4 offset:0
    ds_read_b64_tr_b16 v[36:37], v7 offset:0
    ds_read_b64_tr_b16 v[38:39], v7 offset:1024
    ds_read_b128 v[20:23], v4 offset:2048
    ds_read_b64_tr_b16 v[40:41], v12 offset:0
    ds_read_b64_tr_b16 v[42:43], v12 offset:1024
    ds_read_b128 v[24:27], v4 offset:4096
    ds_read_b64_tr_b16 v[44:45], v13 offset:0
    ds_read_b64_tr_b16 v[46:47], v13 offset:1024
    ds_read_b128 v[28:31], v4 offset:6144
    s_waitcnt lgkmcnt(0)
    v_mfma_f32_16x16x32_bf16 v[128:131], v[32:35], v[16:19], 0
    ds_read_b64_tr_b16 v[64:65], v6 offset:8192
    ds_read_b64_tr_b16 v[66:67], v6 offset:9216
    v_mfma_f32_16x16x32_bf16 v[144:147], v[32:35], v[20:23], 0
    ds_read_b128 v[48:51], v5 offset:0
    ds_read_b64_tr_b16 v[68:69], v7 offset:8192
    v_mfma_f32_16x16x32_bf16 v[160:163], v[32:35], v[24:27], 0
    ds_read_b64_tr_b16 v[70:71], v7 offset:9216
    ds_read_b128 v[52:55], v5 offset:2048
    v_mfma_f32_16x16x32_bf16 v[176:179], v[32:35], v[28:31], 0
    ds_read_b64_tr_b16 v[72:73], v12 offset:8192
    ds_read_b64_tr_b16 v[74:75], v12 offset:9216
    v_mfma_f32_16x16x32_bf16 v[180:183], v[36:39], v[28:31], 0
    ds_read_b128 v[56:59], v5 offset:4096
    ds_read_b64_tr_b16 v[76:77], v13 offset:8192
    v_mfma_f32_16x16x32_bf16 v[164:167], v[36:39], v[24:27], 0
    ds_read_b64_tr_b16 v[78:79], v13 offset:9216
    ds_read_b128 v[60:63], v5 offset:6144
    v_mfma_f32_16x16x32_bf16 v[148:151], v[36:39], v[20:23], 0
    s_add_u32 s70, s70, 32768
    s_cmp_eq_u32 s70, 131072
    v_mfma_f32_16x16x32_bf16 v[132:135], v[36:39], v[16:19], 0
    s_cselect_b32 s70, 0, s70
    v_add_u32 v4, s70, v8
    v_mfma_f32_16x16x32_bf16 v[136:139], v[40:43], v[16:19], 0
    v_add_u32 v5, s70, v9
    v_add_u32 v6, s70, v10
    v_mfma_f32_16x16x32_bf16 v[152:155], v[40:43], v[20:23], 0
    v_add_u32 v7, s70, v11
    v_add_u32 v12, s70, v14
    v_mfma_f32_16x16x32_bf16 v[168:171], v[40:43], v[24:27], 0
    v_add_u32 v13, s70, v15
    v_mfma_f32_16x16x32_bf16 v[184:187], v[40:43], v[28:31], 0
    v_mfma_f32_16x16x32_bf16 v[188:191], v[44:47], v[28:31], 0
    v_mfma_f32_16x16x32_bf16 v[172:175], v[44:47], v[24:27], 0
    v_mfma_f32_16x16x32_bf16 v[156:159], v[44:47], v[20:23], 0
    v_mfma_f32_16x16x32_bf16 v[140:143], v[44:47], v[16:19], 0
    s_waitcnt lgkmcnt(0)
    v_mfma_f32_16x16x32_bf16 v[128:131], v[64:67], v[48:51], v[128:131]
    s_barrier
    v_mfma_f32_16x16x32_bf16 v[144:147], v[64:67], v[52:55], v[144:147]
    ds_read_b64_tr_b16 v[32:33], v6 offset:0
    ds_read_b64_tr_b16 v[34:35], v6 offset:1024
    v_mfma_f32_16x16x32_bf16 v[160:163], v[64:67], v[56:59], v[160:163]
    ds_read_b128 v[16:19], v4 offset:0
    ds_read_b64_tr_b16 v[36:37], v7 offset:0
    v_mfma_f32_16x16x32_bf16 v[176:179], v[64:67], v[60:63], v[176:179]
    ds_read_b64_tr_b16 v[38:39], v7 offset:1024
    ds_read_b128 v[20:23], v4 offset:2048
    v_mfma_f32_16x16x32_bf16 v[180:183], v[68:71], v[60:63], v[180:183]
    ds_read_b64_tr_b16 v[40:41], v12 offset:0
    ds_read_b64_tr_b16 v[42:43], v12 offset:1024
    v_mfma_f32_16x16x32_bf16 v[164:167], v[68:71], v[56:59], v[164:167]
    ds_read_b128 v[24:27], v4 offset:4096
    ds_read_b64_tr_b16 v[44:45], v13 offset:0
    v_mfma_f32_16x16x32_bf16 v[148:151], v[68:71], v[52:55], v[148:151]
    ds_read_b64_tr_b16 v[46:47], v13 offset:1024
    ds_read_b128 v[28:31], v4 offset:6144
    v_mfma_f32_16x16x32_bf16 v[132:135], v[68:71], v[48:51], v[132:135]
    v_mfma_f32_16x16x32_bf16 v[136:139], v[72:75], v[48:51], v[136:139]
    v_mfma_f32_16x16x32_bf16 v[152:155], v[72:75], v[52:55], v[152:155]
    v_mfma_f32_16x16x32_bf16 v[168:171], v[72:75], v[56:59], v[168:171]
    v_mfma_f32_16x16x32_bf16 v[184:187], v[72:75], v[60:63], v[184:187]
    v_mfma_f32_16x16x32_bf16 v[188:191], v[76:79], v[60:63], v[188:191]
    v_mfma_f32_16x16x32_bf16 v[172:175], v[76:79], v[56:59], v[172:175]
    v_mfma_f32_16x16x32_bf16 v[156:159], v[76:79], v[52:55], v[156:159]
    v_mfma_f32_16x16x32_bf16 v[140:143], v[76:79], v[48:51], v[140:143]
    s_waitcnt vmcnt(2)
    s_cmp_lg_u32 s69, 0
    s_cbranch_scc1 L_cnd_68
    s_lshl_b32 s73, s77, 7
    s_lshl_b32 s74, s76, 11
    s_add_u32 s73, s73, s74
    s_add_u32 s48, s26, 0x2700000
    s_addc_u32 s49, s27, 0
    s_mov_b32 s50, 0x8000
    s_mov_b32 s51, 0x20000
    s_add_u32 s71, s73, 2048
    v_mov_b32 v2, s71
    v_mov_b32 v3, 1
    s_mov_b64 exec, 1
    buffer_atomic_add v3, v2, s[48:51], 0 offen sc1
    s_mov_b64 exec, -1
L_cnd_68:
    s_mov_b32 s81, 0
    s_sub_u32 s67, s68, 3
L_sl_69:
    s_waitcnt lgkmcnt(0)
    v_mfma_f32_16x16x32_bf16 v[128:131], v[32:35], v[16:19], v[128:131]
    ds_read_b64_tr_b16 v[64:65], v6 offset:8192
    ds_read_b64_tr_b16 v[66:67], v6 offset:9216
    v_mfma_f32_16x16x32_bf16 v[144:147], v[32:35], v[20:23], v[144:147]
    ds_read_b128 v[48:51], v5 offset:0
    ds_read_b64_tr_b16 v[68:69], v7 offset:8192
    v_mfma_f32_16x16x32_bf16 v[160:163], v[32:35], v[24:27], v[160:163]
    ds_read_b64_tr_b16 v[70:71], v7 offset:9216
    ds_read_b128 v[52:55], v5 offset:2048
    v_mfma_f32_16x16x32_bf16 v[176:179], v[32:35], v[28:31], v[176:179]
    ds_read_b64_tr_b16 v[72:73], v12 offset:8192
    ds_read_b64_tr_b16 v[74:75], v12 offset:9216
    v_mfma_f32_16x16x32_bf16 v[180:183], v[36:39], v[28:31], v[180:183]
    ds_read_b128 v[56:59], v5 offset:4096
    ds_read_b64_tr_b16 v[76:77], v13 offset:8192
    v_mfma_f32_16x16x32_bf16 v[164:167], v[36:39], v[24:27], v[164:167]
    ds_read_b64_tr_b16 v[78:79], v13 offset:9216
    ds_read_b128 v[60:63], v5 offset:6144
    v_mfma_f32_16x16x32_bf16 v[148:151], v[36:39], v[20:23], v[148:151]
    s_add_u32 s70, s70, 32768
    s_cmp_eq_u32 s70, 131072
    v_mfma_f32_16x16x32_bf16 v[132:135], v[36:39], v[16:19], v[132:135]
    s_cselect_b32 s70, 0, s70
    v_add_u32 v4, s70, v8
    v_mfma_f32_16x16x32_bf16 v[136:139], v[40:43], v[16:19], v[136:139]
    v_add_u32 v5, s70, v9
    v_add_u32 v6, s70, v10
    v_mfma_f32_16x16x32_bf16 v[152:155], v[40:43], v[20:23], v[152:155]
    v_add_u32 v7, s70, v11
    v_add_u32 v12, s70, v14
    v_mfma_f32_16x16x32_bf16 v[168:171], v[40:43], v[24:27], v[168:171]
    v_add_u32 v13, s70, v15
    v_mfma_f32_16x16x32_bf16 v[184:187], v[40:43], v[28:31], v[184:187]
    v_mfma_f32_16x16x32_bf16 v[188:191], v[44:47], v[28:31], v[188:191]
    v_mfma_f32_16x16x32_bf16 v[172:175], v[44:47], v[24:27], v[172:175]
    v_mfma_f32_16x16x32_bf16 v[156:159], v[44:47], v[20:23], v[156:159]
    v_mfma_f32_16x16x32_bf16 v[140:143], v[44:47], v[16:19], v[140:143]
    s_waitcnt lgkmcnt(0)
    v_mfma_f32_16x16x32_bf16 v[128:131], v[64:67], v[48:51], v[128:131]
    s_barrier
    v_mfma_f32_16x16x32_bf16 v[144:147], v[64:67], v[52:55], v[144:147]
    ds_read_b64_tr_b16 v[32:33], v6 offset:0
    ds_read_b64_tr_b16 v[34:35], v6 offset:1024
    v_mfma_f32_16x16x32_bf16 v[160:163], v[64:67], v[56:59], v[160:163]
    ds_read_b128 v[16:19], v4 offset:0
    ds_read_b64_tr_b16 v[36:37], v7 offset:0
    v_mfma_f32_16x16x32_bf16 v[176:179], v[64:67], v[60:63], v[176:179]
    ds_read_b64_tr_b16 v[38:39], v7 offset:1024
    ds_read_b128 v[20:23], v4 offset:2048
    v_mfma_f32_16x16x32_bf16 v[180:183], v[68:71], v[60:63], v[180:183]
    ds_read_b64_tr_b16 v[40:41], v12 offset:0
    ds_read_b64_tr_b16 v[42:43], v12 offset:1024
    v_mfma_f32_16x16x32_bf16 v[164:167], v[68:71], v[56:59], v[164:167]
    ds_read_b128 v[24:27], v4 offset:4096
    ds_read_b64_tr_b16 v[44:45], v13 offset:0
    v_mfma_f32_16x16x32_bf16 v[148:151], v[68:71], v[52:55], v[148:151]
    ds_read_b64_tr_b16 v[46:47], v13 offset:1024
    ds_read_b128 v[28:31], v4 offset:6144
    v_mfma_f32_16x16x32_bf16 v[132:135], v[68:71], v[48:51], v[132:135]
    v_mfma_f32_16x16x32_bf16 v[136:139], v[72:75], v[48:51], v[136:139]
    v_mfma_f32_16x16x32_bf16 v[152:155], v[72:75], v[52:55], v[152:155]
    v_mfma_f32_16x16x32_bf16 v[168:171], v[72:75], v[56:59], v[168:171]
    v_mfma_f32_16x16x32_bf16 v[184:187], v[72:75], v[60:63], v[184:187]
    v_mfma_f32_16x16x32_bf16 v[188:191], v[76:79], v[60:63], v[188:191]
    v_mfma_f32_16x16x32_bf16 v[172:175], v[76:79], v[56:59], v[172:175]
    v_mfma_f32_16x16x32_bf16 v[156:159], v[76:79], v[52:55], v[156:159]
    v_mfma_f32_16x16x32_bf16 v[140:143], v[76:79], v[48:51], v[140:143]
    s_sub_u32 s67, s67, 1
    s_cmp_lg_u32 s67, 0
    s_cbranch_scc1 L_sl_69
    s_cmp_lg_u32 s81, 0
    s_cbranch_scc1 L_sn_70
    s_cmp_lg_u32 s60, 0
    s_cbranch_scc1 L_w0_71
    s_xor_b32 s76, s76, s69
    s_lshl_b32 s73, s77, 7
    s_lshl_b32 s74, s76, 11
    s_add_u32 s73, s73, s74
    s_add_u32 s48, s26, 0x2700000
    s_addc_u32 s49, s27, 0
    s_mov_b32 s50, 0x8000
    s_mov_b32 s51, 0x20000
    v_mov_b32 v121, 0
    v_mov_b32 v122, 0
    s_add_u32 s71, s73, 2048
    v_mov_b32 v121, s71
    s_mov_b32 s71, 32
    v_writelane_b32 v122, s71, 0
    s_add_u32 s71, s66, 24576
    v_writelane_b32 v121, s71, 1
    s_mov_b32 s71, 1
    v_writelane_b32 v122, s71, 1
    buffer_load_dword v123, v121, s[48:51], 0 offen sc1
    s_lshl_b32 s71, s76, 3
    s_sub_u32 s71, 32, s71
    v_writelane_b32 v122, s71, 0
    s_xor_b32 s76, s76, s69
L_w0_71:
    s_mov_b32 s81, 1
    s_mov_b32 s67, 2
    s_branch L_sl_69
L_sn_70:
    s_cmp_lg_u32 s81, 1
    s_cbranch_scc1 L_sn_72
    s_cmp_lg_u32 s60, 0
    s_cbranch_scc1 L_w0_73
    s_waitcnt vmcnt(0)
    v_cmp_lt_u32 vcc, v123, v122
    s_nop 0
    s_cmp_eq_u64 vcc, 0
    s_cbranch_scc1 L_apolld_75
    s_add_u32 s48, s26, 0x2700000
    s_addc_u32 s49, s27, 0
    s_mov_b32 s50, 0x8000
    s_mov_b32 s51, 0x20000
    s_mov_b32 s72, 0x40000
L_apoll_74:
    buffer_load_dword v123, v121, s[48:51], 0 offen sc1
    s_waitcnt vmcnt(0)
    v_cmp_lt_u32 vcc, v123, v122
    s_sub_u32 s72, s72, 1
    s_cmp_eq_u32 s72, 0
    s_cbranch_scc1 L_apolld_75
    s_cmp_eq_u64 vcc, 0
    s_cbranch_scc1 L_apolld_75
    s_sleep 4
    s_branch L_apoll_74
L_apolld_75:
L_w0_73:
    s_mov_b32 s81, 2
    s_sub_u32 s65, s84, s68
    s_sub_u32 s71, s65, 10
    s_sub_u32 s65, s65, 3
    s_cmp_lg_u32 s69, 0
    s_cselect_b32 s71, 2, s71
    s_and_b32 s72, s78, 3
    s_cmp_eq_u32 s72, 1
    s_cselect_b32 s67, s71, s65
    s_cselect_b32 s81, 2, 4
    s_sub_u32 s65, s65, s67
    s_branch L_sl_69
L_sn_72:
    s_cmp_lg_u32 s81, 2
    s_cbranch_scc1 L_sn_76
    s_cmp_lg_u32 s60, 0
    s_cbranch_scc1 L_w0_77
    s_lshl_b32 s73, s77, 7
    s_add_u32 s48, s26, 0x2700000
    s_addc_u32 s49, s27, 0
    s_mov_b32 s50, 0x8000
    s_mov_b32 s51, 0x20000
    v_mov_b32 v121, 0
    v_mov_b32 v122, 0
    s_add_u32 s71, s73, 4096
    v_mov_b32 v121, s71
    s_mov_b32 s71, 24
    v_writelane_b32 v122, s71, 0
    buffer_load_dword v123, v121, s[48:51], 0 offen sc1
L_w0_77:
    s_mov_b32 s81, 3
    s_mov_b32 s67, 2
    s_branch L_sl_69
L_sn_76:
    s_cmp_lg_u32 s81, 3
    s_cbranch_scc1 L_sn_78
    s_cmp_lg_u32 s60, 0
    s_cbranch_scc1 L_w0_79
    s_waitcnt vmcnt(0)
    v_cmp_lt_u32 vcc, v123, v122
    s_nop 0
    s_cmp_eq_u64 vcc, 0
    s_cbranch_scc1 L_apolld_81
    s_add_u32 s48, s26, 0x2700000
    s_addc_u32 s49, s27, 0
    s_mov_b32 s50, 0x8000
    s_mov_b32 s51, 0x20000
    s_mov_b32 s72, 0x40000
L_apoll_80:
    buffer_load_dword v123, v121, s[48:51], 0 offen sc1
    s_waitcnt vmcnt(0)
    v_cmp_lt_u32 vcc, v123, v122
    s_sub_u32 s72, s72, 1
    s_cmp_eq_u32 s72, 0
    s_cbranch_scc1 L_apolld_81
    s_cmp_eq_u64 vcc, 0
    s_cbranch_scc1 L_apolld_81
    s_sleep 4
    s_branch L_apoll_80
L_apolld_81:
L_w0_79:
    s_mov_b32 s81, 4
    s_sub_u32 s67, s65, 2
    s_branch L_sl_69
L_sn_78:
    s_waitcnt lgkmcnt(0)
    v_mfma_f32_16x16x32_bf16 v[128:131], v[32:35], v[16:19], v[128:131]
    ds_read_b64_tr_b16 v[48:49], v6 offset:8192
    ds_read_b64_tr_b16 v[50:51], v6 offset:9216
    v_mfma_f32_16x16x32_bf16 v[144:147], v[32:35], v[20:23], v[144:147]
    ds_read_b64_tr_b16 v[52:53], v7 offset:8192
    ds_read_b64_tr_b16 v[54:55], v7 offset:9216
    v_mfma_f32_16x16x32_bf16 v[160:163], v[32:35], v[24:27], v[160:163]
    ds_read_b64_tr_b16 v[56:57], v12 offset:8192
    ds_read_b64_tr_b16 v[58:59], v12 offset:9216
    v_mfma_f32_16x16x32_bf16 v[176:179], v[32:35], v[28:31], v[176:179]
    ds_read_b64_tr_b16 v[60:61], v13 offset:8192
    ds_read_b64_tr_b16 v[62:63], v13 offset:9216
    v_mfma_f32_16x16x32_bf16 v[180:183], v[36:39], v[28:31], v[180:183]
    ds_read_b128 v[80:83], v5 offset:4096
    ds_read_b128 v[84:87], v5 offset:6144
    v_mfma_f32_16x16x32_bf16 v[164:167], v[36:39], v[24:27], v[164:167]
    s_add_u32 s70, s70, 32768
    s_and_b32 s70, s70, 0x1ffff
    v_mfma_f32_16x16x32_bf16 v[148:151], v[36:39], v[20:23], v[148:151]
    v_add_u32 v108, s70, v8
    v_add_u32 v109, s70, v9
    v_mfma_f32_16x16x32_bf16 v[132:135], v[36:39], v[16:19], v[132:135]
    v_add_u32 v192, s70, v10
    v_add_u32 v193, s70, v11
    v_mfma_f32_16x16x32_bf16 v[136:139], v[40:43], v[16:19], v[136:139]
    v_add_u32 v194, s70, v14
    v_add_u32 v195, s70, v15
    v_mfma_f32_16x16x32_bf16 v[152:155], v[40:43], v[20:23], v[152:155]
    s_add_u32 s70, s70, 32768
    s_and_b32 s70, s70, 0x1ffff
    v_mfma_f32_16x16x32_bf16 v[168:171], v[40:43], v[24:27], v[168:171]
    v_add_u32 v110, s70, v8
    v_add_u32 v111, s70, v9
    v_add_u32 v196, s70, v10
    v_mfma_f32_16x16x32_bf16 v[184:187], v[40:43], v[28:31], v[184:187]
    v_add_u32 v197, s70, v11
    v_add_u32 v198, s70, v14
    v_add_u32 v199, s70, v15
    v_mfma_f32_16x16x32_bf16 v[188:191], v[44:47], v[28:31], v[188:191]
    s_barrier
    ds_read_b64_tr_b16 v[64:65], v192 offset:0
    ds_read_b64_tr_b16 v[66:67], v192 offset:1024
    v_mfma_f32_16x16x32_bf16 v[172:175], v[44:47], v[24:27], v[172:175]
    ds_read_b64_tr_b16 v[68:69], v193 offset:0
    ds_read_b64_tr_b16 v[70:71], v193 offset:1024
    ds_read_b64_tr_b16 v[72:73], v194 offset:0
    v_mfma_f32_16x16x32_bf16 v[156:159], v[44:47], v[20:23], v[156:159]
    ds_read_b64_tr_b16 v[74:75], v194 offset:1024
    ds_read_b64_tr_b16 v[76:77], v195 offset:0
    ds_read_b64_tr_b16 v[78:79], v195 offset:1024
    v_mfma_f32_16x16x32_bf16 v[140:143], v[44:47], v[16:19], v[140:143]
    ds_read_b128 v[88:91], v108 offset:4096
    ds_read_b128 v[92:95], v108 offset:6144
    s_waitcnt lgkmcnt(10)
    v_mfma_f32_16x16x32_bf16 v[160:163], v[48:51], v[80:83], v[160:163]
    ds_read_b64_tr_b16 v[208:209], v192 offset:8192
    ds_read_b64_tr_b16 v[210:211], v192 offset:9216
    v_mfma_f32_16x16x32_bf16 v[176:179], v[48:51], v[84:87], v[176:179]
    ds_read_b64_tr_b16 v[212:213], v193 offset:8192
    ds_read_b64_tr_b16 v[214:215], v193 offset:9216
    v_mfma_f32_16x16x32_bf16 v[164:167], v[52:55], v[80:83], v[164:167]
    ds_read_b64_tr_b16 v[216:217], v194 offset:8192
    ds_read_b64_tr_b16 v[218:219], v194 offset:9216
    v_mfma_f32_16x16x32_bf16 v[180:183], v[52:55], v[84:87], v[180:183]
    ds_read_b64_tr_b16 v[220:221], v195 offset:8192
    ds_read_b64_tr_b16 v[222:223], v195 offset:9216
    v_mfma_f32_16x16x32_bf16 v[168:171], v[56:59], v[80:83], v[168:171]
    ds_read_b128 v[16:19], v109 offset:4096
    ds_read_b128 v[20:23], v109 offset:6144
    v_mfma_f32_16x16x32_bf16 v[184:187], v[56:59], v[84:87], v[184:187]
    v_mfma_f32_16x16x32_bf16 v[172:175], v[60:63], v[80:83], v[172:175]
    v_mfma_f32_16x16x32_bf16 v[188:191], v[60:63], v[84:87], v[188:191]
    s_waitcnt lgkmcnt(10)
    v_mfma_f32_16x16x32_bf16 v[160:163], v[64:67], v[88:91], v[160:163]
    s_barrier
    ds_read_b64_tr_b16 v[224:225], v196 offset:0
    v_mfma_f32_16x16x32_bf16 v[176:179], v[64:67], v[92:95], v[176:179]
    ds_read_b64_tr_b16 v[226:227], v196 offset:1024
    ds_read_b64_tr_b16 v[228:229], v197 offset:0
    v_mfma_f32_16x16x32_bf16 v[164:167], v[68:71], v[88:91], v[164:167]
    ds_read_b64_tr_b16 v[230:231], v197 offset:1024
    ds_read_b64_tr_b16 v[232:233], v198 offset:0
    v_mfma_f32_16x16x32_bf16 v[180:183], v[68:71], v[92:95], v[180:183]
    ds_read_b64_tr_b16 v[234:235], v198 offset:1024
    ds_read_b64_tr_b16 v[236:237], v199 offset:0
    v_mfma_f32_16x16x32_bf16 v[168:171], v[72:75], v[88:91], v[168:171]
    ds_read_b64_tr_b16 v[238:239], v199 offset:1024
    ds_read_b128 v[24:27], v110 offset:4096
    v_mfma_f32_16x16x32_bf16 v[184:187], v[72:75], v[92:95], v[184:187]
    ds_read_b128 v[28:31], v110 offset:6144
    v_mfma_f32_16x16x32_bf16 v[172:175], v[76:79], v[88:91], v[172:175]
    v_mfma_f32_16x16x32_bf16 v[188:191], v[76:79], v[92:95], v[188:191]
    s_waitcnt lgkmcnt(10)
    v_mfma_f32_16x16x32_bf16 v[160:163], v[208:211], v[16:19], v[160:163]
    ds_read_b64_tr_b16 v[240:241], v196 offset:8192
    ds_read_b64_tr_b16 v[242:243], v196 offset:9216
    v_mfma_f32_16x16x32_bf16 v[176:179], v[208:211], v[20:23], v[176:179]
    ds_read_b64_tr_b16 v[244:245], v197 offset:8192
    ds_read_b64_tr_b16 v[246:247], v197 offset:9216
    v_mfma_f32_16x16x32_bf16 v[164:167], v[212:215], v[16:19], v[164:167]
    ds_read_b64_tr_b16 v[248:249], v198 offset:8192
    ds_read_b64_tr_b16 v[250:251], v198 offset:9216
    v_mfma_f32_16x16x32_bf16 v[180:183], v[212:215], v[20:23], v[180:183]
    ds_read_b64_tr_b16 v[252:253], v199 offset:8192
    ds_read_b64_tr_b16 v[254:255], v199 offset:9216
    v_mfma_f32_16x16x32_bf16 v[168:171], v[216:219], v[16:19], v[168:171]
    ds_read_b128 v[32:35], v111 offset:4096
    ds_read_b128 v[36:39], v111 offset:6144
    v_mfma_f32_16x16x32_bf16 v[184:187], v[216:219], v[20:23], v[184:187]
    v_mfma_f32_16x16x32_bf16 v[172:175], v[220:223], v[16:19], v[172:175]
    v_mfma_f32_16x16x32_bf16 v[188:191], v[220:223], v[20:23], v[188:191]
    s_waitcnt lgkmcnt(10)
    v_mfma_f32_16x16x32_bf16 v[160:163], v[224:227], v[24:27], v[160:163]
    ds_read_b128 v[40:43], v5 offset:0
    ds_read_b128 v[44:47], v5 offset:2048
    v_mfma_f32_16x16x32_bf16 v[176:179], v[224:227], v[28:31], v[176:179]
    ds_read_b128 v[80:83], v108 offset:0
    ds_read_b128 v[84:87], v108 offset:2048
    v_mfma_f32_16x16x32_bf16 v[164:167], v[228:231], v[24:27], v[164:167]
    v_mfma_f32_16x16x32_bf16 v[180:183], v[228:231], v[28:31], v[180:183]
    v_mfma_f32_16x16x32_bf16 v[168:171], v[232:235], v[24:27], v[168:171]
    v_mfma_f32_16x16x32_bf16 v[184:187], v[232:235], v[28:31], v[184:187]
    v_mfma_f32_16x16x32_bf16 v[172:175], v[236:239], v[24:27], v[172:175]
    v_mfma_f32_16x16x32_bf16 v[188:191], v[236:239], v[28:31], v[188:191]
    s_waitcnt lgkmcnt(4)
    v_mfma_f32_16x16x32_bf16 v[160:163], v[240:243], v[32:35], v[160:163]
    ds_read_b128 v[88:91], v109 offset:0
    ds_read_b128 v[92:95], v109 offset:2048
    v_mfma_f32_16x16x32_bf16 v[176:179], v[240:243], v[36:39], v[176:179]
    ds_read_b128 v[16:19], v110 offset:0
    ds_read_b128 v[20:23], v110 offset:2048
    v_mfma_f32_16x16x32_bf16 v[164:167], v[244:247], v[32:35], v[164:167]
    v_mfma_f32_16x16x32_bf16 v[180:183], v[244:247], v[36:39], v[180:183]
    v_mfma_f32_16x16x32_bf16 v[168:171], v[248:251], v[32:35], v[168:171]
    v_mfma_f32_16x16x32_bf16 v[184:187], v[248:251], v[36:39], v[184:187]
    v_mfma_f32_16x16x32_bf16 v[172:175], v[252:255], v[32:35], v[172:175]
    v_mfma_f32_16x16x32_bf16 v[188:191], v[252:255], v[36:39], v[188:191]
    s_waitcnt lgkmcnt(6)
    v_mfma_f32_16x16x32_bf16 v[128:131], v[48:51], v[40:43], v[128:131]
    ds_read_b128 v[24:27], v111 offset:0
    ds_read_b128 v[28:31], v111 offset:2048
    v_mfma_f32_16x16x32_bf16 v[144:147], v[48:51], v[44:47], v[144:147]
    v_mfma_f32_16x16x32_bf16 v[132:135], v[52:55], v[40:43], v[132:135]
    v_mfma_f32_16x16x32_bf16 v[148:151], v[52:55], v[44:47], v[148:151]
    v_mfma_f32_16x16x32_bf16 v[136:139], v[56:59], v[40:43], v[136:139]
    v_mfma_f32_16x16x32_bf16 v[152:155], v[56:59], v[44:47], v[152:155]
    v_mfma_f32_16x16x32_bf16 v[140:143], v[60:63], v[40:43], v[140:143]
    v_mfma_f32_16x16x32_bf16 v[156:159], v[60:63], v[44:47], v[156:159]
    s_waitcnt lgkmcnt(6)
    v_mfma_f32_16x16x32_bf16 v[128:131], v[64:67], v[80:83], v[128:131]
    v_cvt_pk_bf16_f32 v96, v160, v161
    v_cvt_pk_bf16_f32 v97, v162, v163
    v_cvt_pk_bf16_f32 v98, v164, v165
    v_mfma_f32_16x16x32_bf16 v[144:147], v[64:67], v[84:87], v[144:147]
    v_cvt_pk_bf16_f32 v99, v166, v167
    buffer_store_dwordx4 v[96:99], v116, s[56:59], 0 offen offset:0 sc1
    v_cvt_pk_bf16_f32 v100, v168, v169
    v_mfma_f32_16x16x32_bf16 v[132:135], v[68:71], v[80:83], v[132:135]
    v_cvt_pk_bf16_f32 v101, v170, v171
    v_cvt_pk_bf16_f32 v102, v172, v173
    v_cvt_pk_bf16_f32 v103, v174, v175
    v_mfma_f32_16x16x32_bf16 v[148:151], v[68:71], v[84:87], v[148:151]
    buffer_store_dwordx4 v[100:103], v116, s[56:59], 0 offen offset:1024 sc1
    v_cvt_pk_bf16_f32 v200, v176, v177
    v_cvt_pk_bf16_f32 v201, v178, v179
    v_mfma_f32_16x16x32_bf16 v[136:139], v[72:75], v[80:83], v[136:139]
    v_cvt_pk_bf16_f32 v202, v180, v181
    v_cvt_pk_bf16_f32 v203, v182, v183
    buffer_store_dwordx4 v[200:203], v116, s[56:59], 0 offen offset:2048 sc1
    v_mfma_f32_16x16x32_bf16 v[152:155], v[72:75], v[84:87], v[152:155]
    v_cvt_pk_bf16_f32 v204, v184, v185
    v_cvt_pk_bf16_f32 v205, v186, v187
    v_cvt_pk_bf16_f32 v206, v188, v189
    v_mfma_f32_16x16x32_bf16 v[140:143], v[76:79], v[80:83], v[140:143]
    v_cvt_pk_bf16_f32 v207, v190, v191
    buffer_store_dwordx4 v[204:207], v116, s[56:59], 0 offen offset:3072 sc1
    v_mfma_f32_16x16x32_bf16 v[156:159], v[76:79], v[84:87], v[156:159]
    s_waitcnt lgkmcnt(4)
    v_mfma_f32_16x16x32_bf16 v[128:131], v[208:211], v[88:91], v[128:131]
    s_barrier
    ds_read_b64 v[32:33], v112 offset:0
    v_mfma_f32_16x16x32_bf16 v[144:147], v[208:211], v[92:95], v[144:147]
    ds_read_b64 v[34:35], v113 offset:0
    ds_read_b64 v[36:37], v114 offset:0
    v_mfma_f32_16x16x32_bf16 v[132:135], v[212:215], v[88:91], v[132:135]
    ds_read_b64 v[38:39], v115 offset:0
    ds_read_b64 v[40:41], v112 offset:2048
    v_mfma_f32_16x16x32_bf16 v[148:151], v[212:215], v[92:95], v[148:151]
    ds_read_b64 v[42:43], v113 offset:2048
    ds_read_b64 v[44:45], v114 offset:2048
    v_mfma_f32_16x16x32_bf16 v[136:139], v[216:219], v[88:91], v[136:139]
    ds_read_b64 v[46:47], v115 offset:2048
    v_mfma_f32_16x16x32_bf16 v[152:155], v[216:219], v[92:95], v[152:155]
    v_mfma_f32_16x16x32_bf16 v[140:143], v[220:223], v[88:91], v[140:143]
    v_mfma_f32_16x16x32_bf16 v[156:159], v[220:223], v[92:95], v[156:159]
    s_waitcnt lgkmcnt(10)
    v_mfma_f32_16x16x32_bf16 v[128:131], v[224:227], v[16:19], v[128:131]
    v_mfma_f32_16x16x32_bf16 v[144:147], v[224:227], v[20:23], v[144:147]
    v_mfma_f32_16x16x32_bf16 v[132:135], v[228:231], v[16:19], v[132:135]
    v_mfma_f32_16x16x32_bf16 v[148:151], v[228:231], v[20:23], v[148:151]
    v_mfma_f32_16x16x32_bf16 v[136:139], v[232:235], v[16:19], v[136:139]
    v_mfma_f32_16x16x32_bf16 v[152:155], v[232:235], v[20:23], v[152:155]
    v_mfma_f32_16x16x32_bf16 v[140:143], v[236:239], v[16:19], v[140:143]
    v_mfma_f32_16x16x32_bf16 v[156:159], v[236:239], v[20:23], v[156:159]
    s_waitcnt lgkmcnt(8)
    v_mfma_f32_16x16x32_bf16 v[128:131], v[240:243], v[24:27], v[128:131]
    v_mfma_f32_16x16x32_bf16 v[144:147], v[240:243], v[28:31], v[144:147]
    v_mfma_f32_16x16x32_bf16 v[132:135], v[244:247], v[24:27], v[132:135]
    v_mfma_f32_16x16x32_bf16 v[148:151], v[244:247], v[28:31], v[148:151]
    v_mfma_f32_16x16x32_bf16 v[136:139], v[248:251], v[24:27], v[136:139]
    v_mfma_f32_16x16x32_bf16 v[152:155], v[248:251], v[28:31], v[152:155]
    v_mfma_f32_16x16x32_bf16 v[140:143], v[252:255], v[24:27], v[140:143]
    v_mfma_f32_16x16x32_bf16 v[156:159], v[252:255], v[28:31], v[156:159]
    s_mov_b32 s71, 0
    buffer_load_dwordx4 v[192:195], v117, s[56:59], 0 offen offset:0 sc1
    buffer_load_dwordx4 v[196:199], v117, s[56:59], 0 offen offset:1024 sc1
    buffer_load_dwordx4 v[200:203], v117, s[56:59], 0 offen offset:2048 sc1
    buffer_load_dwordx4 v[204:207], v117, s[56:59], 0 offen offset:3072 sc1
    s_waitcnt vmcnt(8)
    v_sub_f32 v104, 1.0, v104
    v_cvt_pk_bf16_f32 v104, v104, v104
    v_lshlrev_b32 v104, 16, v104
    v_sub_f32 v106, 1.0, v106
    v_cvt_pk_bf16_f32 v106, v106, v106
    v_lshlrev_b32 v106, 16, v106
    s_waitcnt lgkmcnt(0)
    v_lshlrev_b32 v224, 16, v32
    v_and_b32 v225, 0xffff0000, v32
    v_lshlrev_b32 v226, 16, v33
    v_and_b32 v227, 0xffff0000, v33
    v_lshlrev_b32 v228, 16, v34
    v_and_b32 v229, 0xffff0000, v34
    v_lshlrev_b32 v230, 16, v35
    v_and_b32 v231, 0xffff0000, v35
    v_lshlrev_b32 v232, 16, v36
    v_and_b32 v233, 0xffff0000, v36
    v_lshlrev_b32 v234, 16, v37
    v_and_b32 v235, 0xffff0000, v37
    v_lshlrev_b32 v236, 16, v38
    v_and_b32 v237, 0xffff0000, v38
    v_lshlrev_b32 v238, 16, v39
    v_and_b32 v239, 0xffff0000, v39
    v_lshlrev_b32 v240, 16, v40
    v_and_b32 v241, 0xffff0000, v40
    v_lshlrev_b32 v242, 16, v41
    v_and_b32 v243, 0xffff0000, v41
    v_lshlrev_b32 v244, 16, v42
    v_and_b32 v245, 0xffff0000, v42
    v_lshlrev_b32 v246, 16, v43
    v_and_b32 v247, 0xffff0000, v43
    v_lshlrev_b32 v248, 16, v44
    v_and_b32 v249, 0xffff0000, v44
    v_lshlrev_b32 v250, 16, v45
    v_and_b32 v251, 0xffff0000, v45
    v_lshlrev_b32 v252, 16, v46
    v_and_b32 v253, 0xffff0000, v46
    v_lshlrev_b32 v254, 16, v47
    v_and_b32 v255, 0xffff0000, v47
    v_pk_fma_f32 v[128:129], v[224:225], v[104:105], v[128:129] op_sel:[0,0,0] op_sel_hi:[1,0,1]
    v_pk_fma_f32 v[130:131], v[226:227], v[104:105], v[130:131] op_sel:[0,0,0] op_sel_hi:[1,0,1]
    v_pk_fma_f32 v[132:133], v[228:229], v[104:105], v[132:133] op_sel:[0,0,0] op_sel_hi:[1,0,1]
    v_pk_fma_f32 v[134:135], v[230:231], v[104:105], v[134:135] op_sel:[0,0,0] op_sel_hi:[1,0,1]
    v_pk_fma_f32 v[136:137], v[232:233], v[104:105], v[136:137] op_sel:[0,0,0] op_sel_hi:[1,0,1]
    v_pk_fma_f32 v[138:139], v[234:235], v[104:105], v[138:139] op_sel:[0,0,0] op_sel_hi:[1,0,1]
    v_pk_fma_f32 v[140:141], v[236:237], v[104:105], v[140:141] op_sel:[0,0,0] op_sel_hi:[1,0,1]
    v_pk_fma_f32 v[142:143], v[238:239], v[104:105], v[142:143] op_sel:[0,0,0] op_sel_hi:[1,0,1]
    v_pk_fma_f32 v[144:145], v[240:241], v[106:107], v[144:145] op_sel:[0,0,0] op_sel_hi:[1,0,1]
    v_pk_fma_f32 v[146:147], v[242:243], v[106:107], v[146:147] op_sel:[0,0,0] op_sel_hi:[1,0,1]
    v_pk_fma_f32 v[148:149], v[244:245], v[106:107], v[148:149] op_sel:[0,0,0] op_sel_hi:[1,0,1]
    v_pk_fma_f32 v[150:151], v[246:247], v[106:107], v[150:151] op_sel:[0,0,0] op_sel_hi:[1,0,1]
    v_pk_fma_f32 v[152:153], v[248:249], v[106:107], v[152:153] op_sel:[0,0,0] op_sel_hi:[1,0,1]
    v_pk_fma_f32 v[154:155], v[250:251], v[106:107], v[154:155] op_sel:[0,0,0] op_sel_hi:[1,0,1]
    v_pk_fma_f32 v[156:157], v[252:253], v[106:107], v[156:157] op_sel:[0,0,0] op_sel_hi:[1,0,1]
    v_pk_fma_f32 v[158:159], v[254:255], v[106:107], v[158:159] op_sel:[0,0,0] op_sel_hi:[1,0,1]
    s_mov_b32 s72, 0x40000
L_xpoll_82:
    s_waitcnt vmcnt(0)
    v_max3_u32 v2, v192, v193, v194
    v_max3_u32 v3, v195, v196, v197
    v_max3_u32 v2, v2, v198, v199
    v_max3_u32 v3, v3, v200, v201
    v_max3_u32 v2, v2, v202, v203
    v_max3_u32 v3, v3, v204, v205
    v_max3_u32 v2, v2, v206, v207
    v_max_u32 v2, v2, v3
    v_cmp_eq_u32 vcc, -1, v2
    s_sub_u32 s72, s72, 1
    s_cmp_eq_u32 s72, 0
    s_cbranch_scc1 L_xpolld_83
    s_cmp_eq_u64 vcc, 0
    s_cbranch_scc1 L_xpolld_83
    s_sleep 2
    buffer_load_dwordx4 v[192:195], v117, s[56:59], 0 offen offset:0 sc1
    buffer_load_dwordx4 v[196:199], v117, s[56:59], 0 offen offset:1024 sc1
    buffer_load_dwordx4 v[200:203], v117, s[56:59], 0 offen offset:2048 sc1
    buffer_load_dwordx4 v[204:207], v117, s[56:59], 0 offen offset:3072 sc1
    s_branch L_xpoll_82
L_xpolld_83:
    v_lshlrev_b32 v224, 16, v192
    v_and_b32 v225, 0xffff0000, v192
    v_lshlrev_b32 v226, 16, v193
    v_and_b32 v227, 0xffff0000, v193
    v_lshlrev_b32 v228, 16, v194
    v_and_b32 v229, 0xffff0000, v194
    v_lshlrev_b32 v230, 16, v195
    v_and_b32 v231, 0xffff0000, v195
    v_lshlrev_b32 v232, 16, v196
    v_and_b32 v233, 0xffff0000, v196
    v_lshlrev_b32 v234, 16, v197
    v_and_b32 v235, 0xffff0000, v197
    v_lshlrev_b32 v236, 16, v198
    v_and_b32 v237, 0xffff0000, v198
    v_lshlrev_b32 v238, 16, v199
    v_and_b32 v239, 0xffff0000, v199
    v_lshlrev_b32 v240, 16, v200
    v_and_b32 v241, 0xffff0000, v200
    v_lshlrev_b32 v242, 16, v201
    v_and_b32 v243, 0xffff0000, v201
    v_lshlrev_b32 v244, 16, v202
    v_and_b32 v245, 0xffff0000, v202
    v_lshlrev_b32 v246, 16, v203
    v_and_b32 v247, 0xffff0000, v203
    v_lshlrev_b32 v248, 16, v204
    v_and_b32 v249, 0xffff0000, v204
    v_lshlrev_b32 v250, 16, v205
    v_and_b32 v251, 0xffff0000, v205
    v_lshlrev_b32 v252, 16, v206
    v_and_b32 v253, 0xffff0000, v206
    v_lshlrev_b32 v254, 16, v207
    v_and_b32 v255, 0xffff0000, v207
    v_pk_add_f32 v[128:129], v[128:129], v[224:225]
    v_pk_add_f32 v[130:131], v[130:131], v[226:227]
    v_pk_add_f32 v[132:133], v[132:133], v[228:229]
    v_pk_add_f32 v[134:135], v[134:135], v[230:231]
    v_pk_add_f32 v[136:137], v[136:137], v[232:233]
    v_pk_add_f32 v[138:139], v[138:139], v[234:235]
    v_pk_add_f32 v[140:141], v[140:141], v[236:237]
    v_pk_add_f32 v[142:143], v[142:143], v[238:239]
    v_cvt_pk_bf16_f32 v48, v128, v129
    v_cvt_pk_bf16_f32 v49, v130, v131
    v_cvt_pk_bf16_f32 v50, v132, v133
    v_cvt_pk_bf16_f32 v51, v134, v135
    v_cvt_pk_bf16_f32 v52, v136, v137
    v_cvt_pk_bf16_f32 v53, v138, v139
    v_cvt_pk_bf16_f32 v54, v140, v141
    v_cvt_pk_bf16_f32 v55, v142, v143
    ds_write_b64 v112, v[48:49] offset:0
    ds_write_b64 v113, v[50:51] offset:0
    ds_write_b64 v114, v[52:53] offset:0
    ds_write_b64 v115, v[54:55] offset:0
    v_pk_add_f32 v[144:145], v[144:145], v[240:241]
    v_pk_add_f32 v[146:147], v[146:147], v[242:243]
    v_pk_add_f32 v[148:149], v[148:149], v[244:245]
    v_pk_add_f32 v[150:151], v[150:151], v[246:247]
    v_pk_add_f32 v[152:153], v[152:153], v[248:249]
    v_pk_add_f32 v[154:155], v[154:155], v[250:251]
    v_pk_add_f32 v[156:157], v[156:157], v[252:253]
    v_pk_add_f32 v[158:159], v[158:159], v[254:255]
    v_cvt_pk_bf16_f32 v56, v144, v145
    v_cvt_pk_bf16_f32 v57, v146, v147
    v_cvt_pk_bf16_f32 v58, v148, v149
    v_cvt_pk_bf16_f32 v59, v150, v151
    v_cvt_pk_bf16_f32 v60, v152, v153
    v_cvt_pk_bf16_f32 v61, v154, v155
    v_cvt_pk_bf16_f32 v62, v156, v157
    v_cvt_pk_bf16_f32 v63, v158, v159
    ds_write_b64 v112, v[56:57] offset:2048
    ds_write_b64 v113, v[58:59] offset:2048
    ds_write_b64 v114, v[60:61] offset:2048
    ds_write_b64 v115, v[62:63] offset:2048
    ds_read_b128 v[32:35], v118 offset:0
    ds_read_b128 v[36:39], v119 offset:1024
    ds_read_b128 v[40:43], v118 offset:2048
    ds_read_b128 v[44:47], v119 offset:3072
    s_waitcnt lgkmcnt(0)
    v_add_u32 v8, 0x0, v120
    v_add_u32 v9, 0x4000, v120
    v_add_u32 v10, 0x8000, v120
    v_add_u32 v11, 0xc000, v120
    buffer_store_dwordx4 v[32:35], v8, s[36:39], 0 offen sc0 sc1
    buffer_store_dwordx4 v[36:39], v9, s[36:39], 0 offen sc0 sc1
    buffer_store_dwordx4 v[40:43], v10, s[36:39], 0 offen sc0 sc1
    buffer_store_dwordx4 v[44:47], v11, s[36:39], 0 offen sc0 sc1
    s_branch L_gated_mix__linear_attn_block__mixer_s_mlp__prompt_kernel_end
L_owg_c:
    s_add_u32 s44, s26, 0x3000000
    s_addc_u32 s45, s27, 0
    s_mov_b32 s46, 0x1000000
    s_mov_b32 s47, 0x20000
    s_cmp_eq_u32 s76, 0
    s_mov_b32 s73, 0x51743260
    s_cselect_b32 s73, 0x76543210, s73
    s_lshl_b32 s71, s63, 2
    s_lshr_b32 s73, s73, s71
    s_and_b32 s73, s73, 7
    s_lshl_b32 s71, s77, 3
    s_add_u32 s71, s71, s73
    s_lshl_b32 s71, s71, 1
    s_add_u32 s71, s71, s76
    s_lshl_b32 s71, s71, 2
    s_add_u32 s71, s71, s60
    s_lshl_b32 s71, s71, 14
    v_lshlrev_b32 v252, 4, v1
    v_mov_b32 v248, -1
    v_mov_b32 v249, -1
    v_mov_b32 v250, -1
    v_mov_b32 v251, -1
    v_add_u32 v252, s71, v252
    s_mov_b32 s71, 0
    buffer_store_dwordx4 v[248:251], v252, s[44:47], s71 offen offset:0 sc1
    s_mov_b32 s71, 0
    buffer_store_dwordx4 v[248:251], v252, s[44:47], s71 offen offset:1024 sc1
    s_mov_b32 s71, 0
    buffer_store_dwordx4 v[248:251], v252, s[44:47], s71 offen offset:2048 sc1
    s_mov_b32 s71, 0
    buffer_store_dwordx4 v[248:251], v252, s[44:47], s71 offen offset:3072 sc1
    s_nop 1
    s_waitcnt vmcnt(0)
    s_barrier
    s_cmp_lg_u32 s60, 0
    s_cbranch_scc1 L_w0_84
    s_add_u32 s48, s26, 0x2700000
    s_addc_u32 s49, s27, 0
    s_mov_b32 s50, 0x8000
    s_mov_b32 s51, 0x20000
    s_lshl_b32 s71, s77, 7
    s_add_u32 s71, s71, 12288
    v_mov_b32 v2, s71
    v_mov_b32 v3, 1
    s_mov_b64 exec, 1
    buffer_atomic_add v3, v2, s[48:51], 0 offen sc1
    s_mov_b64 exec, -1
    s_add_u32 s48, s26, 0x2700000
    s_addc_u32 s49, s27, 0
    s_mov_b32 s50, 0x8000
    s_mov_b32 s51, 0x20000
    v_mov_b32 v2, 20480
    v_mov_b32 v3, 1
    s_mov_b64 exec, 1
    buffer_atomic_add v3, v2, s[48:51], 0 offen sc1
    s_mov_b64 exec, -1
    s_cmp_lg_u32 s60, 0
    s_cbranch_scc1 L_cnd_85
    s_cmp_eq_u32 s76, 0
    s_mov_b32 s73, 0x51743260
    s_cselect_b32 s73, 0x76543210, s73
    s_lshl_b32 s71, s63, 2
    s_lshr_b32 s73, s73, s71
    s_and_b32 s73, s73, 7
    s_lshl_b32 s72, s77, 3
    s_add_u32 s73, s73, s72
    s_lshl_b32 s73, s73, 1
    s_add_u32 s73, s73, s76
    s_xor_b32 s73, s73, 1
    s_lshl_b32 s73, s73, 5
    s_add_u32 s48, s26, 0x2700000
    s_addc_u32 s49, s27, 0
    s_mov_b32 s50, 0x8000
    s_mov_b32 s51, 0x20000
    s_add_u32 s71, s73, 24576
    v_mov_b32 v2, s71
    v_mov_b32 v3, 1
    s_mov_b64 exec, 1
    buffer_atomic_add v3, v2, s[48:51], 0 offen sc1
    s_mov_b64 exec, -1
L_cnd_85:
    s_add_u32 s48, s26, 0x2700000
    s_addc_u32 s49, s27, 0
    s_mov_b32 s50, 0x8000
    s_mov_b32 s51, 0x20000
    v_mov_b32 v2, 20480
    v_mov_b32 v125, 0
    s_mov_b32 s71, 20480
    v_writelane_b32 v2, s71, 0
    s_mov_b32 s71, 32
    v_writelane_b32 v125, s71, 0
    s_lshl_b32 s71, s68, 7
    s_add_u32 s71, s71, 12288
    v_writelane_b32 v2, s71, 1
    s_mov_b32 s71, 8
    v_writelane_b32 v125, s71, 1
    s_lshl_b32 s71, s77, 7
    s_add_u32 s71, s71, 0
    v_writelane_b32 v2, s71, 2
    s_mov_b32 s71, 8
    v_writelane_b32 v125, s71, 2
    s_mov_b32 s72, 0x40000
L_poll_86:
    buffer_load_dword v3, v2, s[48:51], 0 offen sc1
    s_waitcnt vmcnt(0)
    v_cmp_lt_u32 vcc, v3, v125
    s_sub_u32 s72, s72, 1
    s_cmp_eq_u32 s72, 0
    s_cbranch_scc1 L_polld_87
    s_cmp_eq_u64 vcc, 0
    s_cbranch_scc1 L_polld_87
    s_sleep 4
    s_branch L_poll_86
L_polld_87:
L_w0_84:
    s_barrier
L_owg:
    s_sub_u32 s71, s80, 24
    s_and_b32 s72, s79, 3
    s_lshl_b32 s72, s72, 3
    s_add_u32 s73, s71, s72
    s_mov_b32 s28, s26
    s_mov_b32 s29, s27
    s_mov_b32 s30, 0x400000
    s_mov_b32 s31, 0x20000
    s_xor_b32 s65, s60, 4
    s_lshl_b32 s65, s65, 14
    v_lshrrev_b32 v2, 4, v1
    v_and_b32 v3, 15, v1
    v_xor_b32 v3, v3, v2
    v_lshlrev_b32 v2, 11, v2
    v_xor_b32 v4, 0, v3
    v_lshl_add_u32 v4, v4, 4, v2
    v_xor_b32 v5, 4, v3
    v_lshl_add_u32 v5, v5, 4, v2
    v_add_u32 v5, 7168, v5
    v_xor_b32 v6, 8, v3
    v_lshl_add_u32 v6, v6, 4, v2
    v_add_u32 v6, 14336, v6
    v_xor_b32 v7, 12, v3
    v_lshl_add_u32 v7, v7, 4, v2
    v_add_u32 v7, 21504, v7
    s_lshl_b32 s74, s73, 17
    s_lshl_b32 s71, s60, 8
    s_add_u32 s74, s74, s71
    s_add_u32 m0, s65, 0
    s_nop 0
    buffer_load_dwordx4 v4, s[28:31], s74 offen offset:0 sc1 lds
    buffer_load_dwordx4 v5, s[28:31], s74 offen offset:1024 sc1 lds
    buffer_load_dwordx4 v6, s[28:31], s74 offen offset:2048 sc1 lds
    buffer_load_dwordx4 v7, s[28:31], s74 offen offset:3072 sc1 lds
    s_add_u32 s74, s74, 32768
    s_add_u32 m0, s65, 4096
    s_nop 0
    buffer_load_dwordx4 v4, s[28:31], s74 offen offset:0 sc1 lds
    buffer_load_dwordx4 v5, s[28:31], s74 offen offset:1024 sc1 lds
    buffer_load_dwordx4 v6, s[28:31], s74 offen offset:2048 sc1 lds
    buffer_load_dwordx4 v7, s[28:31], s74 offen offset:3072 sc1 lds
    s_add_u32 s74, s74, 32768
    s_add_u32 m0, s65, 8192
    s_nop 0
    buffer_load_dwordx4 v4, s[28:31], s74 offen offset:0 sc1 lds
    buffer_load_dwordx4 v5, s[28:31], s74 offen offset:1024 sc1 lds
    buffer_load_dwordx4 v6, s[28:31], s74 offen offset:2048 sc1 lds
    buffer_load_dwordx4 v7, s[28:31], s74 offen offset:3072 sc1 lds
    s_add_u32 s74, s74, 32768
    s_add_u32 m0, s65, 12288
    s_nop 0
    buffer_load_dwordx4 v4, s[28:31], s74 offen offset:0 sc1 lds
    buffer_load_dwordx4 v5, s[28:31], s74 offen offset:1024 sc1 lds
    buffer_load_dwordx4 v6, s[28:31], s74 offen offset:2048 sc1 lds
    buffer_load_dwordx4 v7, s[28:31], s74 offen offset:3072 sc1 lds
    s_add_u32 s74, s74, 32768
    s_add_u32 s28, s26, 0x2300000
    s_addc_u32 s29, s27, 0
    s_mov_b32 s30, 0x2000
    s_mov_b32 s31, 0x20000
    v_and_b32 v11, 31, v1
    v_lshlrev_b32 v11, 2, v11
    s_lshl_b32 s73, s73, 8
    buffer_load_dword v12, v11, s[28:31], s73 offen sc1
    buffer_load_dword v13, v11, s[28:31], s73 offen offset:128 sc1
    s_sub_u32 s71, s80, 24
    s_and_b32 s72, s79, 3
    s_lshl_b32 s72, s72, 3
    s_add_u32 s78, s71, s72
    s_waitcnt lgkmcnt(0)
    s_add_u32 s28, s26, 0x2400000
    s_addc_u32 s29, s27, 0
    s_mov_b32 s30, 0x10000
    s_mov_b32 s31, 0x20000
    s_add_u32 s32, s26, 0x2410000
    s_addc_u32 s33, s27, 0
    s_mov_b32 s34, 0x800
    s_mov_b32 s35, 0x20000
    s_mov_b32 s36, s26
    s_mov_b32 s37, s27
    s_mov_b32 s38, 0x400000
    s_mov_b32 s39, 0x20000
    s_mov_b32 s40, s26
    s_mov_b32 s41, s27
    s_mov_b32 s42, 0x400000
    s_mov_b32 s43, 0x20000
    s_mov_b32 s52, s4
    s_mov_b32 s53, s5
    s_mov_b32 s54, 0x400000
    s_mov_b32 s55, 0x20000
    s_add_u32 s44, s26, 0x2300000
    s_addc_u32 s45, s27, 0
    s_mov_b32 s46, 0x2000
    s_mov_b32 s47, 0x20000
    v_and_b32 v2, 31, v1
    v_lshrrev_b32 v3, 5, v1
    v_lshlrev_b32 v3, 4, v3
    v_lshlrev_b32 v4, 5, v3
    v_lshl_add_u32 v4, v2, 3, v4
    s_lshl_b32 s71, s60, 13
    v_add_u32 v4, s71, v4
    s_lshl_b32 s71, s60, 8
    v_add_u32 v5, s71, v3
    s_lshl_b32 s72, s78, 6
    v_add_u32 v6, s72, v2
    v_lshlrev_b32 v6, 11, v6
    v_add3_u32 v6, v6, v3, s71
    v_add_u32 v7, 0x10000, v6
    buffer_load_dwordx2 v[16:17], v4, s[28:31], 0 offen offset:0 sc1
    buffer_load_dwordx2 v[18:19], v4, s[28:31], 0 offen offset:256 sc1
    buffer_load_dwordx2 v[20:21], v4, s[28:31], 0 offen offset:1024 sc1
    buffer_load_dwordx2 v[22:23], v4, s[28:31], 0 offen offset:1280 sc1
    buffer_load_dwordx2 v[24:25], v4, s[28:31], 0 offen offset:2048 sc1
    buffer_load_dwordx2 v[26:27], v4, s[28:31], 0 offen offset:2304 sc1
    buffer_load_dwordx2 v[28:29], v4, s[28:31], 0 offen offset:3072 sc1
    buffer_load_dwordx2 v[30:31], v4, s[28:31], 0 offen offset:3328 sc1
    v_add_u32 v8, 4096, v4
    buffer_load_dwordx2 v[32:33], v8, s[28:31], 0 offen offset:0 sc1
    buffer_load_dwordx2 v[34:35], v8, s[28:31], 0 offen offset:256 sc1
    buffer_load_dwordx2 v[36:37], v8, s[28:31], 0 offen offset:1024 sc1
    buffer_load_dwordx2 v[38:39], v8, s[28:31], 0 offen offset:1280 sc1
    buffer_load_dwordx2 v[40:41], v8, s[28:31], 0 offen offset:2048 sc1
    buffer_load_dwordx2 v[42:43], v8, s[28:31], 0 offen offset:2304 sc1
    buffer_load_dwordx2 v[44:45], v8, s[28:31], 0 offen offset:3072 sc1
    buffer_load_dwordx2 v[46:47], v8, s[28:31], 0 offen offset:3328 sc1
    buffer_load_dwordx4 v[48:51], v5, s[32:35], 0 offen offset:0 sc1
    buffer_load_dwordx4 v[52:55], v5, s[32:35], 0 offen offset:32 sc1
    buffer_load_dwordx4 v[56:59], v5, s[32:35], 0 offen offset:64 sc1
    buffer_load_dwordx4 v[60:63], v5, s[32:35], 0 offen offset:96 sc1
    buffer_load_dwordx4 v[64:67], v5, s[32:35], 0 offen offset:128 sc1
    buffer_load_dwordx4 v[68:71], v5, s[32:35], 0 offen offset:160 sc1
    buffer_load_dwordx4 v[72:75], v5, s[32:35], 0 offen offset:192 sc1
    buffer_load_dwordx4 v[76:79], v5, s[32:35], 0 offen offset:224 sc1
    v_and_b32 v6, 15, v1
    v_lshrrev_b32 v7, 5, v1
    v_xor_b32 v6, v6, v7
    v_and_b32 v7, 31, v1
    v_lshlrev_b32 v7, 8, v7
    v_add_u32 v7, s65, v7
    v_xor_b32 v144, 0, v6
    v_lshl_add_u32 v144, v144, 4, v7
    v_xor_b32 v145, 2, v6
    v_lshl_add_u32 v145, v145, 4, v7
    v_xor_b32 v146, 4, v6
    v_lshl_add_u32 v146, v146, 4, v7
    v_xor_b32 v147, 6, v6
    v_lshl_add_u32 v147, v147, 4, v7
    v_xor_b32 v148, 8, v6
    v_lshl_add_u32 v148, v148, 4, v7
    v_xor_b32 v149, 10, v6
    v_lshl_add_u32 v149, v149, 4, v7
    v_xor_b32 v150, 12, v6
    v_lshl_add_u32 v150, v150, 4, v7
    v_xor_b32 v151, 14, v6
    v_lshl_add_u32 v151, v151, 4, v7
    s_waitcnt vmcnt(24)
    ds_read_b128 v[80:83], v144 offset:0
    ds_read_b128 v[84:87], v145 offset:0
    ds_read_b128 v[88:91], v146 offset:0
    ds_read_b128 v[92:95], v147 offset:0
    ds_read_b128 v[96:99], v148 offset:0
    ds_read_b128 v[100:103], v149 offset:0
    ds_read_b128 v[104:107], v150 offset:0
    ds_read_b128 v[108:111], v151 offset:0
    ds_read_b128 v[112:115], v144 offset:8192
    ds_read_b128 v[116:119], v145 offset:8192
    ds_read_b128 v[120:123], v146 offset:8192
    ds_read_b128 v[124:127], v147 offset:8192
    ds_read_b128 v[128:131], v148 offset:8192
    ds_read_b128 v[132:135], v149 offset:8192
    ds_read_b128 v[136:139], v150 offset:8192
    ds_read_b128 v[140:143], v151 offset:8192
    s_lshl_b32 s73, s78, 6
    s_lshl_b32 s74, s60, 8
    s_xor_b32 s60, s60, 4
    s_lshl_b32 s71, s60, 14
    s_add_u32 s71, s71, 0
    v_and_b32 v2, 31, v1
    v_lshrrev_b32 v3, 5, v1
    v_and_b32 v10, 7, v2
    v_xor_b32 v3, v3, v10
    v_lshlrev_b32 v2, 7, v2
    v_add_u32 v2, s71, v2
    v_xor_b32 v240, 0, v3
    v_lshl_add_u32 v240, v240, 4, v2
    v_xor_b32 v241, 2, v3
    v_lshl_add_u32 v241, v241, 4, v2
    v_xor_b32 v242, 4, v3
    v_lshl_add_u32 v242, v242, 4, v2
    v_xor_b32 v243, 6, v3
    v_lshl_add_u32 v243, v243, 4, v2
    v_lshrrev_b32 v2, 3, v1
    v_and_b32 v3, 7, v1
    v_xor_b32 v10, v3, v2
    v_lshlrev_b32 v10, 4, v10
    v_lshl_add_u32 v10, v2, 7, v10
    v_add_u32 v10, s71, v10
    v_add_u32 v2, s73, v2
    s_mov_b32 s72, 2048
    v_mul_lo_u32 v2, v2, s72
    v_lshl_add_u32 v2, v3, 4, v2
    v_add_u32 v9, s74, v2
    s_xor_b32 s60, s60, 4
    s_waitcnt lgkmcnt(0)
    s_waitcnt vmcnt(0)
    v_mfma_f32_32x32x16_bf16 v[144:159], v[16:19], v[80:83], 0
    v_mfma_f32_32x32x16_bf16 v[160:175], v[48:51], v[80:83], 0
    v_mfma_f32_32x32x16_bf16 v[144:159], v[20:23], v[84:87], v[144:159]
    v_mfma_f32_32x32x16_bf16 v[160:175], v[52:55], v[84:87], v[160:175]
    s_nop 15
    s_nop 3
    v_cvt_pk_bf16_f32 v160, v160, v160
    v_lshlrev_b32 v160, 16, v160
    v_add_f32 v160, 0x358637bd, v160
    v_cvt_pk_bf16_f32 v160, v160, v160
    v_lshlrev_b32 v160, 16, v160
    v_rcp_f32 v160, v160
    s_nop 0
    v_mul_f32 v160, v160, v12
    v_pk_mul_f32 v[144:145], v[144:145], v[160:161] op_sel:[0,0] op_sel_hi:[1,0]
    v_pk_mul_f32 v[146:147], v[146:147], v[160:161] op_sel:[0,0] op_sel_hi:[1,0]
    v_pk_mul_f32 v[148:149], v[148:149], v[160:161] op_sel:[0,0] op_sel_hi:[1,0]
    v_pk_mul_f32 v[150:151], v[150:151], v[160:161] op_sel:[0,0] op_sel_hi:[1,0]
    v_pk_mul_f32 v[152:153], v[152:153], v[160:161] op_sel:[0,0] op_sel_hi:[1,0]
    v_pk_mul_f32 v[154:155], v[154:155], v[160:161] op_sel:[0,0] op_sel_hi:[1,0]
    v_pk_mul_f32 v[156:157], v[156:157], v[160:161] op_sel:[0,0] op_sel_hi:[1,0]
    v_pk_mul_f32 v[158:159], v[158:159], v[160:161] op_sel:[0,0] op_sel_hi:[1,0]
    v_cvt_pk_bf16_f32 v184, v144, v145
    v_cvt_pk_bf16_f32 v185, v146, v147
    v_cvt_pk_bf16_f32 v186, v148, v149
    v_cvt_pk_bf16_f32 v187, v150, v151
    v_cvt_pk_bf16_f32 v188, v152, v153
    v_cvt_pk_bf16_f32 v189, v154, v155
    v_cvt_pk_bf16_f32 v190, v156, v157
    v_cvt_pk_bf16_f32 v191, v158, v159
    s_nop 1
    v_permlane32_swap_b32 v184, v186
    v_permlane32_swap_b32 v185, v187
    v_permlane32_swap_b32 v188, v190
    v_permlane32_swap_b32 v189, v191
    ds_write_b128 v240, v[184:187] offset:0
    ds_write_b128 v241, v[188:191] offset:0
    v_mfma_f32_32x32x16_bf16 v[192:207], v[24:27], v[88:91], 0
    v_mfma_f32_32x32x16_bf16 v[208:223], v[56:59], v[88:91], 0
    v_mfma_f32_32x32x16_bf16 v[192:207], v[28:31], v[92:95], v[192:207]
    v_mfma_f32_32x32x16_bf16 v[208:223], v[60:63], v[92:95], v[208:223]
    s_nop 15
    s_nop 3
    v_cvt_pk_bf16_f32 v208, v208, v208
    v_lshlrev_b32 v208, 16, v208
    v_add_f32 v208, 0x358637bd, v208
    v_cvt_pk_bf16_f32 v208, v208, v208
    v_lshlrev_b32 v208, 16, v208
    v_rcp_f32 v208, v208
    s_nop 0
    v_mul_f32 v208, v208, v12
    v_pk_mul_f32 v[192:193], v[192:193], v[208:209] op_sel:[0,0] op_sel_hi:[1,0]
    v_pk_mul_f32 v[194:195], v[194:195], v[208:209] op_sel:[0,0] op_sel_hi:[1,0]
    v_pk_mul_f32 v[196:197], v[196:197], v[208:209] op_sel:[0,0] op_sel_hi:[1,0]
    v_pk_mul_f32 v[198:199], v[198:199], v[208:209] op_sel:[0,0] op_sel_hi:[1,0]
    v_pk_mul_f32 v[200:201], v[200:201], v[208:209] op_sel:[0,0] op_sel_hi:[1,0]
    v_pk_mul_f32 v[202:203], v[202:203], v[208:209] op_sel:[0,0] op_sel_hi:[1,0]
    v_pk_mul_f32 v[204:205], v[204:205], v[208:209] op_sel:[0,0] op_sel_hi:[1,0]
    v_pk_mul_f32 v[206:207], v[206:207], v[208:209] op_sel:[0,0] op_sel_hi:[1,0]
    v_cvt_pk_bf16_f32 v232, v192, v193
    v_cvt_pk_bf16_f32 v233, v194, v195
    v_cvt_pk_bf16_f32 v234, v196, v197
    v_cvt_pk_bf16_f32 v235, v198, v199
    v_cvt_pk_bf16_f32 v236, v200, v201
    v_cvt_pk_bf16_f32 v237, v202, v203
    v_cvt_pk_bf16_f32 v238, v204, v205
    v_cvt_pk_bf16_f32 v239, v206, v207
    s_nop 1
    v_permlane32_swap_b32 v232, v234
    v_permlane32_swap_b32 v233, v235
    v_permlane32_swap_b32 v236, v238
    v_permlane32_swap_b32 v237, v239
    ds_write_b128 v242, v[232:235] offset:0
    ds_write_b128 v243, v[236:239] offset:0
    ds_read_b128 v[80:83], v10 offset:0
    ds_read_b128 v[84:87], v10 offset:1024
    ds_read_b128 v[88:91], v10 offset:2048
    ds_read_b128 v[92:95], v10 offset:3072
    s_waitcnt lgkmcnt(0)
    v_add_u32 v244, 0x0, v9
    v_add_u32 v245, 0x4000, v9
    v_add_u32 v246, 0x8000, v9
    v_add_u32 v247, 0xc000, v9
    buffer_store_dwordx4 v[80:83], v244, s[40:43], 0 offen sc1
    buffer_store_dwordx4 v[84:87], v245, s[40:43], 0 offen sc1
    buffer_store_dwordx4 v[88:91], v246, s[40:43], 0 offen sc1
    buffer_store_dwordx4 v[92:95], v247, s[40:43], 0 offen sc1
    v_mfma_f32_32x32x16_bf16 v[144:159], v[32:35], v[96:99], 0
    v_mfma_f32_32x32x16_bf16 v[160:175], v[64:67], v[96:99], 0
    v_mfma_f32_32x32x16_bf16 v[144:159], v[36:39], v[100:103], v[144:159]
    v_mfma_f32_32x32x16_bf16 v[160:175], v[68:71], v[100:103], v[160:175]
    s_nop 15
    s_nop 3
    v_cvt_pk_bf16_f32 v160, v160, v160
    v_lshlrev_b32 v160, 16, v160
    v_add_f32 v160, 0x358637bd, v160
    v_cvt_pk_bf16_f32 v160, v160, v160
    v_lshlrev_b32 v160, 16, v160
    v_rcp_f32 v160, v160
    s_nop 0
    v_mul_f32 v160, v160, v12
    v_pk_mul_f32 v[144:145], v[144:145], v[160:161] op_sel:[0,0] op_sel_hi:[1,0]
    v_pk_mul_f32 v[146:147], v[146:147], v[160:161] op_sel:[0,0] op_sel_hi:[1,0]
    v_pk_mul_f32 v[148:149], v[148:149], v[160:161] op_sel:[0,0] op_sel_hi:[1,0]
    v_pk_mul_f32 v[150:151], v[150:151], v[160:161] op_sel:[0,0] op_sel_hi:[1,0]
    v_pk_mul_f32 v[152:153], v[152:153], v[160:161] op_sel:[0,0] op_sel_hi:[1,0]
    v_pk_mul_f32 v[154:155], v[154:155], v[160:161] op_sel:[0,0] op_sel_hi:[1,0]
    v_pk_mul_f32 v[156:157], v[156:157], v[160:161] op_sel:[0,0] op_sel_hi:[1,0]
    v_pk_mul_f32 v[158:159], v[158:159], v[160:161] op_sel:[0,0] op_sel_hi:[1,0]
    v_cvt_pk_bf16_f32 v184, v144, v145
    v_cvt_pk_bf16_f32 v185, v146, v147
    v_cvt_pk_bf16_f32 v186, v148, v149
    v_cvt_pk_bf16_f32 v187, v150, v151
    v_cvt_pk_bf16_f32 v188, v152, v153
    v_cvt_pk_bf16_f32 v189, v154, v155
    v_cvt_pk_bf16_f32 v190, v156, v157
    v_cvt_pk_bf16_f32 v191, v158, v159
    s_nop 1
    v_permlane32_swap_b32 v184, v186
    v_permlane32_swap_b32 v185, v187
    v_permlane32_swap_b32 v188, v190
    v_permlane32_swap_b32 v189, v191
    ds_write_b128 v240, v[184:187] offset:4096
    ds_write_b128 v241, v[188:191] offset:4096
    v_mfma_f32_32x32x16_bf16 v[192:207], v[40:43], v[104:107], 0
    v_mfma_f32_32x32x16_bf16 v[208:223], v[72:75], v[104:107], 0
    v_mfma_f32_32x32x16_bf16 v[192:207], v[44:47], v[108:111], v[192:207]
    v_mfma_f32_32x32x16_bf16 v[208:223], v[76:79], v[108:111], v[208:223]
    s_nop 15
    s_nop 3
    v_cvt_pk_bf16_f32 v208, v208, v208
    v_lshlrev_b32 v208, 16, v208
    v_add_f32 v208, 0x358637bd, v208
    v_cvt_pk_bf16_f32 v208, v208, v208
    v_lshlrev_b32 v208, 16, v208
    v_rcp_f32 v208, v208
    s_nop 0
    v_mul_f32 v208, v208, v12
    v_pk_mul_f32 v[192:193], v[192:193], v[208:209] op_sel:[0,0] op_sel_hi:[1,0]
    v_pk_mul_f32 v[194:195], v[194:195], v[208:209] op_sel:[0,0] op_sel_hi:[1,0]
    v_pk_mul_f32 v[196:197], v[196:197], v[208:209] op_sel:[0,0] op_sel_hi:[1,0]
    v_pk_mul_f32 v[198:199], v[198:199], v[208:209] op_sel:[0,0] op_sel_hi:[1,0]
    v_pk_mul_f32 v[200:201], v[200:201], v[208:209] op_sel:[0,0] op_sel_hi:[1,0]
    v_pk_mul_f32 v[202:203], v[202:203], v[208:209] op_sel:[0,0] op_sel_hi:[1,0]
    v_pk_mul_f32 v[204:205], v[204:205], v[208:209] op_sel:[0,0] op_sel_hi:[1,0]
    v_pk_mul_f32 v[206:207], v[206:207], v[208:209] op_sel:[0,0] op_sel_hi:[1,0]
    v_cvt_pk_bf16_f32 v232, v192, v193
    v_cvt_pk_bf16_f32 v233, v194, v195
    v_cvt_pk_bf16_f32 v234, v196, v197
    v_cvt_pk_bf16_f32 v235, v198, v199
    v_cvt_pk_bf16_f32 v236, v200, v201
    v_cvt_pk_bf16_f32 v237, v202, v203
    v_cvt_pk_bf16_f32 v238, v204, v205
    v_cvt_pk_bf16_f32 v239, v206, v207
    s_nop 1
    v_permlane32_swap_b32 v232, v234
    v_permlane32_swap_b32 v233, v235
    v_permlane32_swap_b32 v236, v238
    v_permlane32_swap_b32 v237, v239
    ds_write_b128 v242, v[232:235] offset:4096
    ds_write_b128 v243, v[236:239] offset:4096
    ds_read_b128 v[96:99], v10 offset:4096
    ds_read_b128 v[100:103], v10 offset:5120
    ds_read_b128 v[104:107], v10 offset:6144
    ds_read_b128 v[108:111], v10 offset:7168
    s_waitcnt lgkmcnt(0)
    v_add_u32 v244, 0x80, v9
    v_add_u32 v245, 0x4080, v9
    v_add_u32 v246, 0x8080, v9
    v_add_u32 v247, 0xc080, v9
    buffer_store_dwordx4 v[96:99], v244, s[40:43], 0 offen sc1
    buffer_store_dwordx4 v[100:103], v245, s[40:43], 0 offen sc1
    buffer_store_dwordx4 v[104:107], v246, s[40:43], 0 offen sc1
    buffer_store_dwordx4 v[108:111], v247, s[40:43], 0 offen sc1
    v_mfma_f32_32x32x16_bf16 v[144:159], v[16:19], v[112:115], 0
    v_mfma_f32_32x32x16_bf16 v[160:175], v[48:51], v[112:115], 0
    v_mfma_f32_32x32x16_bf16 v[144:159], v[20:23], v[116:119], v[144:159]
    v_mfma_f32_32x32x16_bf16 v[160:175], v[52:55], v[116:119], v[160:175]
    s_nop 15
    s_nop 3
    v_cvt_pk_bf16_f32 v160, v160, v160
    v_lshlrev_b32 v160, 16, v160
    v_add_f32 v160, 0x358637bd, v160
    v_cvt_pk_bf16_f32 v160, v160, v160
    v_lshlrev_b32 v160, 16, v160
    v_rcp_f32 v160, v160
    s_nop 0
    v_mul_f32 v160, v160, v13
    v_pk_mul_f32 v[144:145], v[144:145], v[160:161] op_sel:[0,0] op_sel_hi:[1,0]
    v_pk_mul_f32 v[146:147], v[146:147], v[160:161] op_sel:[0,0] op_sel_hi:[1,0]
    v_pk_mul_f32 v[148:149], v[148:149], v[160:161] op_sel:[0,0] op_sel_hi:[1,0]
    v_pk_mul_f32 v[150:151], v[150:151], v[160:161] op_sel:[0,0] op_sel_hi:[1,0]
    v_pk_mul_f32 v[152:153], v[152:153], v[160:161] op_sel:[0,0] op_sel_hi:[1,0]
    v_pk_mul_f32 v[154:155], v[154:155], v[160:161] op_sel:[0,0] op_sel_hi:[1,0]
    v_pk_mul_f32 v[156:157], v[156:157], v[160:161] op_sel:[0,0] op_sel_hi:[1,0]
    v_pk_mul_f32 v[158:159], v[158:159], v[160:161] op_sel:[0,0] op_sel_hi:[1,0]
    v_cvt_pk_bf16_f32 v184, v144, v145
    v_cvt_pk_bf16_f32 v185, v146, v147
    v_cvt_pk_bf16_f32 v186, v148, v149
    v_cvt_pk_bf16_f32 v187, v150, v151
    v_cvt_pk_bf16_f32 v188, v152, v153
    v_cvt_pk_bf16_f32 v189, v154, v155
    v_cvt_pk_bf16_f32 v190, v156, v157
    v_cvt_pk_bf16_f32 v191, v158, v159
    s_nop 1
    v_permlane32_swap_b32 v184, v186
    v_permlane32_swap_b32 v185, v187
    v_permlane32_swap_b32 v188, v190
    v_permlane32_swap_b32 v189, v191
    ds_write_b128 v240, v[184:187] offset:0
    ds_write_b128 v241, v[188:191] offset:0
    v_mfma_f32_32x32x16_bf16 v[192:207], v[24:27], v[120:123], 0
    v_mfma_f32_32x32x16_bf16 v[208:223], v[56:59], v[120:123], 0
    v_mfma_f32_32x32x16_bf16 v[192:207], v[28:31], v[124:127], v[192:207]
    v_mfma_f32_32x32x16_bf16 v[208:223], v[60:63], v[124:127], v[208:223]
    s_nop 15
    s_nop 3
    v_cvt_pk_bf16_f32 v208, v208, v208
    v_lshlrev_b32 v208, 16, v208
    v_add_f32 v208, 0x358637bd, v208
    v_cvt_pk_bf16_f32 v208, v208, v208
    v_lshlrev_b32 v208, 16, v208
    v_rcp_f32 v208, v208
    s_nop 0
    v_mul_f32 v208, v208, v13
    v_pk_mul_f32 v[192:193], v[192:193], v[208:209] op_sel:[0,0] op_sel_hi:[1,0]
    v_pk_mul_f32 v[194:195], v[194:195], v[208:209] op_sel:[0,0] op_sel_hi:[1,0]
    v_pk_mul_f32 v[196:197], v[196:197], v[208:209] op_sel:[0,0] op_sel_hi:[1,0]
    v_pk_mul_f32 v[198:199], v[198:199], v[208:209] op_sel:[0,0] op_sel_hi:[1,0]
    v_pk_mul_f32 v[200:201], v[200:201], v[208:209] op_sel:[0,0] op_sel_hi:[1,0]
    v_pk_mul_f32 v[202:203], v[202:203], v[208:209] op_sel:[0,0] op_sel_hi:[1,0]
    v_pk_mul_f32 v[204:205], v[204:205], v[208:209] op_sel:[0,0] op_sel_hi:[1,0]
    v_pk_mul_f32 v[206:207], v[206:207], v[208:209] op_sel:[0,0] op_sel_hi:[1,0]
    v_cvt_pk_bf16_f32 v232, v192, v193
    v_cvt_pk_bf16_f32 v233, v194, v195
    v_cvt_pk_bf16_f32 v234, v196, v197
    v_cvt_pk_bf16_f32 v235, v198, v199
    v_cvt_pk_bf16_f32 v236, v200, v201
    v_cvt_pk_bf16_f32 v237, v202, v203
    v_cvt_pk_bf16_f32 v238, v204, v205
    v_cvt_pk_bf16_f32 v239, v206, v207
    s_nop 1
    v_permlane32_swap_b32 v232, v234
    v_permlane32_swap_b32 v233, v235
    v_permlane32_swap_b32 v236, v238
    v_permlane32_swap_b32 v237, v239
    ds_write_b128 v242, v[232:235] offset:0
    ds_write_b128 v243, v[236:239] offset:0
    ds_read_b128 v[112:115], v10 offset:0
    ds_read_b128 v[116:119], v10 offset:1024
    ds_read_b128 v[120:123], v10 offset:2048
    ds_read_b128 v[124:127], v10 offset:3072
    s_waitcnt lgkmcnt(0)
    v_add_u32 v244, 0x10000, v9
    v_add_u32 v245, 0x14000, v9
    v_add_u32 v246, 0x18000, v9
    v_add_u32 v247, 0x1c000, v9
    buffer_store_dwordx4 v[112:115], v244, s[40:43], 0 offen sc1
    buffer_store_dwordx4 v[116:119], v245, s[40:43], 0 offen sc1
    buffer_store_dwordx4 v[120:123], v246, s[40:43], 0 offen sc1
    buffer_store_dwordx4 v[124:127], v247, s[40:43], 0 offen sc1
    v_mfma_f32_32x32x16_bf16 v[144:159], v[32:35], v[128:131], 0
    v_mfma_f32_32x32x16_bf16 v[160:175], v[64:67], v[128:131], 0
    v_mfma_f32_32x32x16_bf16 v[144:159], v[36:39], v[132:135], v[144:159]
    v_mfma_f32_32x32x16_bf16 v[160:175], v[68:71], v[132:135], v[160:175]
    s_nop 15
    s_nop 3
    v_cvt_pk_bf16_f32 v160, v160, v160
    v_lshlrev_b32 v160, 16, v160
    v_add_f32 v160, 0x358637bd, v160
    v_cvt_pk_bf16_f32 v160, v160, v160
    v_lshlrev_b32 v160, 16, v160
    v_rcp_f32 v160, v160
    s_nop 0
    v_mul_f32 v160, v160, v13
    v_pk_mul_f32 v[144:145], v[144:145], v[160:161] op_sel:[0,0] op_sel_hi:[1,0]
    v_pk_mul_f32 v[146:147], v[146:147], v[160:161] op_sel:[0,0] op_sel_hi:[1,0]
    v_pk_mul_f32 v[148:149], v[148:149], v[160:161] op_sel:[0,0] op_sel_hi:[1,0]
    v_pk_mul_f32 v[150:151], v[150:151], v[160:161] op_sel:[0,0] op_sel_hi:[1,0]
    v_pk_mul_f32 v[152:153], v[152:153], v[160:161] op_sel:[0,0] op_sel_hi:[1,0]
    v_pk_mul_f32 v[154:155], v[154:155], v[160:161] op_sel:[0,0] op_sel_hi:[1,0]
    v_pk_mul_f32 v[156:157], v[156:157], v[160:161] op_sel:[0,0] op_sel_hi:[1,0]
    v_pk_mul_f32 v[158:159], v[158:159], v[160:161] op_sel:[0,0] op_sel_hi:[1,0]
    v_cvt_pk_bf16_f32 v184, v144, v145
    v_cvt_pk_bf16_f32 v185, v146, v147
    v_cvt_pk_bf16_f32 v186, v148, v149
    v_cvt_pk_bf16_f32 v187, v150, v151
    v_cvt_pk_bf16_f32 v188, v152, v153
    v_cvt_pk_bf16_f32 v189, v154, v155
    v_cvt_pk_bf16_f32 v190, v156, v157
    v_cvt_pk_bf16_f32 v191, v158, v159
    s_nop 1
    v_permlane32_swap_b32 v184, v186
    v_permlane32_swap_b32 v185, v187
    v_permlane32_swap_b32 v188, v190
    v_permlane32_swap_b32 v189, v191
    ds_write_b128 v240, v[184:187] offset:4096
    ds_write_b128 v241, v[188:191] offset:4096
    v_mfma_f32_32x32x16_bf16 v[192:207], v[40:43], v[136:139], 0
    v_mfma_f32_32x32x16_bf16 v[208:223], v[72:75], v[136:139], 0
    v_mfma_f32_32x32x16_bf16 v[192:207], v[44:47], v[140:143], v[192:207]
    v_mfma_f32_32x32x16_bf16 v[208:223], v[76:79], v[140:143], v[208:223]
    s_nop 15
    s_nop 3
    v_cvt_pk_bf16_f32 v208, v208, v208
    v_lshlrev_b32 v208, 16, v208
    v_add_f32 v208, 0x358637bd, v208
    v_cvt_pk_bf16_f32 v208, v208, v208
    v_lshlrev_b32 v208, 16, v208
    v_rcp_f32 v208, v208
    s_nop 0
    v_mul_f32 v208, v208, v13
    v_pk_mul_f32 v[192:193], v[192:193], v[208:209] op_sel:[0,0] op_sel_hi:[1,0]
    v_pk_mul_f32 v[194:195], v[194:195], v[208:209] op_sel:[0,0] op_sel_hi:[1,0]
    v_pk_mul_f32 v[196:197], v[196:197], v[208:209] op_sel:[0,0] op_sel_hi:[1,0]
    v_pk_mul_f32 v[198:199], v[198:199], v[208:209] op_sel:[0,0] op_sel_hi:[1,0]
    v_pk_mul_f32 v[200:201], v[200:201], v[208:209] op_sel:[0,0] op_sel_hi:[1,0]
    v_pk_mul_f32 v[202:203], v[202:203], v[208:209] op_sel:[0,0] op_sel_hi:[1,0]
    v_pk_mul_f32 v[204:205], v[204:205], v[208:209] op_sel:[0,0] op_sel_hi:[1,0]
    v_pk_mul_f32 v[206:207], v[206:207], v[208:209] op_sel:[0,0] op_sel_hi:[1,0]
    v_cvt_pk_bf16_f32 v232, v192, v193
    v_cvt_pk_bf16_f32 v233, v194, v195
    v_cvt_pk_bf16_f32 v234, v196, v197
    v_cvt_pk_bf16_f32 v235, v198, v199
    v_cvt_pk_bf16_f32 v236, v200, v201
    v_cvt_pk_bf16_f32 v237, v202, v203
    v_cvt_pk_bf16_f32 v238, v204, v205
    v_cvt_pk_bf16_f32 v239, v206, v207
    s_nop 1
    v_permlane32_swap_b32 v232, v234
    v_permlane32_swap_b32 v233, v235
    v_permlane32_swap_b32 v236, v238
    v_permlane32_swap_b32 v237, v239
    ds_write_b128 v242, v[232:235] offset:4096
    ds_write_b128 v243, v[236:239] offset:4096
    ds_read_b128 v[128:131], v10 offset:4096
    ds_read_b128 v[132:135], v10 offset:5120
    ds_read_b128 v[136:139], v10 offset:6144
    ds_read_b128 v[140:143], v10 offset:7168
    s_waitcnt lgkmcnt(0)
    v_add_u32 v244, 0x10080, v9
    v_add_u32 v245, 0x14080, v9
    v_add_u32 v246, 0x18080, v9
    v_add_u32 v247, 0x1c080, v9
    buffer_store_dwordx4 v[128:131], v244, s[40:43], 0 offen sc1
    buffer_store_dwordx4 v[132:135], v245, s[40:43], 0 offen sc1
    buffer_store_dwordx4 v[136:139], v246, s[40:43], 0 offen sc1
    buffer_store_dwordx4 v[140:143], v247, s[40:43], 0 offen sc1
    s_waitcnt vmcnt(0)
    s_barrier
    s_cmp_ge_u32 s60, 4
    s_cbranch_scc1 L_owg_loader4
    s_cmp_lg_u32 s60, 0
    s_cbranch_scc1 L_w0_88
    s_lshr_b32 s73, s78, 1
    s_add_u32 s48, s26, 0x2700000
    s_addc_u32 s49, s27, 0
    s_mov_b32 s50, 0x8000
    s_mov_b32 s51, 0x20000
    s_lshl_b32 s71, s73, 7
    s_add_u32 s71, s71, 6144
    v_mov_b32 v2, s71
    v_mov_b32 v3, 1
    s_mov_b64 exec, 1
    buffer_atomic_add v3, v2, s[48:51], 0 offen sc1
    s_mov_b64 exec, -1
L_w0_88:
    s_branch L_c4
L_M_loader:
    v_mov_b32 v4, 149504
    v_mov_b32 v3, 0
    ds_write_b32 v4, v3
    s_add_u32 s36, s26, 0x400000
    s_addc_u32 s37, s27, 0
    s_mov_b32 s38, 0x400000
    s_mov_b32 s39, 0x20000
L_nozero:
    s_cmp_gt_u32 s63, 5
    s_subb_u32 s73, s63, 0
    s_lshl_b32 s73, s73, 2
    s_add_u32 s73, s73, s75
    s_cmp_eq_u32 s63, 5
    s_cselect_b32 s72, 16, s77
    s_mov_b32 s44, s16
    s_mov_b32 s45, s17
    s_mov_b32 s46, 0x700000
    s_mov_b32 s47, 0x20000
    v_lshrrev_b32 v240, 4, v1
    s_lshl_b32 s71, s72, 6
    v_add_u32 v240, s71, v240
    s_mov_b32 s71, 7168
    v_mul_lo_u32 v240, v240, s71
    v_and_b32 v2, 15, v1
    v_lshl_add_u32 v240, v2, 4, v240
    s_lshl_b32 s71, s73, 8
    v_add_u32 v240, s71, v240
    s_waitcnt vmcnt(16)
    s_barrier
    s_add_u32 m0, s70, 98304
    s_nop 0
    buffer_load_dwordx4 v28, s[28:31], s68 offen offset:0 lds
    buffer_load_dwordx4 v29, s[28:31], s68 offen offset:1024 lds
    buffer_load_dwordx4 v30, s[28:31], s68 offen offset:2048 lds
    buffer_load_dwordx4 v31, s[28:31], s68 offen offset:3072 lds
    s_add_u32 m0, s70, 114688
    s_add_u32 s68, s68, 128
    buffer_load_dwordx4 v20, s[32:35], s69 offen offset:0 lds
    buffer_load_dwordx4 v21, s[32:35], s69 offen offset:1024 lds
    buffer_load_dwordx4 v22, s[32:35], s69 offen offset:2048 lds
    buffer_load_dwordx4 v23, s[32:35], s69 offen offset:3072 lds
    s_add_u32 s69, s69, 131072
    s_waitcnt vmcnt(16)
    s_barrier
    s_add_u32 m0, s70, 0
    s_nop 0
    buffer_load_dwordx4 v28, s[28:31], s68 offen offset:0 lds
    buffer_load_dwordx4 v29, s[28:31], s68 offen offset:1024 lds
    buffer_load_dwordx4 v30, s[28:31], s68 offen offset:2048 lds
    buffer_load_dwordx4 v31, s[28:31], s68 offen offset:3072 lds
    s_add_u32 m0, s70, 16384
    s_add_u32 s68, s68, 128
    buffer_load_dwordx4 v20, s[32:35], s69 offen offset:0 lds
    buffer_load_dwordx4 v21, s[32:35], s69 offen offset:1024 lds
    buffer_load_dwordx4 v22, s[32:35], s69 offen offset:2048 lds
    buffer_load_dwordx4 v23, s[32:35], s69 offen offset:3072 lds
    s_add_u32 s69, s69, 131072
    s_waitcnt vmcnt(16)
    s_barrier
    s_add_u32 m0, s70, 32768
    s_nop 0
    buffer_load_dwordx4 v28, s[28:31], s68 offen offset:0 lds
    buffer_load_dwordx4 v29, s[28:31], s68 offen offset:1024 lds
    buffer_load_dwordx4 v30, s[28:31], s68 offen offset:2048 lds
    buffer_load_dwordx4 v31, s[28:31], s68 offen offset:3072 lds
    s_add_u32 m0, s70, 49152
    s_add_u32 s68, s68, 128
    buffer_load_dwordx4 v20, s[32:35], s69 offen offset:0 lds
    buffer_load_dwordx4 v21, s[32:35], s69 offen offset:1024 lds
    buffer_load_dwordx4 v22, s[32:35], s69 offen offset:2048 lds
    buffer_load_dwordx4 v23, s[32:35], s69 offen offset:3072 lds
    s_add_u32 s69, s69, 131072
    s_waitcnt vmcnt(16)
    s_barrier
    s_add_u32 m0, s70, 65536
    s_nop 0
    buffer_load_dwordx4 v28, s[28:31], s68 offen offset:0 lds
    buffer_load_dwordx4 v29, s[28:31], s68 offen offset:1024 lds
    buffer_load_dwordx4 v30, s[28:31], s68 offen offset:2048 lds
    buffer_load_dwordx4 v31, s[28:31], s68 offen offset:3072 lds
    s_add_u32 m0, s70, 81920
    s_add_u32 s68, s68, 128
    buffer_load_dwordx4 v20, s[32:35], s69 offen offset:0 lds
    buffer_load_dwordx4 v21, s[32:35], s69 offen offset:1024 lds
    buffer_load_dwordx4 v22, s[32:35], s69 offen offset:2048 lds
    buffer_load_dwordx4 v23, s[32:35], s69 offen offset:3072 lds
    s_add_u32 s69, s69, 131072
    s_waitcnt vmcnt(16)
    s_barrier
    s_add_u32 m0, s70, 98304
    s_nop 0
    buffer_load_dwordx4 v28, s[28:31], s68 offen offset:0 lds
    buffer_load_dwordx4 v29, s[28:31], s68 offen offset:1024 lds
    buffer_load_dwordx4 v30, s[28:31], s68 offen offset:2048 lds
    buffer_load_dwordx4 v31, s[28:31], s68 offen offset:3072 lds
    s_add_u32 m0, s70, 114688
    s_add_u32 s68, s68, 128
    buffer_load_dwordx4 v20, s[32:35], s69 offen offset:0 lds
    buffer_load_dwordx4 v21, s[32:35], s69 offen offset:1024 lds
    buffer_load_dwordx4 v22, s[32:35], s69 offen offset:2048 lds
    buffer_load_dwordx4 v23, s[32:35], s69 offen offset:3072 lds
    s_add_u32 s69, s69, 131072
    s_waitcnt vmcnt(16)
    s_barrier
    s_add_u32 m0, s70, 0
    s_nop 0
    buffer_load_dwordx4 v28, s[28:31], s68 offen offset:0 lds
    buffer_load_dwordx4 v29, s[28:31], s68 offen offset:1024 lds
    buffer_load_dwordx4 v30, s[28:31], s68 offen offset:2048 lds
    buffer_load_dwordx4 v31, s[28:31], s68 offen offset:3072 lds
    s_add_u32 m0, s70, 16384
    s_add_u32 s68, s68, 128
    buffer_load_dwordx4 v20, s[32:35], s69 offen offset:0 lds
    buffer_load_dwordx4 v21, s[32:35], s69 offen offset:1024 lds
    buffer_load_dwordx4 v22, s[32:35], s69 offen offset:2048 lds
    buffer_load_dwordx4 v23, s[32:35], s69 offen offset:3072 lds
    s_add_u32 s69, s69, 131072
    s_waitcnt vmcnt(16)
    s_barrier
    s_add_u32 m0, s70, 32768
    s_nop 0
    buffer_load_dwordx4 v28, s[28:31], s68 offen offset:0 lds
    buffer_load_dwordx4 v29, s[28:31], s68 offen offset:1024 lds
    buffer_load_dwordx4 v30, s[28:31], s68 offen offset:2048 lds
    buffer_load_dwordx4 v31, s[28:31], s68 offen offset:3072 lds
    s_add_u32 m0, s70, 49152
    s_add_u32 s68, s68, 128
    buffer_load_dwordx4 v20, s[32:35], s69 offen offset:0 lds
    buffer_load_dwordx4 v21, s[32:35], s69 offen offset:1024 lds
    buffer_load_dwordx4 v22, s[32:35], s69 offen offset:2048 lds
    buffer_load_dwordx4 v23, s[32:35], s69 offen offset:3072 lds
    s_add_u32 s69, s69, 131072
    s_waitcnt vmcnt(16)
    s_barrier
    s_add_u32 m0, s70, 65536
    s_nop 0
    buffer_load_dwordx4 v28, s[28:31], s68 offen offset:0 lds
    buffer_load_dwordx4 v29, s[28:31], s68 offen offset:1024 lds
    buffer_load_dwordx4 v30, s[28:31], s68 offen offset:2048 lds
    buffer_load_dwordx4 v31, s[28:31], s68 offen offset:3072 lds
    s_add_u32 m0, s70, 81920
    s_add_u32 s68, s68, 128
    buffer_load_dwordx4 v20, s[32:35], s69 offen offset:0 lds
    buffer_load_dwordx4 v21, s[32:35], s69 offen offset:1024 lds
    buffer_load_dwordx4 v22, s[32:35], s69 offen offset:2048 lds
    buffer_load_dwordx4 v23, s[32:35], s69 offen offset:3072 lds
    s_add_u32 s69, s69, 131072
    s_waitcnt vmcnt(16)
    s_barrier
    s_add_u32 m0, s70, 98304
    s_nop 0
    buffer_load_dwordx4 v28, s[28:31], s68 offen offset:0 lds
    buffer_load_dwordx4 v29, s[28:31], s68 offen offset:1024 lds
    buffer_load_dwordx4 v30, s[28:31], s68 offen offset:2048 lds
    buffer_load_dwordx4 v31, s[28:31], s68 offen offset:3072 lds
    s_add_u32 m0, s70, 114688
    s_add_u32 s68, s68, 128
    buffer_load_dwordx4 v20, s[32:35], s69 offen offset:0 lds
    buffer_load_dwordx4 v21, s[32:35], s69 offen offset:1024 lds
    buffer_load_dwordx4 v22, s[32:35], s69 offen offset:2048 lds
    buffer_load_dwordx4 v23, s[32:35], s69 offen offset:3072 lds
    s_add_u32 s69, s69, 131072
    s_waitcnt vmcnt(16)
    s_barrier
    s_add_u32 m0, s70, 0
    s_nop 0
    buffer_load_dwordx4 v28, s[28:31], s68 offen offset:0 lds
    buffer_load_dwordx4 v29, s[28:31], s68 offen offset:1024 lds
    buffer_load_dwordx4 v30, s[28:31], s68 offen offset:2048 lds
    buffer_load_dwordx4 v31, s[28:31], s68 offen offset:3072 lds
    s_add_u32 m0, s70, 16384
    s_add_u32 s68, s68, 128
    buffer_load_dwordx4 v20, s[32:35], s69 offen offset:0 lds
    buffer_load_dwordx4 v21, s[32:35], s69 offen offset:1024 lds
    buffer_load_dwordx4 v22, s[32:35], s69 offen offset:2048 lds
    buffer_load_dwordx4 v23, s[32:35], s69 offen offset:3072 lds
    s_add_u32 s69, s69, 131072
    s_waitcnt vmcnt(16)
    s_barrier
    s_add_u32 m0, s70, 32768
    s_nop 0
    buffer_load_dwordx4 v28, s[28:31], s68 offen offset:0 lds
    buffer_load_dwordx4 v29, s[28:31], s68 offen offset:1024 lds
    buffer_load_dwordx4 v30, s[28:31], s68 offen offset:2048 lds
    buffer_load_dwordx4 v31, s[28:31], s68 offen offset:3072 lds
    s_add_u32 m0, s70, 49152
    s_add_u32 s68, s68, 128
    buffer_load_dwordx4 v20, s[32:35], s69 offen offset:0 lds
    buffer_load_dwordx4 v21, s[32:35], s69 offen offset:1024 lds
    buffer_load_dwordx4 v22, s[32:35], s69 offen offset:2048 lds
    buffer_load_dwordx4 v23, s[32:35], s69 offen offset:3072 lds
    s_add_u32 s69, s69, 131072
    s_waitcnt vmcnt(16)
    s_barrier
    s_add_u32 m0, s70, 65536
    s_nop 0
    buffer_load_dwordx4 v28, s[28:31], s68 offen offset:0 lds
    buffer_load_dwordx4 v29, s[28:31], s68 offen offset:1024 lds
    buffer_load_dwordx4 v30, s[28:31], s68 offen offset:2048 lds
    buffer_load_dwordx4 v31, s[28:31], s68 offen offset:3072 lds
    s_add_u32 m0, s70, 81920
    s_add_u32 s68, s68, 128
    buffer_load_dwordx4 v20, s[32:35], s69 offen offset:0 lds
    buffer_load_dwordx4 v21, s[32:35], s69 offen offset:1024 lds
    buffer_load_dwordx4 v22, s[32:35], s69 offen offset:2048 lds
    buffer_load_dwordx4 v23, s[32:35], s69 offen offset:3072 lds
    s_add_u32 s69, s69, 131072
    s_waitcnt vmcnt(16)
    s_barrier
    s_add_u32 m0, s70, 98304
    s_nop 0
    buffer_load_dwordx4 v28, s[28:31], s68 offen offset:0 lds
    buffer_load_dwordx4 v29, s[28:31], s68 offen offset:1024 lds
    buffer_load_dwordx4 v30, s[28:31], s68 offen offset:2048 lds
    buffer_load_dwordx4 v31, s[28:31], s68 offen offset:3072 lds
    s_add_u32 m0, s70, 114688
    s_add_u32 s68, s68, 128
    buffer_load_dwordx4 v20, s[32:35], s69 offen offset:0 lds
    buffer_load_dwordx4 v21, s[32:35], s69 offen offset:1024 lds
    buffer_load_dwordx4 v22, s[32:35], s69 offen offset:2048 lds
    buffer_load_dwordx4 v23, s[32:35], s69 offen offset:3072 lds
    s_add_u32 s69, s69, 131072
    s_waitcnt vmcnt(16)
    s_barrier
    s_add_u32 s40, s26, 0x2680000
    s_addc_u32 s41, s27, 0
    s_mov_b32 s42, 0x4000
    s_mov_b32 s43, 0x20000
    v_and_b32 v2, 31, v1
    s_lshl_b32 s71, s75, 5
    s_add_u32 s71, s71, s61
    s_sub_u32 s71, s71, s66
    v_add_u32 v2, s71, v2
    v_lshlrev_b32 v2, 3, v2
    buffer_load_dwordx2 v[64:65], v2, s[40:43], 0 offen sc1
    s_mov_b32 s71, 0
    buffer_load_dwordx4 v[128:131], v240, s[44:47], s71 offen
    s_mov_b32 s71, 28672
    buffer_load_dwordx4 v[132:135], v240, s[44:47], s71 offen
    s_waitcnt vmcnt(11)
    s_barrier
    s_mov_b32 s71, 57344
    buffer_load_dwordx4 v[136:139], v240, s[44:47], s71 offen
    s_mov_b32 s71, 86016
    buffer_load_dwordx4 v[140:143], v240, s[44:47], s71 offen
    s_mov_b32 s71, 114688
    buffer_load_dwordx4 v[144:147], v240, s[44:47], s71 offen
    s_mov_b32 s71, 143360
    buffer_load_dwordx4 v[148:151], v240, s[44:47], s71 offen
    s_mov_b32 s71, 172032
    buffer_load_dwordx4 v[152:155], v240, s[44:47], s71 offen
    s_mov_b32 s71, 200704
    buffer_load_dwordx4 v[156:159], v240, s[44:47], s71 offen
    s_waitcnt vmcnt(9)
    s_barrier
    s_waitcnt vmcnt(8)
    v_mov_b32 v68, v65
    v_mul_f32 v69, v64, v64
    v_mul_f32 v69, v69, v64
    v_mul_f32 v69, 0xbdd2d3e8, v69
    v_mul_f32 v70, 0xc0135761, v64
    v_rcp_f32 v71, v64
    v_and_b32 v3, 31, v1
    s_lshl_b32 s71, s75, 5
    v_add_u32 v3, s71, v3
    v_lshlrev_b32 v3, 4, v3
    v_add_u32 v3, 150080, v3
    ds_write_b128 v3, v[68:71]
    s_waitcnt lgkmcnt(0)
    s_mov_b32 s71, 229376
    buffer_load_dwordx4 v[160:163], v240, s[44:47], s71 offen
    s_mov_b32 s71, 258048
    buffer_load_dwordx4 v[164:167], v240, s[44:47], s71 offen
    s_mov_b32 s71, 286720
    buffer_load_dwordx4 v[168:171], v240, s[44:47], s71 offen
    s_mov_b32 s71, 315392
    buffer_load_dwordx4 v[172:175], v240, s[44:47], s71 offen
    s_mov_b32 s71, 344064
    buffer_load_dwordx4 v[176:179], v240, s[44:47], s71 offen
    s_mov_b32 s71, 372736
    buffer_load_dwordx4 v[180:183], v240, s[44:47], s71 offen
    s_mov_b32 s71, 401408
    buffer_load_dwordx4 v[184:187], v240, s[44:47], s71 offen
    s_mov_b32 s71, 430080
    buffer_load_dwordx4 v[188:191], v240, s[44:47], s71 offen
    s_barrier
    s_barrier
    s_mov_b32 s32, s14
    s_mov_b32 s33, s15
    s_mov_b32 s34, 0x200000
    s_mov_b32 s35, 0x20000
    s_add_u32 s28, s26, 0x400000
    s_addc_u32 s29, s27, 0
    s_mov_b32 s30, 0x400000
    s_mov_b32 s31, 0x20000
    s_mov_b32 s68, 0
    s_mov_b32 s69, 0
    s_mov_b32 s40, s4
    s_mov_b32 s41, s5
    s_mov_b32 s42, 0x400000
    s_mov_b32 s43, 0x20000
    s_lshl_b32 s69, s85, 10
    s_add_u32 m0, s70, 16384
    s_nop 0
    buffer_load_dwordx4 v20, s[32:35], s69 offen offset:0 lds
    buffer_load_dwordx4 v21, s[32:35], s69 offen offset:1024 lds
    buffer_load_dwordx4 v22, s[32:35], s69 offen offset:2048 lds
    buffer_load_dwordx4 v23, s[32:35], s69 offen offset:3072 lds
    s_add_u32 s69, s69, 131072
    s_add_u32 m0, s70, 49152
    s_nop 0
    buffer_load_dwordx4 v20, s[32:35], s69 offen offset:0 lds
    buffer_load_dwordx4 v21, s[32:35], s69 offen offset:1024 lds
    buffer_load_dwordx4 v22, s[32:35], s69 offen offset:2048 lds
    buffer_load_dwordx4 v23, s[32:35], s69 offen offset:3072 lds
    s_add_u32 s69, s69, 131072
    s_cmp_eq_u32 s63, 0
    s_cselect_b32 s68, 256, 0
    s_lshl_b32 s69, s68, 10
    s_add_u32 m0, s70, 81920
    s_nop 0
    buffer_load_dwordx4 v20, s[32:35], s69 offen offset:0 lds
    buffer_load_dwordx4 v21, s[32:35], s69 offen offset:1024 lds
    buffer_load_dwordx4 v22, s[32:35], s69 offen offset:2048 lds
    buffer_load_dwordx4 v23, s[32:35], s69 offen offset:3072 lds
    s_add_u32 s69, s69, 131072
    s_add_u32 m0, s70, 114688
    s_nop 0
    buffer_load_dwordx4 v20, s[32:35], s69 offen offset:0 lds
    buffer_load_dwordx4 v21, s[32:35], s69 offen offset:1024 lds
    buffer_load_dwordx4 v22, s[32:35], s69 offen offset:2048 lds
    buffer_load_dwordx4 v23, s[32:35], s69 offen offset:3072 lds
    s_add_u32 s69, s69, 131072
    s_waitcnt vmcnt(16)
    s_waitcnt vmcnt(63)
    v_lshlrev_b32 v224, 16, v128
    v_and_b32 v225, 0xffff0000, v128
    v_lshlrev_b32 v226, 16, v129
    v_and_b32 v227, 0xffff0000, v129
    v_lshlrev_b32 v228, 16, v130
    v_and_b32 v229, 0xffff0000, v130
    v_lshlrev_b32 v230, 16, v131
    v_and_b32 v231, 0xffff0000, v131
    v_lshlrev_b32 v232, 16, v132
    v_and_b32 v233, 0xffff0000, v132
    v_lshlrev_b32 v234, 16, v133
    v_and_b32 v235, 0xffff0000, v133
    v_lshlrev_b32 v236, 16, v134
    v_and_b32 v237, 0xffff0000, v134
    v_lshlrev_b32 v238, 16, v135
    v_and_b32 v239, 0xffff0000, v135
    v_pk_add_f32 v[224:225], v[224:225], v[232:233]
    v_pk_add_f32 v[226:227], v[226:227], v[234:235]
    v_pk_add_f32 v[228:229], v[228:229], v[236:237]
    v_pk_add_f32 v[230:231], v[230:231], v[238:239]
    v_lshlrev_b32 v232, 16, v136
    v_and_b32 v233, 0xffff0000, v136
    v_lshlrev_b32 v234, 16, v137
    v_and_b32 v235, 0xffff0000, v137
    v_lshlrev_b32 v236, 16, v138
    v_and_b32 v237, 0xffff0000, v138
    v_lshlrev_b32 v238, 16, v139
    v_and_b32 v239, 0xffff0000, v139
    v_pk_add_f32 v[224:225], v[224:225], v[232:233]
    v_pk_add_f32 v[226:227], v[226:227], v[234:235]
    v_pk_add_f32 v[228:229], v[228:229], v[236:237]
    v_pk_add_f32 v[230:231], v[230:231], v[238:239]
    v_lshlrev_b32 v232, 16, v140
    v_and_b32 v233, 0xffff0000, v140
    v_lshlrev_b32 v234, 16, v141
    v_and_b32 v235, 0xffff0000, v141
    v_lshlrev_b32 v236, 16, v142
    v_and_b32 v237, 0xffff0000, v142
    v_lshlrev_b32 v238, 16, v143
    v_and_b32 v239, 0xffff0000, v143
    v_pk_add_f32 v[224:225], v[224:225], v[232:233]
    v_pk_add_f32 v[226:227], v[226:227], v[234:235]
    v_pk_add_f32 v[228:229], v[228:229], v[236:237]
    v_pk_add_f32 v[230:231], v[230:231], v[238:239]
    v_lshlrev_b32 v232, 16, v144
    v_and_b32 v233, 0xffff0000, v144
    v_lshlrev_b32 v234, 16, v145
    v_and_b32 v235, 0xffff0000, v145
    v_lshlrev_b32 v236, 16, v146
    v_and_b32 v237, 0xffff0000, v146
    v_lshlrev_b32 v238, 16, v147
    v_and_b32 v239, 0xffff0000, v147
    v_pk_add_f32 v[224:225], v[224:225], v[232:233]
    v_pk_add_f32 v[226:227], v[226:227], v[234:235]
    v_pk_add_f32 v[228:229], v[228:229], v[236:237]
    v_pk_add_f32 v[230:231], v[230:231], v[238:239]
    v_lshlrev_b32 v232, 16, v148
    v_and_b32 v233, 0xffff0000, v148
    v_lshlrev_b32 v234, 16, v149
    v_and_b32 v235, 0xffff0000, v149
    v_lshlrev_b32 v236, 16, v150
    v_and_b32 v237, 0xffff0000, v150
    v_lshlrev_b32 v238, 16, v151
    v_and_b32 v239, 0xffff0000, v151
    v_pk_add_f32 v[224:225], v[224:225], v[232:233]
    v_pk_add_f32 v[226:227], v[226:227], v[234:235]
    v_pk_add_f32 v[228:229], v[228:229], v[236:237]
    v_pk_add_f32 v[230:231], v[230:231], v[238:239]
    v_lshlrev_b32 v232, 16, v152
    v_and_b32 v233, 0xffff0000, v152
    v_lshlrev_b32 v234, 16, v153
    v_and_b32 v235, 0xffff0000, v153
    v_lshlrev_b32 v236, 16, v154
    v_and_b32 v237, 0xffff0000, v154
    v_lshlrev_b32 v238, 16, v155
    v_and_b32 v239, 0xffff0000, v155
    v_pk_add_f32 v[224:225], v[224:225], v[232:233]
    v_pk_add_f32 v[226:227], v[226:227], v[234:235]
    v_pk_add_f32 v[228:229], v[228:229], v[236:237]
    v_pk_add_f32 v[230:231], v[230:231], v[238:239]
    v_lshlrev_b32 v232, 16, v156
    v_and_b32 v233, 0xffff0000, v156
    v_lshlrev_b32 v234, 16, v157
    v_and_b32 v235, 0xffff0000, v157
    v_lshlrev_b32 v236, 16, v158
    v_and_b32 v237, 0xffff0000, v158
    v_lshlrev_b32 v238, 16, v159
    v_and_b32 v239, 0xffff0000, v159
    v_pk_add_f32 v[224:225], v[224:225], v[232:233]
    v_pk_add_f32 v[226:227], v[226:227], v[234:235]
    v_pk_add_f32 v[228:229], v[228:229], v[236:237]
    v_pk_add_f32 v[230:231], v[230:231], v[238:239]
    s_cmp_gt_u32 s63, 5
    s_subb_u32 s73, s63, 0
    s_lshl_b32 s73, s73, 2
    s_add_u32 s73, s73, s75
    s_cmp_eq_u32 s63, 5
    s_cselect_b32 s72, 16, s77
    s_waitcnt vmcnt(63)
    v_lshlrev_b32 v232, 16, v160
    v_and_b32 v233, 0xffff0000, v160
    v_lshlrev_b32 v234, 16, v161
    v_and_b32 v235, 0xffff0000, v161
    v_lshlrev_b32 v236, 16, v162
    v_and_b32 v237, 0xffff0000, v162
    v_lshlrev_b32 v238, 16, v163
    v_and_b32 v239, 0xffff0000, v163
    v_pk_add_f32 v[224:225], v[224:225], v[232:233]
    v_pk_add_f32 v[226:227], v[226:227], v[234:235]
    v_pk_add_f32 v[228:229], v[228:229], v[236:237]
    v_pk_add_f32 v[230:231], v[230:231], v[238:239]
    v_lshlrev_b32 v232, 16, v164
    v_and_b32 v233, 0xffff0000, v164
    v_lshlrev_b32 v234, 16, v165
    v_and_b32 v235, 0xffff0000, v165
    v_lshlrev_b32 v236, 16, v166
    v_and_b32 v237, 0xffff0000, v166
    v_lshlrev_b32 v238, 16, v167
    v_and_b32 v239, 0xffff0000, v167
    v_pk_add_f32 v[224:225], v[224:225], v[232:233]
    v_pk_add_f32 v[226:227], v[226:227], v[234:235]
    v_pk_add_f32 v[228:229], v[228:229], v[236:237]
    v_pk_add_f32 v[230:231], v[230:231], v[238:239]
    v_lshlrev_b32 v232, 16, v168
    v_and_b32 v233, 0xffff0000, v168
    v_lshlrev_b32 v234, 16, v169
    v_and_b32 v235, 0xffff0000, v169
    v_lshlrev_b32 v236, 16, v170
    v_and_b32 v237, 0xffff0000, v170
    v_lshlrev_b32 v238, 16, v171
    v_and_b32 v239, 0xffff0000, v171
    v_pk_add_f32 v[224:225], v[224:225], v[232:233]
    v_pk_add_f32 v[226:227], v[226:227], v[234:235]
    v_pk_add_f32 v[228:229], v[228:229], v[236:237]
    v_pk_add_f32 v[230:231], v[230:231], v[238:239]
    v_lshlrev_b32 v232, 16, v172
    v_and_b32 v233, 0xffff0000, v172
    v_lshlrev_b32 v234, 16, v173
    v_and_b32 v235, 0xffff0000, v173
    v_lshlrev_b32 v236, 16, v174
    v_and_b32 v237, 0xffff0000, v174
    v_lshlrev_b32 v238, 16, v175
    v_and_b32 v239, 0xffff0000, v175
    v_pk_add_f32 v[224:225], v[224:225], v[232:233]
    v_pk_add_f32 v[226:227], v[226:227], v[234:235]
    v_pk_add_f32 v[228:229], v[228:229], v[236:237]
    v_pk_add_f32 v[230:231], v[230:231], v[238:239]
    v_lshlrev_b32 v232, 16, v176
    v_and_b32 v233, 0xffff0000, v176
    v_lshlrev_b32 v234, 16, v177
    v_and_b32 v235, 0xffff0000, v177
    v_lshlrev_b32 v236, 16, v178
    v_and_b32 v237, 0xffff0000, v178
    v_lshlrev_b32 v238, 16, v179
    v_and_b32 v239, 0xffff0000, v179
    v_pk_add_f32 v[224:225], v[224:225], v[232:233]
    v_pk_add_f32 v[226:227], v[226:227], v[234:235]
    v_pk_add_f32 v[228:229], v[228:229], v[236:237]
    v_pk_add_f32 v[230:231], v[230:231], v[238:239]
    v_lshlrev_b32 v232, 16, v180
    v_and_b32 v233, 0xffff0000, v180
    v_lshlrev_b32 v234, 16, v181
    v_and_b32 v235, 0xffff0000, v181
    v_lshlrev_b32 v236, 16, v182
    v_and_b32 v237, 0xffff0000, v182
    v_lshlrev_b32 v238, 16, v183
    v_and_b32 v239, 0xffff0000, v183
    v_pk_add_f32 v[224:225], v[224:225], v[232:233]
    v_pk_add_f32 v[226:227], v[226:227], v[234:235]
    v_pk_add_f32 v[228:229], v[228:229], v[236:237]
    v_pk_add_f32 v[230:231], v[230:231], v[238:239]
    v_lshlrev_b32 v232, 16, v184
    v_and_b32 v233, 0xffff0000, v184
    v_lshlrev_b32 v234, 16, v185
    v_and_b32 v235, 0xffff0000, v185
    v_lshlrev_b32 v236, 16, v186
    v_and_b32 v237, 0xffff0000, v186
    v_lshlrev_b32 v238, 16, v187
    v_and_b32 v239, 0xffff0000, v187
    v_pk_add_f32 v[224:225], v[224:225], v[232:233]
    v_pk_add_f32 v[226:227], v[226:227], v[234:235]
    v_pk_add_f32 v[228:229], v[228:229], v[236:237]
    v_pk_add_f32 v[230:231], v[230:231], v[238:239]
    v_lshlrev_b32 v232, 16, v188
    v_and_b32 v233, 0xffff0000, v188
    v_lshlrev_b32 v234, 16, v189
    v_and_b32 v235, 0xffff0000, v189
    v_lshlrev_b32 v236, 16, v190
    v_and_b32 v237, 0xffff0000, v190
    v_lshlrev_b32 v238, 16, v191
    v_and_b32 v239, 0xffff0000, v191
    v_pk_add_f32 v[224:225], v[224:225], v[232:233]
    v_pk_add_f32 v[226:227], v[226:227], v[234:235]
    v_pk_add_f32 v[228:229], v[228:229], v[236:237]
    v_pk_add_f32 v[230:231], v[230:231], v[238:239]
    v_mov_b32 v232, v224
    v_mov_b32 v233, v225
    v_mov_b32 v234, v226
    v_mov_b32 v235, v227
    v_mov_b32 v236, v228
    v_mov_b32 v237, v229
    v_mov_b32 v238, v230
    v_mov_b32 v239, v231
    s_nop 1
    v_permlane32_swap_b32 v224, v232
    v_permlane32_swap_b32 v225, v233
    v_permlane32_swap_b32 v226, v234
    v_permlane32_swap_b32 v227, v235
    v_permlane32_swap_b32 v228, v236
    v_permlane32_swap_b32 v229, v237
    v_permlane32_swap_b32 v230, v238
    v_permlane32_swap_b32 v231, v239
    s_nop 1
    v_pk_add_f32 v[224:225], v[224:225], v[232:233]
    v_pk_add_f32 v[226:227], v[226:227], v[234:235]
    v_pk_add_f32 v[228:229], v[228:229], v[236:237]
    v_pk_add_f32 v[230:231], v[230:231], v[238:239]
    v_mov_b32 v232, v224
    v_mov_b32 v233, v225
    v_mov_b32 v234, v226
    v_mov_b32 v235, v227
    v_mov_b32 v236, v228
    v_mov_b32 v237, v229
    v_mov_b32 v238, v230
    v_mov_b32 v239, v231
    s_nop 1
    v_permlane16_swap_b32 v224, v232
    v_permlane16_swap_b32 v225, v233
    v_permlane16_swap_b32 v226, v234
    v_permlane16_swap_b32 v227, v235
    v_permlane16_swap_b32 v228, v236
    v_permlane16_swap_b32 v229, v237
    v_permlane16_swap_b32 v230, v238
    v_permlane16_swap_b32 v231, v239
    s_nop 1
    v_pk_add_f32 v[224:225], v[224:225], v[232:233]
    v_pk_add_f32 v[226:227], v[226:227], v[234:235]
    v_pk_add_f32 v[228:229], v[228:229], v[236:237]
    v_pk_add_f32 v[230:231], v[230:231], v[238:239]
    s_add_u32 s44, s26, 0x2600000
    s_addc_u32 s45, s27, 0
    s_mov_b32 s46, 0x38000
    s_mov_b32 s47, 0x20000
    s_mul_i32 s71, s72, 14336
    s_lshl_b32 s73, s73, 9
    s_add_u32 s71, s71, s73
    v_lshlrev_b32 v2, 5, v1
    s_mov_b64 exec, 0xffff
    buffer_store_dwordx4 v[224:227], v2, s[44:47], s71 offen sc1
    buffer_store_dwordx4 v[228:231], v2, s[44:47], s71 offen offset:16 sc1
    s_mov_b64 exec, -1
    s_nop 1
    s_waitcnt vmcnt(14)
    s_barrier
    s_waitcnt vmcnt(10)
    s_barrier
    s_waitcnt vmcnt(0)
    s_barrier
    v_mov_b32 v4, 149504
    s_cmp_lg_u32 s75, 0
    s_cbranch_scc1 L_lgo_89
    s_add_u32 s48, s26, 0x2700000
    s_addc_u32 s49, s27, 0
    s_mov_b32 s50, 0x8000
    s_mov_b32 s51, 0x20000
    s_lshl_b32 s71, s77, 7
    s_add_u32 s71, s71, 10240
    v_mov_b32 v2, s71
    s_mov_b32 s72, 0x40000
L_poll_92:
    buffer_load_dword v3, v2, s[48:51], 0 offen sc1
    s_waitcnt vmcnt(0)
    v_readfirstlane_b32 s71, v3
    s_sub_u32 s72, s72, 1
    s_cmp_eq_u32 s72, 0
    s_cbranch_scc1 L_polld_93
    s_cmp_ge_u32 s71, 8
    s_cbranch_scc1 L_polld_93
    s_sleep 4
    s_branch L_poll_92
L_polld_93:
    v_mov_b32 v3, 1
    ds_write_b32 v4, v3
    s_waitcnt lgkmcnt(0)
    s_branch L_lgd_90
L_lgo_89:
    s_mov_b32 s72, 0x400000
L_lgp_91:
    s_sleep 1
    ds_read_b32 v3, v4
    s_waitcnt lgkmcnt(0)
    v_readfirstlane_b32 s71, v3
    s_sub_u32 s72, s72, 1
    s_cmp_eq_u32 s72, 0
    s_cbranch_scc1 L_lgd_90
    s_cmp_lg_u32 s71, 1
    s_cbranch_scc1 L_lgp_91
L_lgd_90:
    s_add_u32 m0, s70, 65536
    s_nop 0
    buffer_load_dwordx4 v16, s[28:31], s68 offen offset:0 sc1 lds
    buffer_load_dwordx4 v17, s[28:31], s68 offen offset:1024 sc1 lds
    buffer_load_dwordx4 v18, s[28:31], s68 offen offset:2048 sc1 lds
    buffer_load_dwordx4 v19, s[28:31], s68 offen offset:3072 sc1 lds
    s_add_u32 s68, s68, 128
    s_add_u32 m0, s70, 98304
    s_nop 0
    buffer_load_dwordx4 v16, s[28:31], s68 offen offset:0 sc1 lds
    buffer_load_dwordx4 v17, s[28:31], s68 offen offset:1024 sc1 lds
    buffer_load_dwordx4 v18, s[28:31], s68 offen offset:2048 sc1 lds
    buffer_load_dwordx4 v19, s[28:31], s68 offen offset:3072 sc1 lds
    s_add_u32 s68, s68, 128
    s_cmp_eq_u32 s68, s85
    s_cselect_b32 s71, 256, 0
    s_add_u32 s68, s68, s71
    s_lshl_b32 s69, s68, 10
    s_add_u32 m0, s70, 0
    s_nop 0
    buffer_load_dwordx4 v16, s[28:31], s68 offen offset:0 sc1 lds
    buffer_load_dwordx4 v17, s[28:31], s68 offen offset:1024 sc1 lds
    buffer_load_dwordx4 v18, s[28:31], s68 offen offset:2048 sc1 lds
    buffer_load_dwordx4 v19, s[28:31], s68 offen offset:3072 sc1 lds
    s_add_u32 m0, s70, 16384
    s_add_u32 s68, s68, 128
    buffer_load_dwordx4 v20, s[32:35], s69 offen offset:0 lds
    buffer_load_dwordx4 v21, s[32:35], s69 offen offset:1024 lds
    buffer_load_dwordx4 v22, s[32:35], s69 offen offset:2048 lds
    buffer_load_dwordx4 v23, s[32:35], s69 offen offset:3072 lds
    s_add_u32 s69, s69, 131072
    s_waitcnt vmcnt(12)
    s_barrier
    s_add_u32 m0, s70, 32768
    s_nop 0
    buffer_load_dwordx4 v16, s[28:31], s68 offen offset:0 sc1 lds
    buffer_load_dwordx4 v17, s[28:31], s68 offen offset:1024 sc1 lds
    buffer_load_dwordx4 v18, s[28:31], s68 offen offset:2048 sc1 lds
    buffer_load_dwordx4 v19, s[28:31], s68 offen offset:3072 sc1 lds
    s_add_u32 m0, s70, 49152
    s_add_u32 s68, s68, 128
    buffer_load_dwordx4 v20, s[32:35], s69 offen offset:0 lds
    buffer_load_dwordx4 v21, s[32:35], s69 offen offset:1024 lds
    buffer_load_dwordx4 v22, s[32:35], s69 offen offset:2048 lds
    buffer_load_dwordx4 v23, s[32:35], s69 offen offset:3072 lds
    s_add_u32 s69, s69, 131072
    s_waitcnt vmcnt(16)
    s_barrier
    s_cmp_eq_u32 s68, s85
    s_cselect_b32 s71, 256, 0
    s_add_u32 s68, s68, s71
    s_lshl_b32 s69, s68, 10
    s_add_u32 m0, s70, 65536
    s_nop 0
    buffer_load_dwordx4 v16, s[28:31], s68 offen offset:0 sc1 lds
    buffer_load_dwordx4 v17, s[28:31], s68 offen offset:1024 sc1 lds
    buffer_load_dwordx4 v18, s[28:31], s68 offen offset:2048 sc1 lds
    buffer_load_dwordx4 v19, s[28:31], s68 offen offset:3072 sc1 lds
    s_add_u32 m0, s70, 81920
    s_add_u32 s68, s68, 128
    buffer_load_dwordx4 v20, s[32:35], s69 offen offset:0 lds
    buffer_load_dwordx4 v21, s[32:35], s69 offen offset:1024 lds
    buffer_load_dwordx4 v22, s[32:35], s69 offen offset:2048 lds
    buffer_load_dwordx4 v23, s[32:35], s69 offen offset:3072 lds
    s_add_u32 s69, s69, 131072
    s_waitcnt vmcnt(16)
    s_barrier
    s_add_u32 m0, s70, 98304
    s_nop 0
    buffer_load_dwordx4 v16, s[28:31], s68 offen offset:0 sc1 lds
    buffer_load_dwordx4 v17, s[28:31], s68 offen offset:1024 sc1 lds
    buffer_load_dwordx4 v18, s[28:31], s68 offen offset:2048 sc1 lds
    buffer_load_dwordx4 v19, s[28:31], s68 offen offset:3072 sc1 lds
    s_add_u32 m0, s70, 114688
    s_add_u32 s68, s68, 128
    buffer_load_dwordx4 v20, s[32:35], s69 offen offset:0 lds
    buffer_load_dwordx4 v21, s[32:35], s69 offen offset:1024 lds
    buffer_load_dwordx4 v22, s[32:35], s69 offen offset:2048 lds
    buffer_load_dwordx4 v23, s[32:35], s69 offen offset:3072 lds
    s_add_u32 s69, s69, 131072
    s_waitcnt vmcnt(16)
    s_barrier
    s_cmp_eq_u32 s68, s85
    s_cselect_b32 s71, 256, 0
    s_add_u32 s68, s68, s71
    s_lshl_b32 s69, s68, 10
    s_add_u32 m0, s70, 0
    s_nop 0
    buffer_load_dwordx4 v16, s[28:31], s68 offen offset:0 sc1 lds
    buffer_load_dwordx4 v17, s[28:31], s68 offen offset:1024 sc1 lds
    buffer_load_dwordx4 v18, s[28:31], s68 offen offset:2048 sc1 lds
    buffer_load_dwordx4 v19, s[28:31], s68 offen offset:3072 sc1 lds
    s_add_u32 m0, s70, 16384
    s_add_u32 s68, s68, 128
    buffer_load_dwordx4 v20, s[32:35], s69 offen offset:0 lds
    buffer_load_dwordx4 v21, s[32:35], s69 offen offset:1024 lds
    buffer_load_dwordx4 v22, s[32:35], s69 offen offset:2048 lds
    buffer_load_dwordx4 v23, s[32:35], s69 offen offset:3072 lds
    s_add_u32 s69, s69, 131072
    s_waitcnt vmcnt(16)
    s_barrier
    s_add_u32 m0, s70, 32768
    s_nop 0
    buffer_load_dwordx4 v16, s[28:31], s68 offen offset:0 sc1 lds
    buffer_load_dwordx4 v17, s[28:31], s68 offen offset:1024 sc1 lds
    buffer_load_dwordx4 v18, s[28:31], s68 offen offset:2048 sc1 lds
    buffer_load_dwordx4 v19, s[28:31], s68 offen offset:3072 sc1 lds
    s_add_u32 m0, s70, 49152
    s_add_u32 s68, s68, 128
    buffer_load_dwordx4 v20, s[32:35], s69 offen offset:0 lds
    buffer_load_dwordx4 v21, s[32:35], s69 offen offset:1024 lds
    buffer_load_dwordx4 v22, s[32:35], s69 offen offset:2048 lds
    buffer_load_dwordx4 v23, s[32:35], s69 offen offset:3072 lds
    s_add_u32 s69, s69, 131072
    s_waitcnt vmcnt(16)
    s_barrier
    s_cmp_eq_u32 s68, s85
    s_cselect_b32 s71, 256, 0
    s_add_u32 s68, s68, s71
    s_lshl_b32 s69, s68, 10
    s_add_u32 m0, s70, 65536
    s_nop 0
    buffer_load_dwordx4 v16, s[28:31], s68 offen offset:0 sc1 lds
    buffer_load_dwordx4 v17, s[28:31], s68 offen offset:1024 sc1 lds
    buffer_load_dwordx4 v18, s[28:31], s68 offen offset:2048 sc1 lds
    buffer_load_dwordx4 v19, s[28:31], s68 offen offset:3072 sc1 lds
    s_add_u32 m0, s70, 81920
    s_add_u32 s68, s68, 128
    buffer_load_dwordx4 v20, s[32:35], s69 offen offset:0 lds
    buffer_load_dwordx4 v21, s[32:35], s69 offen offset:1024 lds
    buffer_load_dwordx4 v22, s[32:35], s69 offen offset:2048 lds
    buffer_load_dwordx4 v23, s[32:35], s69 offen offset:3072 lds
    s_add_u32 s69, s69, 131072
    s_waitcnt vmcnt(16)
    s_barrier
    s_add_u32 m0, s70, 98304
    s_nop 0
    buffer_load_dwordx4 v16, s[28:31], s68 offen offset:0 sc1 lds
    buffer_load_dwordx4 v17, s[28:31], s68 offen offset:1024 sc1 lds
    buffer_load_dwordx4 v18, s[28:31], s68 offen offset:2048 sc1 lds
    buffer_load_dwordx4 v19, s[28:31], s68 offen offset:3072 sc1 lds
    s_add_u32 m0, s70, 114688
    s_add_u32 s68, s68, 128
    buffer_load_dwordx4 v20, s[32:35], s69 offen offset:0 lds
    buffer_load_dwordx4 v21, s[32:35], s69 offen offset:1024 lds
    buffer_load_dwordx4 v22, s[32:35], s69 offen offset:2048 lds
    buffer_load_dwordx4 v23, s[32:35], s69 offen offset:3072 lds
    s_add_u32 s69, s69, 131072
    s_waitcnt vmcnt(16)
    s_barrier
    s_cmp_eq_u32 s68, s85
    s_cselect_b32 s71, 256, 0
    s_add_u32 s68, s68, s71
    s_lshl_b32 s69, s68, 10
    s_add_u32 m0, s70, 0
    s_nop 0
    buffer_load_dwordx4 v16, s[28:31], s68 offen offset:0 sc1 lds
    buffer_load_dwordx4 v17, s[28:31], s68 offen offset:1024 sc1 lds
    buffer_load_dwordx4 v18, s[28:31], s68 offen offset:2048 sc1 lds
    buffer_load_dwordx4 v19, s[28:31], s68 offen offset:3072 sc1 lds
    s_add_u32 m0, s70, 16384
    s_add_u32 s68, s68, 128
    buffer_load_dwordx4 v20, s[32:35], s69 offen offset:0 lds
    buffer_load_dwordx4 v21, s[32:35], s69 offen offset:1024 lds
    buffer_load_dwordx4 v22, s[32:35], s69 offen offset:2048 lds
    buffer_load_dwordx4 v23, s[32:35], s69 offen offset:3072 lds
    s_add_u32 s69, s69, 131072
    s_waitcnt vmcnt(16)
    s_barrier
    s_add_u32 m0, s70, 32768
    s_nop 0
    buffer_load_dwordx4 v16, s[28:31], s68 offen offset:0 sc1 lds
    buffer_load_dwordx4 v17, s[28:31], s68 offen offset:1024 sc1 lds
    buffer_load_dwordx4 v18, s[28:31], s68 offen offset:2048 sc1 lds
    buffer_load_dwordx4 v19, s[28:31], s68 offen offset:3072 sc1 lds
    s_add_u32 m0, s70, 49152
    s_add_u32 s68, s68, 128
    buffer_load_dwordx4 v20, s[32:35], s69 offen offset:0 lds
    buffer_load_dwordx4 v21, s[32:35], s69 offen offset:1024 lds
    buffer_load_dwordx4 v22, s[32:35], s69 offen offset:2048 lds
    buffer_load_dwordx4 v23, s[32:35], s69 offen offset:3072 lds
    s_add_u32 s69, s69, 131072
    s_waitcnt vmcnt(16)
    s_barrier
    s_cmp_eq_u32 s68, s85
    s_cselect_b32 s71, 256, 0
    s_add_u32 s68, s68, s71
    s_lshl_b32 s69, s68, 10
    s_add_u32 m0, s70, 65536
    s_nop 0
    buffer_load_dwordx4 v16, s[28:31], s68 offen offset:0 sc1 lds
    buffer_load_dwordx4 v17, s[28:31], s68 offen offset:1024 sc1 lds
    buffer_load_dwordx4 v18, s[28:31], s68 offen offset:2048 sc1 lds
    buffer_load_dwordx4 v19, s[28:31], s68 offen offset:3072 sc1 lds
    s_add_u32 m0, s70, 81920
    s_add_u32 s68, s68, 128
    buffer_load_dwordx4 v20, s[32:35], s69 offen offset:0 lds
    buffer_load_dwordx4 v21, s[32:35], s69 offen offset:1024 lds
    buffer_load_dwordx4 v22, s[32:35], s69 offen offset:2048 lds
    buffer_load_dwordx4 v23, s[32:35], s69 offen offset:3072 lds
    s_add_u32 s69, s69, 131072
    s_waitcnt vmcnt(16)
    s_barrier
    s_add_u32 m0, s70, 98304
    s_nop 0
    buffer_load_dwordx4 v16, s[28:31], s68 offen offset:0 sc1 lds
    buffer_load_dwordx4 v17, s[28:31], s68 offen offset:1024 sc1 lds
    buffer_load_dwordx4 v18, s[28:31], s68 offen offset:2048 sc1 lds
    buffer_load_dwordx4 v19, s[28:31], s68 offen offset:3072 sc1 lds
    s_add_u32 m0, s70, 114688
    s_add_u32 s68, s68, 128
    buffer_load_dwordx4 v20, s[32:35], s69 offen offset:0 lds
    buffer_load_dwordx4 v21, s[32:35], s69 offen offset:1024 lds
    buffer_load_dwordx4 v22, s[32:35], s69 offen offset:2048 lds
    buffer_load_dwordx4 v23, s[32:35], s69 offen offset:3072 lds
    s_add_u32 s69, s69, 131072
    s_waitcnt vmcnt(16)
    s_barrier
    s_add_u32 m0, s70, 0
    s_add_u32 s71, s85, 0
    buffer_load_dwordx4 v16, s[40:43], s71 offen offset:0 lds
    buffer_load_dwordx4 v17, s[40:43], s71 offen offset:1024 lds
    buffer_load_dwordx4 v18, s[40:43], s71 offen offset:2048 lds
    buffer_load_dwordx4 v19, s[40:43], s71 offen offset:3072 lds
    s_waitcnt vmcnt(12)
    s_barrier
    s_add_u32 m0, s70, 49152
    s_add_u32 s71, s85, 128
    buffer_load_dwordx4 v16, s[40:43], s71 offen offset:0 lds
    buffer_load_dwordx4 v17, s[40:43], s71 offen offset:1024 lds
    buffer_load_dwordx4 v18, s[40:43], s71 offen offset:2048 lds
    buffer_load_dwordx4 v19, s[40:43], s71 offen offset:3072 lds
    s_waitcnt vmcnt(8)
    s_barrier
    s_waitcnt vmcnt(0)
    s_barrier
L_m_l3:
    s_lshl_b32 s78, s76, 3
    s_add_u32 s78, s78, s63
    s_lshl_b32 s62, s78, 8
    s_add_u32 s28, s26, 0x800000
    s_addc_u32 s29, s27, 0
    s_mov_b32 s30, 0x400000
    s_mov_b32 s31, 0x20000
    s_mov_b32 s32, s16
    s_mov_b32 s33, s17
    s_mov_b32 s34, 0x700000
    s_mov_b32 s35, 0x20000
    s_add_u32 s36, s26, 0x1000000
    s_addc_u32 s37, s27, 0
    s_mov_b32 s38, 0xe00000
    s_mov_b32 s39, 0x20000
    s_mov_b32 s64, 7168
    s_mov_b32 s65, 32
    s_mov_b32 s66, 64
    v_lshrrev_b32 v3, 5, v1
    v_and_b32 v4, 31, v1
    s_lshl_b32 s71, s75, 4
    v_add_u32 v6, s71, v3
    v_mul_lo_u32 v6, v6, s64
    v_or_b32 v5, 0, v3
    v_lshlrev_b32 v5, 2, v5
    v_xor_b32 v5, v5, v4
    v_bfe_u32 v7, v5, 2, 1
    v_mul_lo_u32 v7, v7, s65
    v_lshrrev_b32 v8, 3, v5
    v_mul_lo_u32 v8, v8, s66
    v_and_b32 v9, 3, v5
    v_lshlrev_b32 v9, 3, v9
    v_add3_u32 v7, v7, v8, v9
    v_add_u32 v7, s62, v7
    v_lshl_add_u32 v10, v7, 1, v6
    v_or_b32 v5, 2, v3
    v_lshlrev_b32 v5, 2, v5
    v_xor_b32 v5, v5, v4
    v_bfe_u32 v7, v5, 2, 1
    v_mul_lo_u32 v7, v7, s65
    v_lshrrev_b32 v8, 3, v5
    v_mul_lo_u32 v8, v8, s66
    v_and_b32 v9, 3, v5
    v_lshlrev_b32 v9, 3, v9
    v_add3_u32 v7, v7, v8, v9
    v_add_u32 v7, s62, v7
    v_lshl_add_u32 v11, v7, 1, v6
    s_mul_i32 s71, s64, 0
    s_sub_u32 s71, s71, 0
    v_add_u32 v20, s71, v10
    s_mul_i32 s71, s64, 2
    s_sub_u32 s71, s71, 1024
    v_add_u32 v21, s71, v11
    s_mul_i32 s71, s64, 4
    s_sub_u32 s71, s71, 2048
    v_add_u32 v22, s71, v10
    s_mul_i32 s71, s64, 6
    s_sub_u32 s71, s71, 3072
    v_add_u32 v23, s71, v11
    v_xor_b32 v10, 32, v10
    v_xor_b32 v11, 32, v11
    s_mul_i32 s71, s64, 8
    s_sub_u32 s71, s71, 0
    v_add_u32 v24, s71, v10
    s_mul_i32 s71, s64, 10
    s_sub_u32 s71, s71, 1024
    v_add_u32 v25, s71, v11
    s_mul_i32 s71, s64, 12
    s_sub_u32 s71, s71, 2048
    v_add_u32 v26, s71, v10
    s_mul_i32 s71, s64, 14
    s_sub_u32 s71, s71, 3072
    v_add_u32 v27, s71, v11
    s_mul_i32 s69, s63, 917504
    s_add_u32 m0, s84, 16384
    s_nop 0
    buffer_load_dwordx4 v20, s[32:35], s69 offen offset:0 lds
    buffer_load_dwordx4 v21, s[32:35], s69 offen offset:1024 lds
    buffer_load_dwordx4 v22, s[32:35], s69 offen offset:2048 lds
    buffer_load_dwordx4 v23, s[32:35], s69 offen offset:3072 lds
    s_add_u32 m0, s84, 20480
    s_nop 0
    buffer_load_dwordx4 v24, s[32:35], s69 offen offset:0 lds
    buffer_load_dwordx4 v25, s[32:35], s69 offen offset:1024 lds
    buffer_load_dwordx4 v26, s[32:35], s69 offen offset:2048 lds
    buffer_load_dwordx4 v27, s[32:35], s69 offen offset:3072 lds
    s_add_u32 s69, s69, 458752
    s_add_u32 m0, s84, 65536
    s_nop 0
    buffer_load_dwordx4 v20, s[32:35], s69 offen offset:0 lds
    buffer_load_dwordx4 v21, s[32:35], s69 offen offset:1024 lds
    buffer_load_dwordx4 v22, s[32:35], s69 offen offset:2048 lds
    buffer_load_dwordx4 v23, s[32:35], s69 offen offset:3072 lds
    s_add_u32 m0, s84, 69632
    s_nop 0
    buffer_load_dwordx4 v24, s[32:35], s69 offen offset:0 lds
    buffer_load_dwordx4 v25, s[32:35], s69 offen offset:1024 lds
    buffer_load_dwordx4 v26, s[32:35], s69 offen offset:2048 lds
    buffer_load_dwordx4 v27, s[32:35], s69 offen offset:3072 lds
    s_add_u32 s69, s69, 458752
    s_lshl_b32 s85, s63, 8
    s_cmp_eq_u32 s63, 0
    s_cselect_b32 s68, 256, 0
    s_cselect_b32 s69, 917504, 0
    s_add_u32 m0, s84, 114688
    s_nop 0
    buffer_load_dwordx4 v20, s[32:35], s69 offen offset:0 lds
    buffer_load_dwordx4 v21, s[32:35], s69 offen offset:1024 lds
    buffer_load_dwordx4 v22, s[32:35], s69 offen offset:2048 lds
    buffer_load_dwordx4 v23, s[32:35], s69 offen offset:3072 lds
    s_add_u32 m0, s84, 118784
    s_nop 0
    buffer_load_dwordx4 v24, s[32:35], s69 offen offset:0 lds
    buffer_load_dwordx4 v25, s[32:35], s69 offen offset:1024 lds
    buffer_load_dwordx4 v26, s[32:35], s69 offen offset:2048 lds
    buffer_load_dwordx4 v27, s[32:35], s69 offen offset:3072 lds
    s_add_u32 s69, s69, 458752
    s_cmp_eq_u32 s76, 0
    s_mov_b32 s78, 0x51743260
    s_cselect_b32 s78, 0x76543210, s78
    s_lshl_b32 s71, s63, 2
    s_lshr_b32 s78, s78, s71
    s_and_b32 s78, s78, 7
    s_lshl_b32 s62, s78, 7
    s_mov_b32 s28, s26
    s_mov_b32 s29, s27
    s_mov_b32 s30, 0x400000
    s_mov_b32 s31, 0x20000
    s_mov_b32 s32, s8
    s_mov_b32 s33, s9
    s_mov_b32 s34, 0x200000
    s_mov_b32 s35, 0x20000
    s_add_u32 s44, s26, 0x1000000
    s_addc_u32 s45, s27, 0
    s_mov_b32 s46, 0xe00000
    s_mov_b32 s47, 0x20000
    s_mov_b32 s36, s22
    s_mov_b32 s37, s23
    s_mov_b32 s38, 0x400000
    s_mov_b32 s39, 0x20000
    s_add_u32 s40, s26, 0x800000
    s_addc_u32 s41, s27, 0
    s_mov_b32 s42, 0x400000
    s_mov_b32 s43, 0x20000
    s_add_u32 s52, s26, 0x2300000
    s_addc_u32 s53, s27, 0
    s_mov_b32 s54, 0x2000
    s_mov_b32 s55, 0x20000
    v_lshrrev_b32 v5, 4, v1
    s_lshl_b32 s71, s75, 4
    v_add_u32 v3, s71, v5
    s_mov_b32 s72, 2048
    v_mul_lo_u32 v3, v3, s72
    v_and_b32 v4, 15, v1
    v_lshlrev_b32 v5, 2, v5
    v_xor_b32 v4, v4, v5
    v_lshl_add_u32 v3, v4, 4, v3
    s_lshl_b32 s71, s62, 1
    v_add_u32 v3, s71, v3
    v_add_u32 v204, 0x0, v3
    v_add_u32 v205, 0x1c00, v3
    v_xor_b32 v3, 32, v3
    v_add_u32 v206, 0x3800, v3
    v_add_u32 v207, 0x5400, v3
    v_lshrrev_b32 v3, 3, v1
    v_and_b32 v4, 7, v1
    v_lshrrev_b32 v5, 4, v1
    v_xor_b32 v4, v4, v5
    s_xor_b32 s71, s75, s76
    s_lshl_b32 s71, s71, 5
    s_add_u32 s71, s71, s61
    v_add_u32 v3, s71, v3
    s_mov_b32 s72, 2048
    v_mul_lo_u32 v3, v3, s72
    v_mov_b32 v5, v4
    v_lshl_add_u32 v5, v5, 4, v3
    v_add_u32 v200, 0x0, v5
    v_xor_b32 v5, 4, v4
    v_lshl_add_u32 v5, v5, 4, v3
    v_add_u32 v201, 0x3c00, v5
    v_mov_b32 v5, v4
    v_lshl_add_u32 v5, v5, 4, v3
    v_add_u32 v202, 0x7800, v5
    v_xor_b32 v5, 4, v4
    v_lshl_add_u32 v5, v5, 4, v3
    v_add_u32 v203, 0xb400, v5
    v_lshrrev_b32 v3, 3, v1
    v_and_b32 v4, 7, v1
    v_lshrrev_b32 v5, 4, v1
    v_xor_b32 v4, v4, v5
    s_xor_b32 s71, s75, s76
    s_lshl_b32 s71, s71, 5
    s_add_u32 s71, s71, s61
    v_add_u32 v3, s71, v3
    s_mov_b32 s72, 7168
    v_mul_lo_u32 v3, v3, s72
    v_mov_b32 v5, v4
    v_lshl_add_u32 v5, v5, 4, v3
    v_add_u32 v208, 0x0, v5
    v_xor_b32 v5, 4, v4
    v_lshl_add_u32 v5, v5, 4, v3
    v_add_u32 v209, 0xdc00, v5
    v_mov_b32 v5, v4
    v_lshl_add_u32 v5, v5, 4, v3
    v_add_u32 v210, 0x1b800, v5
    v_xor_b32 v5, 4, v4
    v_lshl_add_u32 v5, v5, 4, v3
    v_add_u32 v211, 0x29400, v5
    s_lshl_b32 s78, s76, 3
    s_add_u32 s78, s78, s63
    s_lshl_b32 s62, s78, 8
    s_add_u32 s28, s26, 0x800000
    s_addc_u32 s29, s27, 0
    s_mov_b32 s30, 0x400000
    s_mov_b32 s31, 0x20000
    s_mov_b32 s32, s16
    s_mov_b32 s33, s17
    s_mov_b32 s34, 0x700000
    s_mov_b32 s35, 0x20000
    s_add_u32 s36, s26, 0x1000000
    s_addc_u32 s37, s27, 0
    s_mov_b32 s38, 0xe00000
    s_mov_b32 s39, 0x20000
    s_mov_b32 s64, 7168
    s_mov_b32 s65, 32
    s_mov_b32 s66, 64
    s_waitcnt vmcnt(16)
    s_barrier
    s_waitcnt vmcnt(8)
    s_barrier
    v_mov_b32 v4, 149504
    s_cmp_lg_u32 s75, 0
    s_cbranch_scc1 L_lgo_94
    s_add_u32 s48, s26, 0x2700000
    s_addc_u32 s49, s27, 0
    s_mov_b32 s50, 0x8000
    s_mov_b32 s51, 0x20000
    v_mov_b32 v2, 20480
    v_mov_b32 v125, 0
    s_lshl_b32 s71, s77, 7
    s_add_u32 s71, s71, 0
    v_writelane_b32 v2, s71, 0
    s_mov_b32 s71, 8
    v_writelane_b32 v125, s71, 0
    s_mov_b32 s71, 20864
    v_writelane_b32 v2, s71, 1
    s_mov_b32 s71, 128
    v_writelane_b32 v125, s71, 1
    s_mov_b32 s72, 0x40000
L_poll_97:
    buffer_load_dword v3, v2, s[48:51], 0 offen sc1
    s_waitcnt vmcnt(0)
    v_cmp_lt_u32 vcc, v3, v125
    s_sub_u32 s72, s72, 1
    s_cmp_eq_u32 s72, 0
    s_cbranch_scc1 L_polld_98
    s_cmp_eq_u64 vcc, 0
    s_cbranch_scc1 L_polld_98
    s_sleep 4
    s_branch L_poll_97
L_polld_98:
    v_mov_b32 v3, 2
    ds_write_b32 v4, v3
    s_waitcnt lgkmcnt(0)
    s_branch L_lgd_95
L_lgo_94:
    s_mov_b32 s72, 0x400000
L_lgp_96:
    s_sleep 1
    ds_read_b32 v3, v4
    s_waitcnt lgkmcnt(0)
    v_readfirstlane_b32 s71, v3
    s_sub_u32 s72, s72, 1
    s_cmp_eq_u32 s72, 0
    s_cbranch_scc1 L_lgd_95
    s_cmp_lg_u32 s71, 2
    s_cbranch_scc1 L_lgp_96
L_lgd_95:
    s_add_u32 m0, s70, 98304
    s_nop 0
    buffer_load_dwordx4 v16, s[28:31], s68 offen offset:0 sc1 lds
    buffer_load_dwordx4 v17, s[28:31], s68 offen offset:1024 sc1 lds
    buffer_load_dwordx4 v18, s[28:31], s68 offen offset:2048 sc1 lds
    buffer_load_dwordx4 v19, s[28:31], s68 offen offset:3072 sc1 lds
    s_add_u32 s68, s68, 128
    s_add_u32 m0, s70, 0
    s_nop 0
    buffer_load_dwordx4 v16, s[28:31], s68 offen offset:0 sc1 lds
    buffer_load_dwordx4 v17, s[28:31], s68 offen offset:1024 sc1 lds
    buffer_load_dwordx4 v18, s[28:31], s68 offen offset:2048 sc1 lds
    buffer_load_dwordx4 v19, s[28:31], s68 offen offset:3072 sc1 lds
    s_add_u32 m0, s84, 16384
    s_add_u32 s68, s68, 128
    buffer_load_dwordx4 v20, s[32:35], s69 offen offset:0 lds
    buffer_load_dwordx4 v21, s[32:35], s69 offen offset:1024 lds
    buffer_load_dwordx4 v22, s[32:35], s69 offen offset:2048 lds
    buffer_load_dwordx4 v23, s[32:35], s69 offen offset:3072 lds
    s_add_u32 m0, s84, 20480
    s_nop 0
    buffer_load_dwordx4 v24, s[32:35], s69 offen offset:0 lds
    buffer_load_dwordx4 v25, s[32:35], s69 offen offset:1024 lds
    buffer_load_dwordx4 v26, s[32:35], s69 offen offset:2048 lds
    buffer_load_dwordx4 v27, s[32:35], s69 offen offset:3072 lds
    s_add_u32 s69, s69, 458752
    s_waitcnt vmcnt(12)
    s_barrier
    s_cmp_eq_u32 s68, s85
    s_cselect_b32 s71, 256, 0
    s_cselect_b32 s72, 917504, 0
    s_add_u32 s68, s68, s71
    s_add_u32 s69, s69, s72
    s_add_u32 m0, s70, 49152
    s_nop 0
    buffer_load_dwordx4 v16, s[28:31], s68 offen offset:0 sc1 lds
    buffer_load_dwordx4 v17, s[28:31], s68 offen offset:1024 sc1 lds
    buffer_load_dwordx4 v18, s[28:31], s68 offen offset:2048 sc1 lds
    buffer_load_dwordx4 v19, s[28:31], s68 offen offset:3072 sc1 lds
    s_add_u32 m0, s84, 65536
    s_add_u32 s68, s68, 128
    buffer_load_dwordx4 v20, s[32:35], s69 offen offset:0 lds
    buffer_load_dwordx4 v21, s[32:35], s69 offen offset:1024 lds
    buffer_load_dwordx4 v22, s[32:35], s69 offen offset:2048 lds
    buffer_load_dwordx4 v23, s[32:35], s69 offen offset:3072 lds
    s_add_u32 m0, s84, 69632
    s_nop 0
    buffer_load_dwordx4 v24, s[32:35], s69 offen offset:0 lds
    buffer_load_dwordx4 v25, s[32:35], s69 offen offset:1024 lds
    buffer_load_dwordx4 v26, s[32:35], s69 offen offset:2048 lds
    buffer_load_dwordx4 v27, s[32:35], s69 offen offset:3072 lds
    s_add_u32 s69, s69, 458752
    s_waitcnt vmcnt(12)
    s_barrier
    s_add_u32 m0, s70, 98304
    s_nop 0
    buffer_load_dwordx4 v16, s[28:31], s68 offen offset:0 sc1 lds
    buffer_load_dwordx4 v17, s[28:31], s68 offen offset:1024 sc1 lds
    buffer_load_dwordx4 v18, s[28:31], s68 offen offset:2048 sc1 lds
    buffer_load_dwordx4 v19, s[28:31], s68 offen offset:3072 sc1 lds
    s_add_u32 m0, s84, 114688
    s_add_u32 s68, s68, 128
    buffer_load_dwordx4 v20, s[32:35], s69 offen offset:0 lds
    buffer_load_dwordx4 v21, s[32:35], s69 offen offset:1024 lds
    buffer_load_dwordx4 v22, s[32:35], s69 offen offset:2048 lds
    buffer_load_dwordx4 v23, s[32:35], s69 offen offset:3072 lds
    s_add_u32 m0, s84, 118784
    s_nop 0
    buffer_load_dwordx4 v24, s[32:35], s69 offen offset:0 lds
    buffer_load_dwordx4 v25, s[32:35], s69 offen offset:1024 lds
    buffer_load_dwordx4 v26, s[32:35], s69 offen offset:2048 lds
    buffer_load_dwordx4 v27, s[32:35], s69 offen offset:3072 lds
    s_add_u32 s69, s69, 458752
    s_waitcnt vmcnt(12)
    s_barrier
    s_cmp_eq_u32 s68, s85
    s_cselect_b32 s71, 256, 0
    s_cselect_b32 s72, 917504, 0
    s_add_u32 s68, s68, s71
    s_add_u32 s69, s69, s72
    s_add_u32 m0, s70, 0
    s_nop 0
    buffer_load_dwordx4 v16, s[28:31], s68 offen offset:0 sc1 lds
    buffer_load_dwordx4 v17, s[28:31], s68 offen offset:1024 sc1 lds
    buffer_load_dwordx4 v18, s[28:31], s68 offen offset:2048 sc1 lds
    buffer_load_dwordx4 v19, s[28:31], s68 offen offset:3072 sc1 lds
    s_add_u32 m0, s84, 16384
    s_add_u32 s68, s68, 128
    buffer_load_dwordx4 v20, s[32:35], s69 offen offset:0 lds
    buffer_load_dwordx4 v21, s[32:35], s69 offen offset:1024 lds
    buffer_load_dwordx4 v22, s[32:35], s69 offen offset:2048 lds
    buffer_load_dwordx4 v23, s[32:35], s69 offen offset:3072 lds
    s_add_u32 m0, s84, 20480
    s_nop 0
    buffer_load_dwordx4 v24, s[32:35], s69 offen offset:0 lds
    buffer_load_dwordx4 v25, s[32:35], s69 offen offset:1024 lds
    buffer_load_dwordx4 v26, s[32:35], s69 offen offset:2048 lds
    buffer_load_dwordx4 v27, s[32:35], s69 offen offset:3072 lds
    s_add_u32 s69, s69, 458752
    s_waitcnt vmcnt(12)
    s_barrier
    s_add_u32 m0, s70, 49152
    s_nop 0
    buffer_load_dwordx4 v16, s[28:31], s68 offen offset:0 sc1 lds
    buffer_load_dwordx4 v17, s[28:31], s68 offen offset:1024 sc1 lds
    buffer_load_dwordx4 v18, s[28:31], s68 offen offset:2048 sc1 lds
    buffer_load_dwordx4 v19, s[28:31], s68 offen offset:3072 sc1 lds
    s_add_u32 m0, s84, 65536
    s_add_u32 s68, s68, 128
    buffer_load_dwordx4 v20, s[32:35], s69 offen offset:0 lds
    buffer_load_dwordx4 v21, s[32:35], s69 offen offset:1024 lds
    buffer_load_dwordx4 v22, s[32:35], s69 offen offset:2048 lds
    buffer_load_dwordx4 v23, s[32:35], s69 offen offset:3072 lds
    s_add_u32 m0, s84, 69632
    s_nop 0
    buffer_load_dwordx4 v24, s[32:35], s69 offen offset:0 lds
    buffer_load_dwordx4 v25, s[32:35], s69 offen offset:1024 lds
    buffer_load_dwordx4 v26, s[32:35], s69 offen offset:2048 lds
    buffer_load_dwordx4 v27, s[32:35], s69 offen offset:3072 lds
    s_add_u32 s69, s69, 458752
    s_waitcnt vmcnt(12)
    s_barrier
    s_cmp_eq_u32 s68, s85
    s_cselect_b32 s71, 256, 0
    s_cselect_b32 s72, 917504, 0
    s_add_u32 s68, s68, s71
    s_add_u32 s69, s69, s72
    s_add_u32 m0, s70, 98304
    s_nop 0
    buffer_load_dwordx4 v16, s[28:31], s68 offen offset:0 sc1 lds
    buffer_load_dwordx4 v17, s[28:31], s68 offen offset:1024 sc1 lds
    buffer_load_dwordx4 v18, s[28:31], s68 offen offset:2048 sc1 lds
    buffer_load_dwordx4 v19, s[28:31], s68 offen offset:3072 sc1 lds
    s_add_u32 m0, s84, 114688
    s_add_u32 s68, s68, 128
    buffer_load_dwordx4 v20, s[32:35], s69 offen offset:0 lds
    buffer_load_dwordx4 v21, s[32:35], s69 offen offset:1024 lds
    buffer_load_dwordx4 v22, s[32:35], s69 offen offset:2048 lds
    buffer_load_dwordx4 v23, s[32:35], s69 offen offset:3072 lds
    s_add_u32 m0, s84, 118784
    s_nop 0
    buffer_load_dwordx4 v24, s[32:35], s69 offen offset:0 lds
    buffer_load_dwordx4 v25, s[32:35], s69 offen offset:1024 lds
    buffer_load_dwordx4 v26, s[32:35], s69 offen offset:2048 lds
    buffer_load_dwordx4 v27, s[32:35], s69 offen offset:3072 lds
    s_add_u32 s69, s69, 458752
    s_add_u32 s56, s26, 0x3000000
    s_addc_u32 s57, s27, 0
    s_mov_b32 s58, 0x1000000
    s_mov_b32 s59, 0x20000
    s_cmp_eq_u32 s76, 0
    s_mov_b32 s73, 0x51743260
    s_cselect_b32 s73, 0x76543210, s73
    s_lshl_b32 s71, s63, 2
    s_lshr_b32 s73, s73, s71
    s_and_b32 s73, s73, 7
    s_lshl_b32 s71, s77, 3
    s_add_u32 s71, s71, s73
    s_lshl_b32 s71, s71, 1
    s_add_u32 s71, s71, s76
    s_lshl_b32 s71, s71, 2
    s_add_u32 s71, s71, s75
    s_lshl_b32 s71, s71, 14
    v_lshlrev_b32 v220, 4, v1
    v_mov_b32 v216, -1
    v_mov_b32 v217, -1
    v_mov_b32 v218, -1
    v_mov_b32 v219, -1
    v_add_u32 v220, s71, v220
    s_mov_b32 s71, 0
    buffer_store_dwordx4 v[216:219], v220, s[56:59], s71 offen offset:0 sc1
    s_mov_b32 s71, 0
    buffer_store_dwordx4 v[216:219], v220, s[56:59], s71 offen offset:1024 sc1
    s_mov_b32 s71, 0
    buffer_store_dwordx4 v[216:219], v220, s[56:59], s71 offen offset:2048 sc1
    s_mov_b32 s71, 0
    buffer_store_dwordx4 v[216:219], v220, s[56:59], s71 offen offset:3072 sc1
    s_nop 1
    s_waitcnt vmcnt(16)
    s_barrier
    s_add_u32 m0, s70, 0
    s_nop 0
    buffer_load_dwordx4 v16, s[28:31], s68 offen offset:0 sc1 lds
    buffer_load_dwordx4 v17, s[28:31], s68 offen offset:1024 sc1 lds
    buffer_load_dwordx4 v18, s[28:31], s68 offen offset:2048 sc1 lds
    buffer_load_dwordx4 v19, s[28:31], s68 offen offset:3072 sc1 lds
    s_add_u32 m0, s84, 16384
    s_add_u32 s68, s68, 128
    buffer_load_dwordx4 v20, s[32:35], s69 offen offset:0 lds
    buffer_load_dwordx4 v21, s[32:35], s69 offen offset:1024 lds
    buffer_load_dwordx4 v22, s[32:35], s69 offen offset:2048 lds
    buffer_load_dwordx4 v23, s[32:35], s69 offen offset:3072 lds
    s_add_u32 m0, s84, 20480
    s_nop 0
    buffer_load_dwordx4 v24, s[32:35], s69 offen offset:0 lds
    buffer_load_dwordx4 v25, s[32:35], s69 offen offset:1024 lds
    buffer_load_dwordx4 v26, s[32:35], s69 offen offset:2048 lds
    buffer_load_dwordx4 v27, s[32:35], s69 offen offset:3072 lds
    s_add_u32 s69, s69, 458752
    s_waitcnt vmcnt(16)
    s_barrier
    s_cmp_eq_u32 s68, s85
    s_cselect_b32 s71, 256, 0
    s_cselect_b32 s72, 917504, 0
    s_add_u32 s68, s68, s71
    s_add_u32 s69, s69, s72
    s_add_u32 m0, s70, 49152
    s_nop 0
    buffer_load_dwordx4 v16, s[28:31], s68 offen offset:0 sc1 lds
    buffer_load_dwordx4 v17, s[28:31], s68 offen offset:1024 sc1 lds
    buffer_load_dwordx4 v18, s[28:31], s68 offen offset:2048 sc1 lds
    buffer_load_dwordx4 v19, s[28:31], s68 offen offset:3072 sc1 lds
    s_add_u32 m0, s84, 65536
    s_add_u32 s68, s68, 128
    buffer_load_dwordx4 v20, s[32:35], s69 offen offset:0 lds
    buffer_load_dwordx4 v21, s[32:35], s69 offen offset:1024 lds
    buffer_load_dwordx4 v22, s[32:35], s69 offen offset:2048 lds
    buffer_load_dwordx4 v23, s[32:35], s69 offen offset:3072 lds
    s_add_u32 m0, s84, 69632
    s_nop 0
    buffer_load_dwordx4 v24, s[32:35], s69 offen offset:0 lds
    buffer_load_dwordx4 v25, s[32:35], s69 offen offset:1024 lds
    buffer_load_dwordx4 v26, s[32:35], s69 offen offset:2048 lds
    buffer_load_dwordx4 v27, s[32:35], s69 offen offset:3072 lds
    s_add_u32 s69, s69, 458752
    s_waitcnt vmcnt(12)
    s_barrier
    s_add_u32 m0, s70, 98304
    s_nop 0
    buffer_load_dwordx4 v16, s[28:31], s68 offen offset:0 sc1 lds
    buffer_load_dwordx4 v17, s[28:31], s68 offen offset:1024 sc1 lds
    buffer_load_dwordx4 v18, s[28:31], s68 offen offset:2048 sc1 lds
    buffer_load_dwordx4 v19, s[28:31], s68 offen offset:3072 sc1 lds
    s_add_u32 m0, s84, 114688
    s_add_u32 s68, s68, 128
    buffer_load_dwordx4 v20, s[32:35], s69 offen offset:0 lds
    buffer_load_dwordx4 v21, s[32:35], s69 offen offset:1024 lds
    buffer_load_dwordx4 v22, s[32:35], s69 offen offset:2048 lds
    buffer_load_dwordx4 v23, s[32:35], s69 offen offset:3072 lds
    s_add_u32 m0, s84, 118784
    s_nop 0
    buffer_load_dwordx4 v24, s[32:35], s69 offen offset:0 lds
    buffer_load_dwordx4 v25, s[32:35], s69 offen offset:1024 lds
    buffer_load_dwordx4 v26, s[32:35], s69 offen offset:2048 lds
    buffer_load_dwordx4 v27, s[32:35], s69 offen offset:3072 lds
    s_add_u32 s69, s69, 458752
    s_waitcnt vmcnt(12)
    s_barrier
    s_cmp_eq_u32 s68, s85
    s_cselect_b32 s71, 256, 0
    s_cselect_b32 s72, 917504, 0
    s_add_u32 s68, s68, s71
    s_add_u32 s69, s69, s72
    s_add_u32 m0, s70, 0
    s_nop 0
    buffer_load_dwordx4 v16, s[28:31], s68 offen offset:0 sc1 lds
    buffer_load_dwordx4 v17, s[28:31], s68 offen offset:1024 sc1 lds
    buffer_load_dwordx4 v18, s[28:31], s68 offen offset:2048 sc1 lds
    buffer_load_dwordx4 v19, s[28:31], s68 offen offset:3072 sc1 lds
    s_add_u32 m0, s84, 16384
    s_add_u32 s68, s68, 128
    buffer_load_dwordx4 v20, s[32:35], s69 offen offset:0 lds
    buffer_load_dwordx4 v21, s[32:35], s69 offen offset:1024 lds
    buffer_load_dwordx4 v22, s[32:35], s69 offen offset:2048 lds
    buffer_load_dwordx4 v23, s[32:35], s69 offen offset:3072 lds
    s_add_u32 m0, s84, 20480
    s_nop 0
    buffer_load_dwordx4 v24, s[32:35], s69 offen offset:0 lds
    buffer_load_dwordx4 v25, s[32:35], s69 offen offset:1024 lds
    buffer_load_dwordx4 v26, s[32:35], s69 offen offset:2048 lds
    buffer_load_dwordx4 v27, s[32:35], s69 offen offset:3072 lds
    s_add_u32 s69, s69, 458752
    s_waitcnt vmcnt(12)
    s_barrier
    s_add_u32 m0, s70, 49152
    s_nop 0
    buffer_load_dwordx4 v16, s[28:31], s68 offen offset:0 sc1 lds
    buffer_load_dwordx4 v17, s[28:31], s68 offen offset:1024 sc1 lds
    buffer_load_dwordx4 v18, s[28:31], s68 offen offset:2048 sc1 lds
    buffer_load_dwordx4 v19, s[28:31], s68 offen offset:3072 sc1 lds
    s_add_u32 m0, s84, 65536
    s_add_u32 s68, s68, 128
    buffer_load_dwordx4 v20, s[32:35], s69 offen offset:0 lds
    buffer_load_dwordx4 v21, s[32:35], s69 offen offset:1024 lds
    buffer_load_dwordx4 v22, s[32:35], s69 offen offset:2048 lds
    buffer_load_dwordx4 v23, s[32:35], s69 offen offset:3072 lds
    s_add_u32 m0, s84, 69632
    s_nop 0
    buffer_load_dwordx4 v24, s[32:35], s69 offen offset:0 lds
    buffer_load_dwordx4 v25, s[32:35], s69 offen offset:1024 lds
    buffer_load_dwordx4 v26, s[32:35], s69 offen offset:2048 lds
    buffer_load_dwordx4 v27, s[32:35], s69 offen offset:3072 lds
    s_add_u32 s69, s69, 458752
    s_cmp_lg_u32 s75, 0
    s_cbranch_scc1 L_cnd_99
    s_cmp_eq_u32 s76, 0
    s_mov_b32 s73, 0x51743260
    s_cselect_b32 s73, 0x76543210, s73
    s_lshl_b32 s71, s63, 2
    s_lshr_b32 s73, s73, s71
    s_and_b32 s73, s73, 7
    s_lshl_b32 s72, s77, 3
    s_add_u32 s73, s73, s72
    s_lshl_b32 s73, s73, 1
    s_add_u32 s73, s73, s76
    s_xor_b32 s73, s73, 1
    s_lshl_b32 s73, s73, 5
    s_add_u32 s48, s26, 0x2700000
    s_addc_u32 s49, s27, 0
    s_mov_b32 s50, 0x8000
    s_mov_b32 s51, 0x20000
    s_add_u32 s71, s73, 24576
    v_mov_b32 v2, s71
    v_mov_b32 v3, 1
    s_mov_b64 exec, 1
    buffer_atomic_add v3, v2, s[48:51], 0 offen sc1
    s_mov_b64 exec, -1
L_cnd_99:
    s_waitcnt vmcnt(12)
    s_barrier
    s_cmp_eq_u32 s68, s85
    s_cselect_b32 s71, 256, 0
    s_cselect_b32 s72, 917504, 0
    s_add_u32 s68, s68, s71
    s_add_u32 s69, s69, s72
    s_add_u32 m0, s70, 98304
    s_nop 0
    buffer_load_dwordx4 v16, s[28:31], s68 offen offset:0 sc1 lds
    buffer_load_dwordx4 v17, s[28:31], s68 offen offset:1024 sc1 lds
    buffer_load_dwordx4 v18, s[28:31], s68 offen offset:2048 sc1 lds
    buffer_load_dwordx4 v19, s[28:31], s68 offen offset:3072 sc1 lds
    s_add_u32 m0, s84, 114688
    s_add_u32 s68, s68, 128
    buffer_load_dwordx4 v20, s[32:35], s69 offen offset:0 lds
    buffer_load_dwordx4 v21, s[32:35], s69 offen offset:1024 lds
    buffer_load_dwordx4 v22, s[32:35], s69 offen offset:2048 lds
    buffer_load_dwordx4 v23, s[32:35], s69 offen offset:3072 lds
    s_add_u32 m0, s84, 118784
    s_nop 0
    buffer_load_dwordx4 v24, s[32:35], s69 offen offset:0 lds
    buffer_load_dwordx4 v25, s[32:35], s69 offen offset:1024 lds
    buffer_load_dwordx4 v26, s[32:35], s69 offen offset:2048 lds
    buffer_load_dwordx4 v27, s[32:35], s69 offen offset:3072 lds
    s_add_u32 s69, s69, 458752
    s_waitcnt vmcnt(12)
    s_barrier
    s_add_u32 m0, s70, 0
    s_nop 0
    buffer_load_dwordx4 v16, s[28:31], s68 offen offset:0 sc1 lds
    buffer_load_dwordx4 v17, s[28:31], s68 offen offset:1024 sc1 lds
    buffer_load_dwordx4 v18, s[28:31], s68 offen offset:2048 sc1 lds
    buffer_load_dwordx4 v19, s[28:31], s68 offen offset:3072 sc1 lds
    s_add_u32 m0, s84, 16384
    s_add_u32 s68, s68, 128
    buffer_load_dwordx4 v20, s[32:35], s69 offen offset:0 lds
    buffer_load_dwordx4 v21, s[32:35], s69 offen offset:1024 lds
    buffer_load_dwordx4 v22, s[32:35], s69 offen offset:2048 lds
    buffer_load_dwordx4 v23, s[32:35], s69 offen offset:3072 lds
    s_add_u32 m0, s84, 20480
    s_nop 0
    buffer_load_dwordx4 v24, s[32:35], s69 offen offset:0 lds
    buffer_load_dwordx4 v25, s[32:35], s69 offen offset:1024 lds
    buffer_load_dwordx4 v26, s[32:35], s69 offen offset:2048 lds
    buffer_load_dwordx4 v27, s[32:35], s69 offen offset:3072 lds
    s_add_u32 s69, s69, 458752
    s_waitcnt vmcnt(12)
    s_barrier
    s_add_u32 s40, s26, 0x2500000
    s_addc_u32 s41, s27, 0
    s_mov_b32 s42, 0x40000
    s_mov_b32 s43, 0x20000
    s_add_u32 s52, s26, 0x2600000
    s_addc_u32 s53, s27, 0
    s_mov_b32 s54, 0x38000
    s_mov_b32 s55, 0x20000
    v_and_b32 v2, 31, v1
    s_lshl_b32 s71, s75, 8
    s_lshl_b32 s72, s77, 14
    s_add_u32 s71, s71, s72
    v_lshlrev_b32 v2, 3, v2
    v_add_u32 v2, s71, v2
    v_lshrrev_b32 v3, 5, v1
    v_lshl_add_u32 v2, v3, 13, v2
    v_add_u32 v4, 4096, v2
    buffer_load_dwordx2 v[64:65], v2, s[40:43], 0 offen offset:0 sc1
    buffer_load_dwordx2 v[66:67], v2, s[40:43], 0 offen offset:1024 sc1
    buffer_load_dwordx2 v[68:69], v2, s[40:43], 0 offen offset:2048 sc1
    buffer_load_dwordx2 v[70:71], v2, s[40:43], 0 offen offset:3072 sc1
    buffer_load_dwordx2 v[72:73], v4, s[40:43], 0 offen offset:0 sc1
    buffer_load_dwordx2 v[74:75], v4, s[40:43], 0 offen offset:1024 sc1
    buffer_load_dwordx2 v[76:77], v4, s[40:43], 0 offen offset:2048 sc1
    buffer_load_dwordx2 v[78:79], v4, s[40:43], 0 offen offset:3072 sc1
    s_lshl_b32 s71, s75, 6
    s_add_u32 s71, s71, s62
    v_add_u32 v3, s71, v1
    v_lshlrev_b32 v3, 2, v3
    s_mov_b32 s72, 0
    buffer_load_dword v96, v3, s[52:55], s72 offen sc1
    s_mov_b32 s72, 14336
    buffer_load_dword v97, v3, s[52:55], s72 offen sc1
    s_mov_b32 s72, 28672
    buffer_load_dword v98, v3, s[52:55], s72 offen sc1
    s_mov_b32 s72, 43008
    buffer_load_dword v99, v3, s[52:55], s72 offen sc1
    s_mov_b32 s72, 57344
    buffer_load_dword v100, v3, s[52:55], s72 offen sc1
    s_mov_b32 s72, 71680
    buffer_load_dword v101, v3, s[52:55], s72 offen sc1
    s_mov_b32 s72, 86016
    buffer_load_dword v102, v3, s[52:55], s72 offen sc1
    s_mov_b32 s72, 100352
    buffer_load_dword v103, v3, s[52:55], s72 offen sc1
    s_mov_b32 s72, 114688
    buffer_load_dword v104, v3, s[52:55], s72 offen sc1
    s_mov_b32 s72, 129024
    buffer_load_dword v105, v3, s[52:55], s72 offen sc1
    s_mov_b32 s72, 143360
    buffer_load_dword v106, v3, s[52:55], s72 offen sc1
    s_mov_b32 s72, 157696
    buffer_load_dword v107, v3, s[52:55], s72 offen sc1
    s_mov_b32 s72, 172032
    buffer_load_dword v108, v3, s[52:55], s72 offen sc1
    s_mov_b32 s72, 186368
    buffer_load_dword v109, v3, s[52:55], s72 offen sc1
    s_mov_b32 s72, 200704
    buffer_load_dword v110, v3, s[52:55], s72 offen sc1
    s_mov_b32 s72, 215040
    buffer_load_dword v111, v3, s[52:55], s72 offen sc1
    s_add_u32 s40, s26, 0x2300000
    s_addc_u32 s41, s27, 0
    s_mov_b32 s42, 0x2000
    s_mov_b32 s43, 0x20000
    v_and_b32 v2, 31, v1
    s_lshl_b32 s71, s75, 5
    v_add_u32 v2, s71, v2
    v_lshlrev_b32 v113, 2, v2
    v_add_u32 v2, s61, v2
    v_lshlrev_b32 v2, 2, v2
    buffer_load_dword v112, v2, s[40:43], 0 offen sc1
    s_mov_b32 s56, s18
    s_mov_b32 s57, s19
    s_mov_b32 s58, 0x700000
    s_mov_b32 s59, 0x20000
    s_and_b32 s71, s79, 3
    s_cmp_eq_u32 s76, 0
    s_cselect_b32 s72, 32, 24
    s_mul_i32 s71, s71, s72
    s_add_u32 s71, s71, s80
    s_lshl_b32 s72, s76, 7
    s_add_u32 s71, s71, s72
    s_lshl_b32 s71, s71, 2
    s_add_u32 s71, s71, s75
    s_lshl_b32 s71, s71, 13
    v_lshlrev_b32 v126, 7, v1
    buffer_load_dword v127, v126, s[56:59], s71 offen
    s_mov_b32 s56, s8
    s_mov_b32 s57, s9
    s_mov_b32 s58, 0x200000
    s_mov_b32 s59, 0x20000
    s_and_b32 s71, s79, 3
    s_lshl_b32 s71, s71, 5
    s_add_u32 s71, s71, s80
    s_lshl_b32 s71, s71, 2
    s_add_u32 s71, s71, s75
    s_lshl_b32 s71, s71, 12
    s_mov_b32 exec_hi, 0
    buffer_load_dword v127, v126, s[56:59], s71 offen
    s_mov_b64 exec, -1
    s_waitcnt vmcnt(27)
    s_barrier
    s_waitcnt vmcnt(2)
    v_sub_f32 v112, 1.0, v112
    v_cvt_pk_bf16_f32 v112, v112, v112
    v_lshlrev_b32 v112, 16, v112
    v_add_u32 v113, 149568, v113
    ds_write_b32 v113, v112
    v_pk_add_f32 v[64:65], v[64:65], v[66:67]
    v_pk_add_f32 v[64:65], v[64:65], v[68:69]
    v_pk_add_f32 v[64:65], v[64:65], v[70:71]
    v_pk_add_f32 v[64:65], v[64:65], v[72:73]
    v_pk_add_f32 v[64:65], v[64:65], v[74:75]
    v_pk_add_f32 v[64:65], v[64:65], v[76:77]
    v_pk_add_f32 v[64:65], v[64:65], v[78:79]
    v_add_f32 v96, v96, v97
    v_add_f32 v96, v96, v98
    v_add_f32 v96, v96, v99
    v_add_f32 v96, v96, v100
    v_add_f32 v96, v96, v101
    v_add_f32 v96, v96, v102
    v_add_f32 v96, v96, v103
    v_add_f32 v96, v96, v104
    v_add_f32 v96, v96, v105
    v_add_f32 v96, v96, v106
    v_add_f32 v96, v96, v107
    v_add_f32 v96, v96, v108
    v_add_f32 v96, v96, v109
    v_add_f32 v96, v96, v110
    v_add_f32 v96, v96, v111
    v_mov_b32 v50, v64
    v_mov_b32 v51, v65
    v_mov_b32 v52, v96
    v_mov_b32 v55, 0
    v_mov_b32 v56, 0
    v_mov_b32 v53, 0
    s_nop 3
    v_add_f32 v50, v50, v55
    v_add_f32 v51, v51, v56
    v_add_f32 v52, v52, v53
    v_mov_b32 v3, v50
    v_mov_b32 v4, v50
    v_mov_b32 v5, v51
    v_mov_b32 v6, v51
    s_nop 1
    v_permlane32_swap_b32 v3, v4
    v_permlane32_swap_b32 v5, v6
    s_nop 1
    v_add_f32 v3, v3, v4
    v_add_f32 v5, v5, v6
    v_mul_f32 v3, 0x3a800000, v3
    v_mul_f32 v5, 0x3a800000, v5
    v_fma_f32 v5, -v3, v3, v5
    v_max_f32 v5, 0, v5
    v_cvt_pk_bf16_f32 v3, v3, v3
    v_lshlrev_b32 v3, 16, v3
    v_cvt_pk_bf16_f32 v5, v5, v5
    v_lshlrev_b32 v5, 16, v5
    v_add_f32 v5, 0x3727c5ac, v5
    v_cvt_pk_bf16_f32 v5, v5, v5
    v_lshlrev_b32 v5, 16, v5
    v_sqrt_f32 v5, v5
    s_nop 0
    v_cvt_pk_bf16_f32 v5, v5, v5
    v_lshlrev_b32 v5, 16, v5
    v_rcp_f32 v6, v5
    s_nop 0
    v_mul_f32 v7, v3, v6
    v_sub_f32 v7, 0, v7
    v_sub_f32 v4, 0, v3
    v_mov_b32 v68, v4
    v_mul_f32 v69, v6, v6
    v_mul_f32 v69, v69, v6
    v_mul_f32 v69, 0xbdd2d3e8, v69
    v_mul_f32 v70, 0xc0135761, v6
    v_mul_f32 v71, v6, v112
    v_max_f32 v71, 0x0da24260, v71
    v_rcp_f32 v71, v71
    v_and_b32 v3, 31, v1
    s_lshl_b32 s71, s75, 5
    v_add_u32 v3, s71, v3
    v_lshlrev_b32 v3, 4, v3
    v_add_u32 v3, 150080, v3
    ds_write_b128 v3, v[68:71]
    v_and_b32 v3, 31, v1
    s_lshl_b32 s71, s75, 5
    v_add_u32 v3, s71, v3
    v_lshlrev_b32 v3, 3, v3
    v_add_u32 v3, 147456, v3
    ds_write_b64 v3, v[6:7]
    s_lshl_b32 s71, s75, 6
    v_add_u32 v3, s71, v1
    v_lshlrev_b32 v3, 2, v3
    v_add_u32 v3, 148480, v3
    ds_write_b32 v3, v52
    s_waitcnt lgkmcnt(0)
    s_barrier
    s_branch L_loader4
L_A_loader:
    v_mov_b32 v4, 149504
    v_mov_b32 v3, 0
    ds_write_b32 v4, v3
    s_lshl_b32 s62, s63, 7
    v_lshrrev_b32 v5, 4, v1
    s_lshl_b32 s71, s75, 4
    v_add_u32 v3, s71, v5
    s_mov_b32 s72, 6144
    v_mul_lo_u32 v3, v3, s72
    v_and_b32 v4, 15, v1
    v_lshlrev_b32 v5, 2, v5
    v_xor_b32 v4, v4, v5
    v_lshl_add_u32 v3, v4, 4, v3
    s_lshl_b32 s71, s62, 1
    v_add_u32 v3, s71, v3
    v_add_u32 v32, 0x0, v3
    v_add_u32 v33, 0x5c00, v3
    v_xor_b32 v3, 32, v3
    v_add_u32 v34, 0xb800, v3
    v_add_u32 v35, 0x11400, v3
    v_lshrrev_b32 v3, 3, v1
    v_and_b32 v4, 7, v1
    v_lshrrev_b32 v5, 4, v1
    v_xor_b32 v4, v4, v5
    s_lshl_b32 s71, s75, 5
    s_add_u32 s71, s71, s61
    v_add_u32 v3, s71, v3
    s_mov_b32 s72, 2048
    v_mul_lo_u32 v3, v3, s72
    v_mov_b32 v5, v4
    v_lshl_add_u32 v5, v5, 4, v3
    v_add_u32 v28, 0x0, v5
    v_xor_b32 v5, 4, v4
    v_lshl_add_u32 v5, v5, 4, v3
    v_add_u32 v29, 0x3c00, v5
    v_mov_b32 v5, v4
    v_lshl_add_u32 v5, v5, 4, v3
    v_add_u32 v30, 0x7800, v5
    v_xor_b32 v5, 4, v4
    v_lshl_add_u32 v5, v5, 4, v3
    v_add_u32 v31, 0xb400, v5
    s_waitcnt vmcnt(12)
    s_barrier
    s_add_u32 m0, s70, 98304
    s_nop 0
    buffer_load_dwordx4 v16, s[28:31], s68 offen offset:0 lds
    buffer_load_dwordx4 v17, s[28:31], s68 offen offset:1024 lds
    buffer_load_dwordx4 v18, s[28:31], s68 offen offset:2048 lds
    buffer_load_dwordx4 v19, s[28:31], s68 offen offset:3072 lds
    s_add_u32 m0, s84, 114688
    s_add_u32 s68, s68, 128
    buffer_load_dwordx4 v20, s[32:35], s69 offen offset:0 lds
    buffer_load_dwordx4 v21, s[32:35], s69 offen offset:1024 lds
    buffer_load_dwordx4 v22, s[32:35], s69 offen offset:2048 lds
    buffer_load_dwordx4 v23, s[32:35], s69 offen offset:3072 lds
    s_add_u32 m0, s84, 118784
    s_nop 0
    buffer_load_dwordx4 v24, s[32:35], s69 offen offset:0 lds
    buffer_load_dwordx4 v25, s[32:35], s69 offen offset:1024 lds
    buffer_load_dwordx4 v26, s[32:35], s69 offen offset:2048 lds
    buffer_load_dwordx4 v27, s[32:35], s69 offen offset:3072 lds
    s_add_u32 s69, s69, 393216
    s_waitcnt vmcnt(12)
    s_barrier
    s_add_u32 m0, s70, 0
    s_nop 0
    buffer_load_dwordx4 v16, s[28:31], s68 offen offset:0 lds
    buffer_load_dwordx4 v17, s[28:31], s68 offen offset:1024 lds
    buffer_load_dwordx4 v18, s[28:31], s68 offen offset:2048 lds
    buffer_load_dwordx4 v19, s[28:31], s68 offen offset:3072 lds
    s_add_u32 m0, s84, 16384
    s_add_u32 s68, s68, 128
    buffer_load_dwordx4 v20, s[32:35], s69 offen offset:0 lds
    buffer_load_dwordx4 v21, s[32:35], s69 offen offset:1024 lds
    buffer_load_dwordx4 v22, s[32:35], s69 offen offset:2048 lds
    buffer_load_dwordx4 v23, s[32:35], s69 offen offset:3072 lds
    s_add_u32 m0, s84, 20480
    s_nop 0
    buffer_load_dwordx4 v24, s[32:35], s69 offen offset:0 lds
    buffer_load_dwordx4 v25, s[32:35], s69 offen offset:1024 lds
    buffer_load_dwordx4 v26, s[32:35], s69 offen offset:2048 lds
    buffer_load_dwordx4 v27, s[32:35], s69 offen offset:3072 lds
    s_add_u32 s69, s69, 393216
    s_waitcnt vmcnt(12)
    s_barrier
    s_add_u32 m0, s70, 49152
    s_nop 0
    buffer_load_dwordx4 v16, s[28:31], s68 offen offset:0 lds
    buffer_load_dwordx4 v17, s[28:31], s68 offen offset:1024 lds
    buffer_load_dwordx4 v18, s[28:31], s68 offen offset:2048 lds
    buffer_load_dwordx4 v19, s[28:31], s68 offen offset:3072 lds
    s_add_u32 m0, s84, 65536
    s_add_u32 s68, s68, 128
    buffer_load_dwordx4 v20, s[32:35], s69 offen offset:0 lds
    buffer_load_dwordx4 v21, s[32:35], s69 offen offset:1024 lds
    buffer_load_dwordx4 v22, s[32:35], s69 offen offset:2048 lds
    buffer_load_dwordx4 v23, s[32:35], s69 offen offset:3072 lds
    s_add_u32 m0, s84, 69632
    s_nop 0
    buffer_load_dwordx4 v24, s[32:35], s69 offen offset:0 lds
    buffer_load_dwordx4 v25, s[32:35], s69 offen offset:1024 lds
    buffer_load_dwordx4 v26, s[32:35], s69 offen offset:2048 lds
    buffer_load_dwordx4 v27, s[32:35], s69 offen offset:3072 lds
    s_add_u32 s69, s69, 393216
    s_waitcnt vmcnt(12)
    s_barrier
    s_add_u32 m0, s70, 98304
    s_nop 0
    buffer_load_dwordx4 v16, s[28:31], s68 offen offset:0 lds
    buffer_load_dwordx4 v17, s[28:31], s68 offen offset:1024 lds
    buffer_load_dwordx4 v18, s[28:31], s68 offen offset:2048 lds
    buffer_load_dwordx4 v19, s[28:31], s68 offen offset:3072 lds
    s_add_u32 m0, s84, 114688
    s_add_u32 s68, s68, 128
    buffer_load_dwordx4 v20, s[32:35], s69 offen offset:0 lds
    buffer_load_dwordx4 v21, s[32:35], s69 offen offset:1024 lds
    buffer_load_dwordx4 v22, s[32:35], s69 offen offset:2048 lds
    buffer_load_dwordx4 v23, s[32:35], s69 offen offset:3072 lds
    s_add_u32 m0, s84, 118784
    s_nop 0
    buffer_load_dwordx4 v24, s[32:35], s69 offen offset:0 lds
    buffer_load_dwordx4 v25, s[32:35], s69 offen offset:1024 lds
    buffer_load_dwordx4 v26, s[32:35], s69 offen offset:2048 lds
    buffer_load_dwordx4 v27, s[32:35], s69 offen offset:3072 lds
    s_add_u32 s69, s69, 393216
    s_waitcnt vmcnt(12)
    s_barrier
    s_add_u32 m0, s70, 0
    s_nop 0
    buffer_load_dwordx4 v16, s[28:31], s68 offen offset:0 lds
    buffer_load_dwordx4 v17, s[28:31], s68 offen offset:1024 lds
    buffer_load_dwordx4 v18, s[28:31], s68 offen offset:2048 lds
    buffer_load_dwordx4 v19, s[28:31], s68 offen offset:3072 lds
    s_add_u32 m0, s84, 16384
    s_add_u32 s68, s68, 128
    buffer_load_dwordx4 v20, s[32:35], s69 offen offset:0 lds
    buffer_load_dwordx4 v21, s[32:35], s69 offen offset:1024 lds
    buffer_load_dwordx4 v22, s[32:35], s69 offen offset:2048 lds
    buffer_load_dwordx4 v23, s[32:35], s69 offen offset:3072 lds
    s_add_u32 m0, s84, 20480
    s_nop 0
    buffer_load_dwordx4 v24, s[32:35], s69 offen offset:0 lds
    buffer_load_dwordx4 v25, s[32:35], s69 offen offset:1024 lds
    buffer_load_dwordx4 v26, s[32:35], s69 offen offset:2048 lds
    buffer_load_dwordx4 v27, s[32:35], s69 offen offset:3072 lds
    s_add_u32 s69, s69, 393216
    s_waitcnt vmcnt(12)
    s_barrier
    s_add_u32 m0, s70, 49152
    s_nop 0
    buffer_load_dwordx4 v16, s[28:31], s68 offen offset:0 lds
    buffer_load_dwordx4 v17, s[28:31], s68 offen offset:1024 lds
    buffer_load_dwordx4 v18, s[28:31], s68 offen offset:2048 lds
    buffer_load_dwordx4 v19, s[28:31], s68 offen offset:3072 lds
    s_add_u32 m0, s84, 65536
    s_add_u32 s68, s68, 128
    buffer_load_dwordx4 v20, s[32:35], s69 offen offset:0 lds
    buffer_load_dwordx4 v21, s[32:35], s69 offen offset:1024 lds
    buffer_load_dwordx4 v22, s[32:35], s69 offen offset:2048 lds
    buffer_load_dwordx4 v23, s[32:35], s69 offen offset:3072 lds
    s_add_u32 m0, s84, 69632
    s_nop 0
    buffer_load_dwordx4 v24, s[32:35], s69 offen offset:0 lds
    buffer_load_dwordx4 v25, s[32:35], s69 offen offset:1024 lds
    buffer_load_dwordx4 v26, s[32:35], s69 offen offset:2048 lds
    buffer_load_dwordx4 v27, s[32:35], s69 offen offset:3072 lds
    s_add_u32 s69, s69, 393216
    s_waitcnt vmcnt(12)
    s_barrier
    s_add_u32 m0, s70, 98304
    s_nop 0
    buffer_load_dwordx4 v16, s[28:31], s68 offen offset:0 lds
    buffer_load_dwordx4 v17, s[28:31], s68 offen offset:1024 lds
    buffer_load_dwordx4 v18, s[28:31], s68 offen offset:2048 lds
    buffer_load_dwordx4 v19, s[28:31], s68 offen offset:3072 lds
    s_add_u32 m0, s84, 114688
    s_add_u32 s68, s68, 128
    buffer_load_dwordx4 v20, s[32:35], s69 offen offset:0 lds
    buffer_load_dwordx4 v21, s[32:35], s69 offen offset:1024 lds
    buffer_load_dwordx4 v22, s[32:35], s69 offen offset:2048 lds
    buffer_load_dwordx4 v23, s[32:35], s69 offen offset:3072 lds
    s_add_u32 m0, s84, 118784
    s_nop 0
    buffer_load_dwordx4 v24, s[32:35], s69 offen offset:0 lds
    buffer_load_dwordx4 v25, s[32:35], s69 offen offset:1024 lds
    buffer_load_dwordx4 v26, s[32:35], s69 offen offset:2048 lds
    buffer_load_dwordx4 v27, s[32:35], s69 offen offset:3072 lds
    s_add_u32 s69, s69, 393216
    s_waitcnt vmcnt(12)
    s_barrier
    s_add_u32 m0, s70, 0
    s_nop 0
    buffer_load_dwordx4 v16, s[28:31], s68 offen offset:0 lds
    buffer_load_dwordx4 v17, s[28:31], s68 offen offset:1024 lds
    buffer_load_dwordx4 v18, s[28:31], s68 offen offset:2048 lds
    buffer_load_dwordx4 v19, s[28:31], s68 offen offset:3072 lds
    s_add_u32 m0, s84, 16384
    s_add_u32 s68, s68, 128
    buffer_load_dwordx4 v20, s[32:35], s69 offen offset:0 lds
    buffer_load_dwordx4 v21, s[32:35], s69 offen offset:1024 lds
    buffer_load_dwordx4 v22, s[32:35], s69 offen offset:2048 lds
    buffer_load_dwordx4 v23, s[32:35], s69 offen offset:3072 lds
    s_add_u32 m0, s84, 20480
    s_nop 0
    buffer_load_dwordx4 v24, s[32:35], s69 offen offset:0 lds
    buffer_load_dwordx4 v25, s[32:35], s69 offen offset:1024 lds
    buffer_load_dwordx4 v26, s[32:35], s69 offen offset:2048 lds
    buffer_load_dwordx4 v27, s[32:35], s69 offen offset:3072 lds
    s_add_u32 s69, s69, 393216
    s_waitcnt vmcnt(12)
    s_barrier
    s_add_u32 m0, s70, 49152
    s_nop 0
    buffer_load_dwordx4 v16, s[28:31], s68 offen offset:0 lds
    buffer_load_dwordx4 v17, s[28:31], s68 offen offset:1024 lds
    buffer_load_dwordx4 v18, s[28:31], s68 offen offset:2048 lds
    buffer_load_dwordx4 v19, s[28:31], s68 offen offset:3072 lds
    s_add_u32 m0, s84, 65536
    s_add_u32 s68, s68, 128
    buffer_load_dwordx4 v20, s[32:35], s69 offen offset:0 lds
    buffer_load_dwordx4 v21, s[32:35], s69 offen offset:1024 lds
    buffer_load_dwordx4 v22, s[32:35], s69 offen offset:2048 lds
    buffer_load_dwordx4 v23, s[32:35], s69 offen offset:3072 lds
    s_add_u32 m0, s84, 69632
    s_nop 0
    buffer_load_dwordx4 v24, s[32:35], s69 offen offset:0 lds
    buffer_load_dwordx4 v25, s[32:35], s69 offen offset:1024 lds
    buffer_load_dwordx4 v26, s[32:35], s69 offen offset:2048 lds
    buffer_load_dwordx4 v27, s[32:35], s69 offen offset:3072 lds
    s_add_u32 s69, s69, 393216
    s_waitcnt vmcnt(12)
    s_barrier
    s_add_u32 m0, s70, 98304
    s_nop 0
    buffer_load_dwordx4 v16, s[28:31], s68 offen offset:0 lds
    buffer_load_dwordx4 v17, s[28:31], s68 offen offset:1024 lds
    buffer_load_dwordx4 v18, s[28:31], s68 offen offset:2048 lds
    buffer_load_dwordx4 v19, s[28:31], s68 offen offset:3072 lds
    s_add_u32 m0, s84, 114688
    s_add_u32 s68, s68, 128
    buffer_load_dwordx4 v20, s[32:35], s69 offen offset:0 lds
    buffer_load_dwordx4 v21, s[32:35], s69 offen offset:1024 lds
    buffer_load_dwordx4 v22, s[32:35], s69 offen offset:2048 lds
    buffer_load_dwordx4 v23, s[32:35], s69 offen offset:3072 lds
    s_add_u32 m0, s84, 118784
    s_nop 0
    buffer_load_dwordx4 v24, s[32:35], s69 offen offset:0 lds
    buffer_load_dwordx4 v25, s[32:35], s69 offen offset:1024 lds
    buffer_load_dwordx4 v26, s[32:35], s69 offen offset:2048 lds
    buffer_load_dwordx4 v27, s[32:35], s69 offen offset:3072 lds
    s_add_u32 s69, s69, 393216
    s_waitcnt vmcnt(12)
    s_barrier
    s_add_u32 m0, s70, 0
    s_nop 0
    buffer_load_dwordx4 v16, s[28:31], s68 offen offset:0 lds
    buffer_load_dwordx4 v17, s[28:31], s68 offen offset:1024 lds
    buffer_load_dwordx4 v18, s[28:31], s68 offen offset:2048 lds
    buffer_load_dwordx4 v19, s[28:31], s68 offen offset:3072 lds
    s_add_u32 m0, s84, 16384
    s_add_u32 s68, s68, 128
    buffer_load_dwordx4 v20, s[32:35], s69 offen offset:0 lds
    buffer_load_dwordx4 v21, s[32:35], s69 offen offset:1024 lds
    buffer_load_dwordx4 v22, s[32:35], s69 offen offset:2048 lds
    buffer_load_dwordx4 v23, s[32:35], s69 offen offset:3072 lds
    s_add_u32 m0, s84, 20480
    s_nop 0
    buffer_load_dwordx4 v24, s[32:35], s69 offen offset:0 lds
    buffer_load_dwordx4 v25, s[32:35], s69 offen offset:1024 lds
    buffer_load_dwordx4 v26, s[32:35], s69 offen offset:2048 lds
    buffer_load_dwordx4 v27, s[32:35], s69 offen offset:3072 lds
    s_add_u32 s69, s69, 393216
    s_waitcnt vmcnt(12)
    s_barrier
    s_add_u32 m0, s70, 49152
    s_nop 0
    buffer_load_dwordx4 v16, s[28:31], s68 offen offset:0 lds
    buffer_load_dwordx4 v17, s[28:31], s68 offen offset:1024 lds
    buffer_load_dwordx4 v18, s[28:31], s68 offen offset:2048 lds
    buffer_load_dwordx4 v19, s[28:31], s68 offen offset:3072 lds
    s_add_u32 m0, s84, 65536
    s_add_u32 s68, s68, 128
    buffer_load_dwordx4 v20, s[32:35], s69 offen offset:0 lds
    buffer_load_dwordx4 v21, s[32:35], s69 offen offset:1024 lds
    buffer_load_dwordx4 v22, s[32:35], s69 offen offset:2048 lds
    buffer_load_dwordx4 v23, s[32:35], s69 offen offset:3072 lds
    s_add_u32 m0, s84, 69632
    s_nop 0
    buffer_load_dwordx4 v24, s[32:35], s69 offen offset:0 lds
    buffer_load_dwordx4 v25, s[32:35], s69 offen offset:1024 lds
    buffer_load_dwordx4 v26, s[32:35], s69 offen offset:2048 lds
    buffer_load_dwordx4 v27, s[32:35], s69 offen offset:3072 lds
    s_add_u32 s69, s69, 393216
    s_waitcnt vmcnt(12)
    s_barrier
    s_add_u32 m0, s70, 98304
    s_nop 0
    buffer_load_dwordx4 v16, s[28:31], s68 offen offset:0 lds
    buffer_load_dwordx4 v17, s[28:31], s68 offen offset:1024 lds
    buffer_load_dwordx4 v18, s[28:31], s68 offen offset:2048 lds
    buffer_load_dwordx4 v19, s[28:31], s68 offen offset:3072 lds
    s_add_u32 m0, s84, 114688
    s_add_u32 s68, s68, 128
    buffer_load_dwordx4 v20, s[32:35], s69 offen offset:0 lds
    buffer_load_dwordx4 v21, s[32:35], s69 offen offset:1024 lds
    buffer_load_dwordx4 v22, s[32:35], s69 offen offset:2048 lds
    buffer_load_dwordx4 v23, s[32:35], s69 offen offset:3072 lds
    s_add_u32 m0, s84, 118784
    s_nop 0
    buffer_load_dwordx4 v24, s[32:35], s69 offen offset:0 lds
    buffer_load_dwordx4 v25, s[32:35], s69 offen offset:1024 lds
    buffer_load_dwordx4 v26, s[32:35], s69 offen offset:2048 lds
    buffer_load_dwordx4 v27, s[32:35], s69 offen offset:3072 lds
    s_add_u32 s69, s69, 393216
    s_waitcnt vmcnt(12)
    s_barrier
    s_add_u32 m0, s70, 0
    s_nop 0
    buffer_load_dwordx4 v16, s[28:31], s68 offen offset:0 lds
    buffer_load_dwordx4 v17, s[28:31], s68 offen offset:1024 lds
    buffer_load_dwordx4 v18, s[28:31], s68 offen offset:2048 lds
    buffer_load_dwordx4 v19, s[28:31], s68 offen offset:3072 lds
    s_add_u32 m0, s84, 16384
    s_add_u32 s68, s68, 128
    buffer_load_dwordx4 v20, s[32:35], s69 offen offset:0 lds
    buffer_load_dwordx4 v21, s[32:35], s69 offen offset:1024 lds
    buffer_load_dwordx4 v22, s[32:35], s69 offen offset:2048 lds
    buffer_load_dwordx4 v23, s[32:35], s69 offen offset:3072 lds
    s_add_u32 m0, s84, 20480
    s_nop 0
    buffer_load_dwordx4 v24, s[32:35], s69 offen offset:0 lds
    buffer_load_dwordx4 v25, s[32:35], s69 offen offset:1024 lds
    buffer_load_dwordx4 v26, s[32:35], s69 offen offset:2048 lds
    buffer_load_dwordx4 v27, s[32:35], s69 offen offset:3072 lds
    s_add_u32 s69, s69, 393216
    s_waitcnt vmcnt(12)
    s_barrier
    v_mov_b32 v16, v28
    v_mov_b32 v17, v29
    v_mov_b32 v18, v30
    v_mov_b32 v19, v31
    s_waitcnt vmcnt(0)
    s_barrier
    s_barrier
    s_mov_b32 s68, 0
    s_mov_b32 s69, 0
    s_add_u32 m0, s70, 0
    s_nop 0
    buffer_load_dwordx4 v16, s[28:31], s68 offen offset:0 lds
    buffer_load_dwordx4 v17, s[28:31], s68 offen offset:1024 lds
    buffer_load_dwordx4 v18, s[28:31], s68 offen offset:2048 lds
    buffer_load_dwordx4 v19, s[28:31], s68 offen offset:3072 lds
    s_add_u32 m0, s70, 16384
    s_add_u32 s68, s68, 128
    buffer_load_dwordx4 v32, s[32:35], s69 offen offset:0 lds
    buffer_load_dwordx4 v33, s[32:35], s69 offen offset:1024 lds
    buffer_load_dwordx4 v34, s[32:35], s69 offen offset:2048 lds
    buffer_load_dwordx4 v35, s[32:35], s69 offen offset:3072 lds
    s_add_u32 s69, s69, 393216
    s_add_u32 m0, s70, 32768
    s_nop 0
    buffer_load_dwordx4 v16, s[28:31], s68 offen offset:0 lds
    buffer_load_dwordx4 v17, s[28:31], s68 offen offset:1024 lds
    buffer_load_dwordx4 v18, s[28:31], s68 offen offset:2048 lds
    buffer_load_dwordx4 v19, s[28:31], s68 offen offset:3072 lds
    s_add_u32 m0, s70, 49152
    s_add_u32 s68, s68, 128
    buffer_load_dwordx4 v32, s[32:35], s69 offen offset:0 lds
    buffer_load_dwordx4 v33, s[32:35], s69 offen offset:1024 lds
    buffer_load_dwordx4 v34, s[32:35], s69 offen offset:2048 lds
    buffer_load_dwordx4 v35, s[32:35], s69 offen offset:3072 lds
    s_add_u32 s69, s69, 393216
    s_add_u32 m0, s70, 65536
    s_nop 0
    buffer_load_dwordx4 v16, s[28:31], s68 offen offset:0 lds
    buffer_load_dwordx4 v17, s[28:31], s68 offen offset:1024 lds
    buffer_load_dwordx4 v18, s[28:31], s68 offen offset:2048 lds
    buffer_load_dwordx4 v19, s[28:31], s68 offen offset:3072 lds
    s_add_u32 m0, s70, 81920
    s_add_u32 s68, s68, 128
    buffer_load_dwordx4 v32, s[32:35], s69 offen offset:0 lds
    buffer_load_dwordx4 v33, s[32:35], s69 offen offset:1024 lds
    buffer_load_dwordx4 v34, s[32:35], s69 offen offset:2048 lds
    buffer_load_dwordx4 v35, s[32:35], s69 offen offset:3072 lds
    s_add_u32 s69, s69, 393216
    s_add_u32 m0, s70, 98304
    s_nop 0
    buffer_load_dwordx4 v16, s[28:31], s68 offen offset:0 lds
    buffer_load_dwordx4 v17, s[28:31], s68 offen offset:1024 lds
    buffer_load_dwordx4 v18, s[28:31], s68 offen offset:2048 lds
    buffer_load_dwordx4 v19, s[28:31], s68 offen offset:3072 lds
    s_add_u32 m0, s70, 114688
    s_add_u32 s68, s68, 128
    buffer_load_dwordx4 v32, s[32:35], s69 offen offset:0 lds
    buffer_load_dwordx4 v33, s[32:35], s69 offen offset:1024 lds
    buffer_load_dwordx4 v34, s[32:35], s69 offen offset:2048 lds
    buffer_load_dwordx4 v35, s[32:35], s69 offen offset:3072 lds
    s_add_u32 s69, s69, 393216
    s_cmp_eq_u32 s76, 0
    s_mov_b32 s78, 0x51743260
    s_cselect_b32 s78, 0x76543210, s78
    s_lshl_b32 s71, s63, 2
    s_lshr_b32 s78, s78, s71
    s_and_b32 s78, s78, 7
    s_lshl_b32 s62, s78, 7
    s_mov_b32 s28, s26
    s_mov_b32 s29, s27
    s_mov_b32 s30, 0x400000
    s_mov_b32 s31, 0x20000
    s_mov_b32 s32, s8
    s_mov_b32 s33, s9
    s_mov_b32 s34, 0x200000
    s_mov_b32 s35, 0x20000
    s_add_u32 s44, s26, 0x1000000
    s_addc_u32 s45, s27, 0
    s_mov_b32 s46, 0xe00000
    s_mov_b32 s47, 0x20000
    s_mov_b32 s36, s22
    s_mov_b32 s37, s23
    s_mov_b32 s38, 0x400000
    s_mov_b32 s39, 0x20000
    s_add_u32 s40, s26, 0x800000
    s_addc_u32 s41, s27, 0
    s_mov_b32 s42, 0x400000
    s_mov_b32 s43, 0x20000
    s_add_u32 s52, s26, 0x2300000
    s_addc_u32 s53, s27, 0
    s_mov_b32 s54, 0x2000
    s_mov_b32 s55, 0x20000
    v_lshrrev_b32 v5, 4, v1
    s_lshl_b32 s71, s75, 4
    v_add_u32 v3, s71, v5
    s_mov_b32 s72, 2048
    v_mul_lo_u32 v3, v3, s72
    v_and_b32 v4, 15, v1
    v_lshlrev_b32 v5, 2, v5
    v_xor_b32 v4, v4, v5
    v_lshl_add_u32 v3, v4, 4, v3
    s_lshl_b32 s71, s62, 1
    v_add_u32 v3, s71, v3
    v_add_u32 v204, 0x0, v3
    v_add_u32 v205, 0x1c00, v3
    v_xor_b32 v3, 32, v3
    v_add_u32 v206, 0x3800, v3
    v_add_u32 v207, 0x5400, v3
    v_lshrrev_b32 v3, 3, v1
    v_and_b32 v4, 7, v1
    v_lshrrev_b32 v5, 4, v1
    v_xor_b32 v4, v4, v5
    s_xor_b32 s71, s75, s76
    s_lshl_b32 s71, s71, 5
    s_add_u32 s71, s71, s61
    v_add_u32 v3, s71, v3
    s_mov_b32 s72, 2048
    v_mul_lo_u32 v3, v3, s72
    v_mov_b32 v5, v4
    v_lshl_add_u32 v5, v5, 4, v3
    v_add_u32 v200, 0x0, v5
    v_xor_b32 v5, 4, v4
    v_lshl_add_u32 v5, v5, 4, v3
    v_add_u32 v201, 0x3c00, v5
    v_mov_b32 v5, v4
    v_lshl_add_u32 v5, v5, 4, v3
    v_add_u32 v202, 0x7800, v5
    v_xor_b32 v5, 4, v4
    v_lshl_add_u32 v5, v5, 4, v3
    v_add_u32 v203, 0xb400, v5
    v_lshrrev_b32 v3, 3, v1
    v_and_b32 v4, 7, v1
    v_lshrrev_b32 v5, 4, v1
    v_xor_b32 v4, v4, v5
    s_xor_b32 s71, s75, s76
    s_lshl_b32 s71, s71, 5
    s_add_u32 s71, s71, s61
    v_add_u32 v3, s71, v3
    s_mov_b32 s72, 7168
    v_mul_lo_u32 v3, v3, s72
    v_mov_b32 v5, v4
    v_lshl_add_u32 v5, v5, 4, v3
    v_add_u32 v208, 0x0, v5
    v_xor_b32 v5, 4, v4
    v_lshl_add_u32 v5, v5, 4, v3
    v_add_u32 v209, 0xdc00, v5
    v_mov_b32 v5, v4
    v_lshl_add_u32 v5, v5, 4, v3
    v_add_u32 v210, 0x1b800, v5
    v_xor_b32 v5, 4, v4
    v_lshl_add_u32 v5, v5, 4, v3
    v_add_u32 v211, 0x29400, v5
    s_lshl_b32 s78, s76, 3
    s_add_u32 s78, s78, s63
    s_lshl_b32 s62, s78, 8
    s_add_u32 s28, s26, 0x800000
    s_addc_u32 s29, s27, 0
    s_mov_b32 s30, 0x400000
    s_mov_b32 s31, 0x20000
    s_mov_b32 s32, s16
    s_mov_b32 s33, s17
    s_mov_b32 s34, 0x700000
    s_mov_b32 s35, 0x20000
    s_add_u32 s36, s26, 0x1000000
    s_addc_u32 s37, s27, 0
    s_mov_b32 s38, 0xe00000
    s_mov_b32 s39, 0x20000
    s_mov_b32 s64, 7168
    s_mov_b32 s65, 32
    s_mov_b32 s66, 64
    v_lshrrev_b32 v3, 5, v1
    v_and_b32 v4, 31, v1
    s_lshl_b32 s71, s75, 4
    v_add_u32 v6, s71, v3
    v_mul_lo_u32 v6, v6, s64
    v_or_b32 v5, 0, v3
    v_lshlrev_b32 v5, 2, v5
    v_xor_b32 v5, v5, v4
    v_bfe_u32 v7, v5, 2, 1
    v_mul_lo_u32 v7, v7, s65
    v_lshrrev_b32 v8, 3, v5
    v_mul_lo_u32 v8, v8, s66
    v_and_b32 v9, 3, v5
    v_lshlrev_b32 v9, 3, v9
    v_add3_u32 v7, v7, v8, v9
    v_add_u32 v7, s62, v7
    v_lshl_add_u32 v10, v7, 1, v6
    v_or_b32 v5, 2, v3
    v_lshlrev_b32 v5, 2, v5
    v_xor_b32 v5, v5, v4
    v_bfe_u32 v7, v5, 2, 1
    v_mul_lo_u32 v7, v7, s65
    v_lshrrev_b32 v8, 3, v5
    v_mul_lo_u32 v8, v8, s66
    v_and_b32 v9, 3, v5
    v_lshlrev_b32 v9, 3, v9
    v_add3_u32 v7, v7, v8, v9
    v_add_u32 v7, s62, v7
    v_lshl_add_u32 v11, v7, 1, v6
    s_mul_i32 s71, s64, 0
    s_sub_u32 s71, s71, 0
    v_add_u32 v20, s71, v10
    s_mul_i32 s71, s64, 2
    s_sub_u32 s71, s71, 1024
    v_add_u32 v21, s71, v11
    s_mul_i32 s71, s64, 4
    s_sub_u32 s71, s71, 2048
    v_add_u32 v22, s71, v10
    s_mul_i32 s71, s64, 6
    s_sub_u32 s71, s71, 3072
    v_add_u32 v23, s71, v11
    v_xor_b32 v10, 32, v10
    v_xor_b32 v11, 32, v11
    s_mul_i32 s71, s64, 8
    s_sub_u32 s71, s71, 0
    v_add_u32 v24, s71, v10
    s_mul_i32 s71, s64, 10
    s_sub_u32 s71, s71, 1024
    v_add_u32 v25, s71, v11
    s_mul_i32 s71, s64, 12
    s_sub_u32 s71, s71, 2048
    v_add_u32 v26, s71, v10
    s_mul_i32 s71, s64, 14
    s_sub_u32 s71, s71, 3072
    v_add_u32 v27, s71, v11
    s_mov_b32 s28, s4
    s_mov_b32 s29, s5
    s_mov_b32 s30, 0x400000
    s_mov_b32 s31, 0x20000
    s_mov_b32 s32, s6
    s_mov_b32 s33, s7
    s_mov_b32 s34, 0x600000
    s_mov_b32 s35, 0x20000
    s_waitcnt vmcnt(24)
    s_barrier
    s_waitcnt vmcnt(16)
    s_barrier
    s_add_u32 m0, s70, 0
    s_nop 0
    buffer_load_dwordx4 v16, s[28:31], s68 offen offset:0 lds
    buffer_load_dwordx4 v17, s[28:31], s68 offen offset:1024 lds
    buffer_load_dwordx4 v18, s[28:31], s68 offen offset:2048 lds
    buffer_load_dwordx4 v19, s[28:31], s68 offen offset:3072 lds
    s_add_u32 m0, s70, 16384
    s_add_u32 s68, s68, 128
    buffer_load_dwordx4 v32, s[32:35], s69 offen offset:0 lds
    buffer_load_dwordx4 v33, s[32:35], s69 offen offset:1024 lds
    buffer_load_dwordx4 v34, s[32:35], s69 offen offset:2048 lds
    buffer_load_dwordx4 v35, s[32:35], s69 offen offset:3072 lds
    s_add_u32 s69, s69, 393216
    s_waitcnt vmcnt(16)
    s_barrier
    s_add_u32 m0, s70, 32768
    s_nop 0
    buffer_load_dwordx4 v16, s[28:31], s68 offen offset:0 lds
    buffer_load_dwordx4 v17, s[28:31], s68 offen offset:1024 lds
    buffer_load_dwordx4 v18, s[28:31], s68 offen offset:2048 lds
    buffer_load_dwordx4 v19, s[28:31], s68 offen offset:3072 lds
    s_add_u32 m0, s70, 49152
    s_add_u32 s68, s68, 128
    buffer_load_dwordx4 v32, s[32:35], s69 offen offset:0 lds
    buffer_load_dwordx4 v33, s[32:35], s69 offen offset:1024 lds
    buffer_load_dwordx4 v34, s[32:35], s69 offen offset:2048 lds
    buffer_load_dwordx4 v35, s[32:35], s69 offen offset:3072 lds
    s_add_u32 s69, s69, 393216
    s_waitcnt vmcnt(16)
    s_barrier
    s_add_u32 m0, s70, 65536
    s_nop 0
    buffer_load_dwordx4 v16, s[28:31], s68 offen offset:0 lds
    buffer_load_dwordx4 v17, s[28:31], s68 offen offset:1024 lds
    buffer_load_dwordx4 v18, s[28:31], s68 offen offset:2048 lds
    buffer_load_dwordx4 v19, s[28:31], s68 offen offset:3072 lds
    s_add_u32 m0, s70, 81920
    s_add_u32 s68, s68, 128
    buffer_load_dwordx4 v32, s[32:35], s69 offen offset:0 lds
    buffer_load_dwordx4 v33, s[32:35], s69 offen offset:1024 lds
    buffer_load_dwordx4 v34, s[32:35], s69 offen offset:2048 lds
    buffer_load_dwordx4 v35, s[32:35], s69 offen offset:3072 lds
    s_add_u32 s69, s69, 393216
    s_waitcnt vmcnt(16)
    s_barrier
    s_add_u32 m0, s70, 98304
    s_nop 0
    buffer_load_dwordx4 v16, s[28:31], s68 offen offset:0 lds
    buffer_load_dwordx4 v17, s[28:31], s68 offen offset:1024 lds
    buffer_load_dwordx4 v18, s[28:31], s68 offen offset:2048 lds
    buffer_load_dwordx4 v19, s[28:31], s68 offen offset:3072 lds
    s_add_u32 m0, s70, 114688
    s_add_u32 s68, s68, 128
    buffer_load_dwordx4 v32, s[32:35], s69 offen offset:0 lds
    buffer_load_dwordx4 v33, s[32:35], s69 offen offset:1024 lds
    buffer_load_dwordx4 v34, s[32:35], s69 offen offset:2048 lds
    buffer_load_dwordx4 v35, s[32:35], s69 offen offset:3072 lds
    s_add_u32 s69, s69, 393216
    s_waitcnt vmcnt(16)
    s_barrier
    s_add_u32 m0, s70, 0
    s_nop 0
    buffer_load_dwordx4 v16, s[28:31], s68 offen offset:0 lds
    buffer_load_dwordx4 v17, s[28:31], s68 offen offset:1024 lds
    buffer_load_dwordx4 v18, s[28:31], s68 offen offset:2048 lds
    buffer_load_dwordx4 v19, s[28:31], s68 offen offset:3072 lds
    s_add_u32 m0, s70, 16384
    s_add_u32 s68, s68, 128
    buffer_load_dwordx4 v32, s[32:35], s69 offen offset:0 lds
    buffer_load_dwordx4 v33, s[32:35], s69 offen offset:1024 lds
    buffer_load_dwordx4 v34, s[32:35], s69 offen offset:2048 lds
    buffer_load_dwordx4 v35, s[32:35], s69 offen offset:3072 lds
    s_add_u32 s69, s69, 393216
    s_waitcnt vmcnt(16)
    s_barrier
    s_add_u32 m0, s70, 32768
    s_nop 0
    buffer_load_dwordx4 v16, s[28:31], s68 offen offset:0 lds
    buffer_load_dwordx4 v17, s[28:31], s68 offen offset:1024 lds
    buffer_load_dwordx4 v18, s[28:31], s68 offen offset:2048 lds
    buffer_load_dwordx4 v19, s[28:31], s68 offen offset:3072 lds
    s_add_u32 m0, s70, 49152
    s_add_u32 s68, s68, 128
    buffer_load_dwordx4 v32, s[32:35], s69 offen offset:0 lds
    buffer_load_dwordx4 v33, s[32:35], s69 offen offset:1024 lds
    buffer_load_dwordx4 v34, s[32:35], s69 offen offset:2048 lds
    buffer_load_dwordx4 v35, s[32:35], s69 offen offset:3072 lds
    s_add_u32 s69, s69, 393216
    s_waitcnt vmcnt(16)
    s_barrier
    s_add_u32 m0, s70, 65536
    s_nop 0
    buffer_load_dwordx4 v16, s[28:31], s68 offen offset:0 lds
    buffer_load_dwordx4 v17, s[28:31], s68 offen offset:1024 lds
    buffer_load_dwordx4 v18, s[28:31], s68 offen offset:2048 lds
    buffer_load_dwordx4 v19, s[28:31], s68 offen offset:3072 lds
    s_add_u32 m0, s70, 81920
    s_add_u32 s68, s68, 128
    buffer_load_dwordx4 v32, s[32:35], s69 offen offset:0 lds
    buffer_load_dwordx4 v33, s[32:35], s69 offen offset:1024 lds
    buffer_load_dwordx4 v34, s[32:35], s69 offen offset:2048 lds
    buffer_load_dwordx4 v35, s[32:35], s69 offen offset:3072 lds
    s_add_u32 s69, s69, 393216
    s_waitcnt vmcnt(16)
    s_barrier
    s_add_u32 m0, s70, 98304
    s_nop 0
    buffer_load_dwordx4 v16, s[28:31], s68 offen offset:0 lds
    buffer_load_dwordx4 v17, s[28:31], s68 offen offset:1024 lds
    buffer_load_dwordx4 v18, s[28:31], s68 offen offset:2048 lds
    buffer_load_dwordx4 v19, s[28:31], s68 offen offset:3072 lds
    s_add_u32 m0, s70, 114688
    s_add_u32 s68, s68, 128
    buffer_load_dwordx4 v32, s[32:35], s69 offen offset:0 lds
    buffer_load_dwordx4 v33, s[32:35], s69 offen offset:1024 lds
    buffer_load_dwordx4 v34, s[32:35], s69 offen offset:2048 lds
    buffer_load_dwordx4 v35, s[32:35], s69 offen offset:3072 lds
    s_add_u32 s69, s69, 393216
    s_waitcnt vmcnt(16)
    s_barrier
    s_add_u32 m0, s70, 0
    s_nop 0
    buffer_load_dwordx4 v16, s[28:31], s68 offen offset:0 lds
    buffer_load_dwordx4 v17, s[28:31], s68 offen offset:1024 lds
    buffer_load_dwordx4 v18, s[28:31], s68 offen offset:2048 lds
    buffer_load_dwordx4 v19, s[28:31], s68 offen offset:3072 lds
    s_add_u32 m0, s70, 16384
    s_add_u32 s68, s68, 128
    buffer_load_dwordx4 v32, s[32:35], s69 offen offset:0 lds
    buffer_load_dwordx4 v33, s[32:35], s69 offen offset:1024 lds
    buffer_load_dwordx4 v34, s[32:35], s69 offen offset:2048 lds
    buffer_load_dwordx4 v35, s[32:35], s69 offen offset:3072 lds
    s_add_u32 s69, s69, 393216
    s_waitcnt vmcnt(16)
    s_barrier
    s_add_u32 m0, s70, 32768
    s_nop 0
    buffer_load_dwordx4 v16, s[28:31], s68 offen offset:0 lds
    buffer_load_dwordx4 v17, s[28:31], s68 offen offset:1024 lds
    buffer_load_dwordx4 v18, s[28:31], s68 offen offset:2048 lds
    buffer_load_dwordx4 v19, s[28:31], s68 offen offset:3072 lds
    s_add_u32 m0, s70, 49152
    s_add_u32 s68, s68, 128
    buffer_load_dwordx4 v32, s[32:35], s69 offen offset:0 lds
    buffer_load_dwordx4 v33, s[32:35], s69 offen offset:1024 lds
    buffer_load_dwordx4 v34, s[32:35], s69 offen offset:2048 lds
    buffer_load_dwordx4 v35, s[32:35], s69 offen offset:3072 lds
    s_add_u32 s69, s69, 393216
    s_waitcnt vmcnt(16)
    s_barrier
    s_add_u32 m0, s70, 65536
    s_nop 0
    buffer_load_dwordx4 v16, s[28:31], s68 offen offset:0 lds
    buffer_load_dwordx4 v17, s[28:31], s68 offen offset:1024 lds
    buffer_load_dwordx4 v18, s[28:31], s68 offen offset:2048 lds
    buffer_load_dwordx4 v19, s[28:31], s68 offen offset:3072 lds
    s_add_u32 m0, s70, 81920
    s_add_u32 s68, s68, 128
    buffer_load_dwordx4 v32, s[32:35], s69 offen offset:0 lds
    buffer_load_dwordx4 v33, s[32:35], s69 offen offset:1024 lds
    buffer_load_dwordx4 v34, s[32:35], s69 offen offset:2048 lds
    buffer_load_dwordx4 v35, s[32:35], s69 offen offset:3072 lds
    s_add_u32 s69, s69, 393216
    s_waitcnt vmcnt(16)
    s_barrier
    s_add_u32 m0, s70, 98304
    s_nop 0
    buffer_load_dwordx4 v16, s[28:31], s68 offen offset:0 lds
    buffer_load_dwordx4 v17, s[28:31], s68 offen offset:1024 lds
    buffer_load_dwordx4 v18, s[28:31], s68 offen offset:2048 lds
    buffer_load_dwordx4 v19, s[28:31], s68 offen offset:3072 lds
    s_add_u32 m0, s70, 114688
    s_add_u32 s68, s68, 128
    buffer_load_dwordx4 v32, s[32:35], s69 offen offset:0 lds
    buffer_load_dwordx4 v33, s[32:35], s69 offen offset:1024 lds
    buffer_load_dwordx4 v34, s[32:35], s69 offen offset:2048 lds
    buffer_load_dwordx4 v35, s[32:35], s69 offen offset:3072 lds
    s_add_u32 s69, s69, 393216
    s_waitcnt vmcnt(16)
    s_barrier
    s_waitcnt vmcnt(8)
    s_barrier
    s_mov_b32 s32, s16
    s_mov_b32 s33, s17
    s_mov_b32 s34, 0x700000
    s_mov_b32 s35, 0x20000
    s_cmp_ge_u32 s80, 24
    s_cselect_b32 s34, 0, s34
    s_mov_b32 s69, 0
    s_add_u32 m0, s84, 16384
    s_nop 0
    buffer_load_dwordx4 v20, s[32:35], s69 offen offset:0 lds
    buffer_load_dwordx4 v21, s[32:35], s69 offen offset:1024 lds
    buffer_load_dwordx4 v22, s[32:35], s69 offen offset:2048 lds
    buffer_load_dwordx4 v23, s[32:35], s69 offen offset:3072 lds
    s_add_u32 m0, s84, 20480
    s_nop 0
    buffer_load_dwordx4 v24, s[32:35], s69 offen offset:0 lds
    buffer_load_dwordx4 v25, s[32:35], s69 offen offset:1024 lds
    buffer_load_dwordx4 v26, s[32:35], s69 offen offset:2048 lds
    buffer_load_dwordx4 v27, s[32:35], s69 offen offset:3072 lds
    s_add_u32 s69, s69, 458752
    s_waitcnt vmcnt(8)
    s_barrier
    s_add_u32 m0, s84, 65536
    s_nop 0
    buffer_load_dwordx4 v20, s[32:35], s69 offen offset:0 lds
    buffer_load_dwordx4 v21, s[32:35], s69 offen offset:1024 lds
    buffer_load_dwordx4 v22, s[32:35], s69 offen offset:2048 lds
    buffer_load_dwordx4 v23, s[32:35], s69 offen offset:3072 lds
    s_add_u32 m0, s84, 69632
    s_nop 0
    buffer_load_dwordx4 v24, s[32:35], s69 offen offset:0 lds
    buffer_load_dwordx4 v25, s[32:35], s69 offen offset:1024 lds
    buffer_load_dwordx4 v26, s[32:35], s69 offen offset:2048 lds
    buffer_load_dwordx4 v27, s[32:35], s69 offen offset:3072 lds
    s_add_u32 s69, s69, 458752
    s_barrier
    s_cmp_lt_u32 s80, 24
    s_cbranch_scc1 L_A_loader3
    s_waitcnt vmcnt(0)
    s_barrier
    s_barrier
    s_branch L_owg
L_A_loader3:
    s_lshl_b32 s78, s76, 3
    s_add_u32 s78, s78, s63
    s_lshl_b32 s62, s78, 8
    s_add_u32 s28, s26, 0x800000
    s_addc_u32 s29, s27, 0
    s_mov_b32 s30, 0x400000
    s_mov_b32 s31, 0x20000
    s_mov_b32 s32, s16
    s_mov_b32 s33, s17
    s_mov_b32 s34, 0x700000
    s_mov_b32 s35, 0x20000
    s_add_u32 s36, s26, 0x1000000
    s_addc_u32 s37, s27, 0
    s_mov_b32 s38, 0xe00000
    s_mov_b32 s39, 0x20000
    s_mov_b32 s64, 7168
    s_mov_b32 s65, 32
    s_mov_b32 s66, 64
    s_mov_b32 s68, 0
    v_mov_b32 v4, 149504
    s_cmp_lg_u32 s75, 0
    s_cbranch_scc1 L_lgo_100
    s_add_u32 s48, s26, 0x2700000
    s_addc_u32 s49, s27, 0
    s_mov_b32 s50, 0x8000
    s_mov_b32 s51, 0x20000
    v_mov_b32 v2, 20480
    v_mov_b32 v125, 0
    s_lshl_b32 s71, s77, 7
    s_add_u32 s71, s71, 0
    v_writelane_b32 v2, s71, 0
    s_mov_b32 s71, 8
    v_writelane_b32 v125, s71, 0
    s_mov_b32 s71, 20864
    v_writelane_b32 v2, s71, 1
    s_mov_b32 s71, 128
    v_writelane_b32 v125, s71, 1
    s_mov_b32 s72, 0x40000
L_poll_103:
    buffer_load_dword v3, v2, s[48:51], 0 offen sc1
    s_waitcnt vmcnt(0)
    v_cmp_lt_u32 vcc, v3, v125
    s_sub_u32 s72, s72, 1
    s_cmp_eq_u32 s72, 0
    s_cbranch_scc1 L_polld_104
    s_cmp_eq_u64 vcc, 0
    s_cbranch_scc1 L_polld_104
    s_sleep 4
    s_branch L_poll_103
L_polld_104:
    v_mov_b32 v3, 2
    ds_write_b32 v4, v3
    s_waitcnt lgkmcnt(0)
    s_branch L_lgd_101
L_lgo_100:
    s_mov_b32 s72, 0x400000
L_lgp_102:
    s_sleep 1
    ds_read_b32 v3, v4
    s_waitcnt lgkmcnt(0)
    v_readfirstlane_b32 s71, v3
    s_sub_u32 s72, s72, 1
    s_cmp_eq_u32 s72, 0
    s_cbranch_scc1 L_lgd_101
    s_cmp_lg_u32 s71, 2
    s_cbranch_scc1 L_lgp_102
L_lgd_101:
    s_add_u32 m0, s70, 0
    s_nop 0
    buffer_load_dwordx4 v16, s[28:31], s68 offen offset:0 sc1 lds
    buffer_load_dwordx4 v17, s[28:31], s68 offen offset:1024 sc1 lds
    buffer_load_dwordx4 v18, s[28:31], s68 offen offset:2048 sc1 lds
    buffer_load_dwordx4 v19, s[28:31], s68 offen offset:3072 sc1 lds
    s_add_u32 s68, s68, 128
    s_add_u32 m0, s70, 49152
    s_nop 0
    buffer_load_dwordx4 v16, s[28:31], s68 offen offset:0 sc1 lds
    buffer_load_dwordx4 v17, s[28:31], s68 offen offset:1024 sc1 lds
    buffer_load_dwordx4 v18, s[28:31], s68 offen offset:2048 sc1 lds
    buffer_load_dwordx4 v19, s[28:31], s68 offen offset:3072 sc1 lds
    s_add_u32 s68, s68, 128
    s_waitcnt vmcnt(4)
    s_barrier
    s_add_u32 m0, s70, 98304
    s_nop 0
    buffer_load_dwordx4 v16, s[28:31], s68 offen offset:0 sc1 lds
    buffer_load_dwordx4 v17, s[28:31], s68 offen offset:1024 sc1 lds
    buffer_load_dwordx4 v18, s[28:31], s68 offen offset:2048 sc1 lds
    buffer_load_dwordx4 v19, s[28:31], s68 offen offset:3072 sc1 lds
    s_add_u32 m0, s84, 114688
    s_add_u32 s68, s68, 128
    buffer_load_dwordx4 v20, s[32:35], s69 offen offset:0 lds
    buffer_load_dwordx4 v21, s[32:35], s69 offen offset:1024 lds
    buffer_load_dwordx4 v22, s[32:35], s69 offen offset:2048 lds
    buffer_load_dwordx4 v23, s[32:35], s69 offen offset:3072 lds
    s_add_u32 m0, s84, 118784
    s_nop 0
    buffer_load_dwordx4 v24, s[32:35], s69 offen offset:0 lds
    buffer_load_dwordx4 v25, s[32:35], s69 offen offset:1024 lds
    buffer_load_dwordx4 v26, s[32:35], s69 offen offset:2048 lds
    buffer_load_dwordx4 v27, s[32:35], s69 offen offset:3072 lds
    s_add_u32 s69, s69, 458752
    s_waitcnt vmcnt(12)
    s_barrier
    s_add_u32 m0, s70, 0
    s_nop 0
    buffer_load_dwordx4 v16, s[28:31], s68 offen offset:0 sc1 lds
    buffer_load_dwordx4 v17, s[28:31], s68 offen offset:1024 sc1 lds
    buffer_load_dwordx4 v18, s[28:31], s68 offen offset:2048 sc1 lds
    buffer_load_dwordx4 v19, s[28:31], s68 offen offset:3072 sc1 lds
    s_add_u32 m0, s84, 16384
    s_add_u32 s68, s68, 128
    buffer_load_dwordx4 v20, s[32:35], s69 offen offset:0 lds
    buffer_load_dwordx4 v21, s[32:35], s69 offen offset:1024 lds
    buffer_load_dwordx4 v22, s[32:35], s69 offen offset:2048 lds
    buffer_load_dwordx4 v23, s[32:35], s69 offen offset:3072 lds
    s_add_u32 m0, s84, 20480
    s_nop 0
    buffer_load_dwordx4 v24, s[32:35], s69 offen offset:0 lds
    buffer_load_dwordx4 v25, s[32:35], s69 offen offset:1024 lds
    buffer_load_dwordx4 v26, s[32:35], s69 offen offset:2048 lds
    buffer_load_dwordx4 v27, s[32:35], s69 offen offset:3072 lds
    s_add_u32 s69, s69, 458752
    s_waitcnt vmcnt(12)
    s_barrier
    s_add_u32 m0, s70, 49152
    s_nop 0
    buffer_load_dwordx4 v16, s[28:31], s68 offen offset:0 sc1 lds
    buffer_load_dwordx4 v17, s[28:31], s68 offen offset:1024 sc1 lds
    buffer_load_dwordx4 v18, s[28:31], s68 offen offset:2048 sc1 lds
    buffer_load_dwordx4 v19, s[28:31], s68 offen offset:3072 sc1 lds
    s_add_u32 m0, s84, 65536
    s_add_u32 s68, s68, 128
    buffer_load_dwordx4 v20, s[32:35], s69 offen offset:0 lds
    buffer_load_dwordx4 v21, s[32:35], s69 offen offset:1024 lds
    buffer_load_dwordx4 v22, s[32:35], s69 offen offset:2048 lds
    buffer_load_dwordx4 v23, s[32:35], s69 offen offset:3072 lds
    s_add_u32 m0, s84, 69632
    s_nop 0
    buffer_load_dwordx4 v24, s[32:35], s69 offen offset:0 lds
    buffer_load_dwordx4 v25, s[32:35], s69 offen offset:1024 lds
    buffer_load_dwordx4 v26, s[32:35], s69 offen offset:2048 lds
    buffer_load_dwordx4 v27, s[32:35], s69 offen offset:3072 lds
    s_add_u32 s69, s69, 458752
    s_waitcnt vmcnt(12)
    s_barrier
    s_add_u32 m0, s70, 98304
    s_nop 0
    buffer_load_dwordx4 v16, s[28:31], s68 offen offset:0 sc1 lds
    buffer_load_dwordx4 v17, s[28:31], s68 offen offset:1024 sc1 lds
    buffer_load_dwordx4 v18, s[28:31], s68 offen offset:2048 sc1 lds
    buffer_load_dwordx4 v19, s[28:31], s68 offen offset:3072 sc1 lds
    s_add_u32 m0, s84, 114688
    s_add_u32 s68, s68, 128
    buffer_load_dwordx4 v20, s[32:35], s69 offen offset:0 lds
    buffer_load_dwordx4 v21, s[32:35], s69 offen offset:1024 lds
    buffer_load_dwordx4 v22, s[32:35], s69 offen offset:2048 lds
    buffer_load_dwordx4 v23, s[32:35], s69 offen offset:3072 lds
    s_add_u32 m0, s84, 118784
    s_nop 0
    buffer_load_dwordx4 v24, s[32:35], s69 offen offset:0 lds
    buffer_load_dwordx4 v25, s[32:35], s69 offen offset:1024 lds
    buffer_load_dwordx4 v26, s[32:35], s69 offen offset:2048 lds
    buffer_load_dwordx4 v27, s[32:35], s69 offen offset:3072 lds
    s_add_u32 s69, s69, 458752
    s_waitcnt vmcnt(12)
    s_barrier
    s_add_u32 m0, s70, 0
    s_nop 0
    buffer_load_dwordx4 v16, s[28:31], s68 offen offset:0 sc1 lds
    buffer_load_dwordx4 v17, s[28:31], s68 offen offset:1024 sc1 lds
    buffer_load_dwordx4 v18, s[28:31], s68 offen offset:2048 sc1 lds
    buffer_load_dwordx4 v19, s[28:31], s68 offen offset:3072 sc1 lds
    s_add_u32 m0, s84, 16384
    s_add_u32 s68, s68, 128
    buffer_load_dwordx4 v20, s[32:35], s69 offen offset:0 lds
    buffer_load_dwordx4 v21, s[32:35], s69 offen offset:1024 lds
    buffer_load_dwordx4 v22, s[32:35], s69 offen offset:2048 lds
    buffer_load_dwordx4 v23, s[32:35], s69 offen offset:3072 lds
    s_add_u32 m0, s84, 20480
    s_nop 0
    buffer_load_dwordx4 v24, s[32:35], s69 offen offset:0 lds
    buffer_load_dwordx4 v25, s[32:35], s69 offen offset:1024 lds
    buffer_load_dwordx4 v26, s[32:35], s69 offen offset:2048 lds
    buffer_load_dwordx4 v27, s[32:35], s69 offen offset:3072 lds
    s_add_u32 s69, s69, 458752
    s_waitcnt vmcnt(12)
    s_barrier
    s_add_u32 m0, s70, 49152
    s_nop 0
    buffer_load_dwordx4 v16, s[28:31], s68 offen offset:0 sc1 lds
    buffer_load_dwordx4 v17, s[28:31], s68 offen offset:1024 sc1 lds
    buffer_load_dwordx4 v18, s[28:31], s68 offen offset:2048 sc1 lds
    buffer_load_dwordx4 v19, s[28:31], s68 offen offset:3072 sc1 lds
    s_add_u32 m0, s84, 65536
    s_add_u32 s68, s68, 128
    buffer_load_dwordx4 v20, s[32:35], s69 offen offset:0 lds
    buffer_load_dwordx4 v21, s[32:35], s69 offen offset:1024 lds
    buffer_load_dwordx4 v22, s[32:35], s69 offen offset:2048 lds
    buffer_load_dwordx4 v23, s[32:35], s69 offen offset:3072 lds
    s_add_u32 m0, s84, 69632
    s_nop 0
    buffer_load_dwordx4 v24, s[32:35], s69 offen offset:0 lds
    buffer_load_dwordx4 v25, s[32:35], s69 offen offset:1024 lds
    buffer_load_dwordx4 v26, s[32:35], s69 offen offset:2048 lds
    buffer_load_dwordx4 v27, s[32:35], s69 offen offset:3072 lds
    s_add_u32 s69, s69, 458752
    s_waitcnt vmcnt(12)
    s_barrier
    s_add_u32 m0, s70, 98304
    s_nop 0
    buffer_load_dwordx4 v16, s[28:31], s68 offen offset:0 sc1 lds
    buffer_load_dwordx4 v17, s[28:31], s68 offen offset:1024 sc1 lds
    buffer_load_dwordx4 v18, s[28:31], s68 offen offset:2048 sc1 lds
    buffer_load_dwordx4 v19, s[28:31], s68 offen offset:3072 sc1 lds
    s_add_u32 m0, s84, 114688
    s_add_u32 s68, s68, 128
    buffer_load_dwordx4 v20, s[32:35], s69 offen offset:0 lds
    buffer_load_dwordx4 v21, s[32:35], s69 offen offset:1024 lds
    buffer_load_dwordx4 v22, s[32:35], s69 offen offset:2048 lds
    buffer_load_dwordx4 v23, s[32:35], s69 offen offset:3072 lds
    s_add_u32 m0, s84, 118784
    s_nop 0
    buffer_load_dwordx4 v24, s[32:35], s69 offen offset:0 lds
    buffer_load_dwordx4 v25, s[32:35], s69 offen offset:1024 lds
    buffer_load_dwordx4 v26, s[32:35], s69 offen offset:2048 lds
    buffer_load_dwordx4 v27, s[32:35], s69 offen offset:3072 lds
    s_add_u32 s69, s69, 458752
    s_add_u32 s56, s26, 0x3000000
    s_addc_u32 s57, s27, 0
    s_mov_b32 s58, 0x1000000
    s_mov_b32 s59, 0x20000
    s_cmp_eq_u32 s76, 0
    s_mov_b32 s73, 0x51743260
    s_cselect_b32 s73, 0x76543210, s73
    s_lshl_b32 s71, s63, 2
    s_lshr_b32 s73, s73, s71
    s_and_b32 s73, s73, 7
    s_lshl_b32 s71, s77, 3
    s_add_u32 s71, s71, s73
    s_lshl_b32 s71, s71, 1
    s_add_u32 s71, s71, s76
    s_lshl_b32 s71, s71, 2
    s_add_u32 s71, s71, s75
    s_lshl_b32 s71, s71, 14
    v_lshlrev_b32 v220, 4, v1
    v_mov_b32 v216, -1
    v_mov_b32 v217, -1
    v_mov_b32 v218, -1
    v_mov_b32 v219, -1
    v_add_u32 v220, s71, v220
    s_mov_b32 s71, 0
    buffer_store_dwordx4 v[216:219], v220, s[56:59], s71 offen offset:0 sc1
    s_mov_b32 s71, 0
    buffer_store_dwordx4 v[216:219], v220, s[56:59], s71 offen offset:1024 sc1
    s_mov_b32 s71, 0
    buffer_store_dwordx4 v[216:219], v220, s[56:59], s71 offen offset:2048 sc1
    s_mov_b32 s71, 0
    buffer_store_dwordx4 v[216:219], v220, s[56:59], s71 offen offset:3072 sc1
    s_nop 1
    s_waitcnt vmcnt(16)
    s_barrier
    s_add_u32 m0, s70, 0
    s_nop 0
    buffer_load_dwordx4 v16, s[28:31], s68 offen offset:0 sc1 lds
    buffer_load_dwordx4 v17, s[28:31], s68 offen offset:1024 sc1 lds
    buffer_load_dwordx4 v18, s[28:31], s68 offen offset:2048 sc1 lds
    buffer_load_dwordx4 v19, s[28:31], s68 offen offset:3072 sc1 lds
    s_add_u32 m0, s84, 16384
    s_add_u32 s68, s68, 128
    buffer_load_dwordx4 v20, s[32:35], s69 offen offset:0 lds
    buffer_load_dwordx4 v21, s[32:35], s69 offen offset:1024 lds
    buffer_load_dwordx4 v22, s[32:35], s69 offen offset:2048 lds
    buffer_load_dwordx4 v23, s[32:35], s69 offen offset:3072 lds
    s_add_u32 m0, s84, 20480
    s_nop 0
    buffer_load_dwordx4 v24, s[32:35], s69 offen offset:0 lds
    buffer_load_dwordx4 v25, s[32:35], s69 offen offset:1024 lds
    buffer_load_dwordx4 v26, s[32:35], s69 offen offset:2048 lds
    buffer_load_dwordx4 v27, s[32:35], s69 offen offset:3072 lds
    s_add_u32 s69, s69, 458752
    s_waitcnt vmcnt(16)
    s_barrier
    s_add_u32 m0, s70, 49152
    s_nop 0
    buffer_load_dwordx4 v16, s[28:31], s68 offen offset:0 sc1 lds
    buffer_load_dwordx4 v17, s[28:31], s68 offen offset:1024 sc1 lds
    buffer_load_dwordx4 v18, s[28:31], s68 offen offset:2048 sc1 lds
    buffer_load_dwordx4 v19, s[28:31], s68 offen offset:3072 sc1 lds
    s_add_u32 m0, s84, 65536
    s_add_u32 s68, s68, 128
    buffer_load_dwordx4 v20, s[32:35], s69 offen offset:0 lds
    buffer_load_dwordx4 v21, s[32:35], s69 offen offset:1024 lds
    buffer_load_dwordx4 v22, s[32:35], s69 offen offset:2048 lds
    buffer_load_dwordx4 v23, s[32:35], s69 offen offset:3072 lds
    s_add_u32 m0, s84, 69632
    s_nop 0
    buffer_load_dwordx4 v24, s[32:35], s69 offen offset:0 lds
    buffer_load_dwordx4 v25, s[32:35], s69 offen offset:1024 lds
    buffer_load_dwordx4 v26, s[32:35], s69 offen offset:2048 lds
    buffer_load_dwordx4 v27, s[32:35], s69 offen offset:3072 lds
    s_add_u32 s69, s69, 458752
    s_waitcnt vmcnt(12)
    s_barrier
    s_add_u32 m0, s70, 98304
    s_nop 0
    buffer_load_dwordx4 v16, s[28:31], s68 offen offset:0 sc1 lds
    buffer_load_dwordx4 v17, s[28:31], s68 offen offset:1024 sc1 lds
    buffer_load_dwordx4 v18, s[28:31], s68 offen offset:2048 sc1 lds
    buffer_load_dwordx4 v19, s[28:31], s68 offen offset:3072 sc1 lds
    s_add_u32 m0, s84, 114688
    s_add_u32 s68, s68, 128
    buffer_load_dwordx4 v20, s[32:35], s69 offen offset:0 lds
    buffer_load_dwordx4 v21, s[32:35], s69 offen offset:1024 lds
    buffer_load_dwordx4 v22, s[32:35], s69 offen offset:2048 lds
    buffer_load_dwordx4 v23, s[32:35], s69 offen offset:3072 lds
    s_add_u32 m0, s84, 118784
    s_nop 0
    buffer_load_dwordx4 v24, s[32:35], s69 offen offset:0 lds
    buffer_load_dwordx4 v25, s[32:35], s69 offen offset:1024 lds
    buffer_load_dwordx4 v26, s[32:35], s69 offen offset:2048 lds
    buffer_load_dwordx4 v27, s[32:35], s69 offen offset:3072 lds
    s_add_u32 s69, s69, 458752
    s_waitcnt vmcnt(12)
    s_barrier
    s_add_u32 m0, s70, 0
    s_nop 0
    buffer_load_dwordx4 v16, s[28:31], s68 offen offset:0 sc1 lds
    buffer_load_dwordx4 v17, s[28:31], s68 offen offset:1024 sc1 lds
    buffer_load_dwordx4 v18, s[28:31], s68 offen offset:2048 sc1 lds
    buffer_load_dwordx4 v19, s[28:31], s68 offen offset:3072 sc1 lds
    s_add_u32 m0, s84, 16384
    s_add_u32 s68, s68, 128
    buffer_load_dwordx4 v20, s[32:35], s69 offen offset:0 lds
    buffer_load_dwordx4 v21, s[32:35], s69 offen offset:1024 lds
    buffer_load_dwordx4 v22, s[32:35], s69 offen offset:2048 lds
    buffer_load_dwordx4 v23, s[32:35], s69 offen offset:3072 lds
    s_add_u32 m0, s84, 20480
    s_nop 0
    buffer_load_dwordx4 v24, s[32:35], s69 offen offset:0 lds
    buffer_load_dwordx4 v25, s[32:35], s69 offen offset:1024 lds
    buffer_load_dwordx4 v26, s[32:35], s69 offen offset:2048 lds
    buffer_load_dwordx4 v27, s[32:35], s69 offen offset:3072 lds
    s_add_u32 s69, s69, 458752
    s_waitcnt vmcnt(12)
    s_barrier
    s_add_u32 m0, s70, 49152
    s_nop 0
    buffer_load_dwordx4 v16, s[28:31], s68 offen offset:0 sc1 lds
    buffer_load_dwordx4 v17, s[28:31], s68 offen offset:1024 sc1 lds
    buffer_load_dwordx4 v18, s[28:31], s68 offen offset:2048 sc1 lds
    buffer_load_dwordx4 v19, s[28:31], s68 offen offset:3072 sc1 lds
    s_add_u32 m0, s84, 65536
    s_add_u32 s68, s68, 128
    buffer_load_dwordx4 v20, s[32:35], s69 offen offset:0 lds
    buffer_load_dwordx4 v21, s[32:35], s69 offen offset:1024 lds
    buffer_load_dwordx4 v22, s[32:35], s69 offen offset:2048 lds
    buffer_load_dwordx4 v23, s[32:35], s69 offen offset:3072 lds
    s_add_u32 m0, s84, 69632
    s_nop 0
    buffer_load_dwordx4 v24, s[32:35], s69 offen offset:0 lds
    buffer_load_dwordx4 v25, s[32:35], s69 offen offset:1024 lds
    buffer_load_dwordx4 v26, s[32:35], s69 offen offset:2048 lds
    buffer_load_dwordx4 v27, s[32:35], s69 offen offset:3072 lds
    s_add_u32 s69, s69, 458752
    s_cmp_lg_u32 s75, 0
    s_cbranch_scc1 L_cnd_105
    s_cmp_eq_u32 s76, 0
    s_mov_b32 s73, 0x51743260
    s_cselect_b32 s73, 0x76543210, s73
    s_lshl_b32 s71, s63, 2
    s_lshr_b32 s73, s73, s71
    s_and_b32 s73, s73, 7
    s_lshl_b32 s72, s77, 3
    s_add_u32 s73, s73, s72
    s_lshl_b32 s73, s73, 1
    s_add_u32 s73, s73, s76
    s_xor_b32 s73, s73, 1
    s_lshl_b32 s73, s73, 5
    s_add_u32 s48, s26, 0x2700000
    s_addc_u32 s49, s27, 0
    s_mov_b32 s50, 0x8000
    s_mov_b32 s51, 0x20000
    s_add_u32 s71, s73, 24576
    v_mov_b32 v2, s71
    v_mov_b32 v3, 1
    s_mov_b64 exec, 1
    buffer_atomic_add v3, v2, s[48:51], 0 offen sc1
    s_mov_b64 exec, -1
L_cnd_105:
    s_waitcnt vmcnt(12)
    s_barrier
    s_add_u32 m0, s70, 98304
    s_nop 0
    buffer_load_dwordx4 v16, s[28:31], s68 offen offset:0 sc1 lds
    buffer_load_dwordx4 v17, s[28:31], s68 offen offset:1024 sc1 lds
    buffer_load_dwordx4 v18, s[28:31], s68 offen offset:2048 sc1 lds
    buffer_load_dwordx4 v19, s[28:31], s68 offen offset:3072 sc1 lds
    s_add_u32 m0, s84, 114688
    s_add_u32 s68, s68, 128
    buffer_load_dwordx4 v20, s[32:35], s69 offen offset:0 lds
    buffer_load_dwordx4 v21, s[32:35], s69 offen offset:1024 lds
    buffer_load_dwordx4 v22, s[32:35], s69 offen offset:2048 lds
    buffer_load_dwordx4 v23, s[32:35], s69 offen offset:3072 lds
    s_add_u32 m0, s84, 118784
    s_nop 0
    buffer_load_dwordx4 v24, s[32:35], s69 offen offset:0 lds
    buffer_load_dwordx4 v25, s[32:35], s69 offen offset:1024 lds
    buffer_load_dwordx4 v26, s[32:35], s69 offen offset:2048 lds
    buffer_load_dwordx4 v27, s[32:35], s69 offen offset:3072 lds
    s_add_u32 s69, s69, 458752
    s_waitcnt vmcnt(12)
    s_barrier
    s_add_u32 m0, s70, 0
    s_nop 0
    buffer_load_dwordx4 v16, s[28:31], s68 offen offset:0 sc1 lds
    buffer_load_dwordx4 v17, s[28:31], s68 offen offset:1024 sc1 lds
    buffer_load_dwordx4 v18, s[28:31], s68 offen offset:2048 sc1 lds
    buffer_load_dwordx4 v19, s[28:31], s68 offen offset:3072 sc1 lds
    s_add_u32 m0, s84, 16384
    s_add_u32 s68, s68, 128
    buffer_load_dwordx4 v20, s[32:35], s69 offen offset:0 lds
    buffer_load_dwordx4 v21, s[32:35], s69 offen offset:1024 lds
    buffer_load_dwordx4 v22, s[32:35], s69 offen offset:2048 lds
    buffer_load_dwordx4 v23, s[32:35], s69 offen offset:3072 lds
    s_add_u32 m0, s84, 20480
    s_nop 0
    buffer_load_dwordx4 v24, s[32:35], s69 offen offset:0 lds
    buffer_load_dwordx4 v25, s[32:35], s69 offen offset:1024 lds
    buffer_load_dwordx4 v26, s[32:35], s69 offen offset:2048 lds
    buffer_load_dwordx4 v27, s[32:35], s69 offen offset:3072 lds
    s_add_u32 s69, s69, 458752
    s_waitcnt vmcnt(12)
    s_barrier
    s_add_u32 s40, s26, 0x2500000
    s_addc_u32 s41, s27, 0
    s_mov_b32 s42, 0x40000
    s_mov_b32 s43, 0x20000
    s_add_u32 s52, s26, 0x2600000
    s_addc_u32 s53, s27, 0
    s_mov_b32 s54, 0x38000
    s_mov_b32 s55, 0x20000
    v_and_b32 v2, 31, v1
    s_lshl_b32 s71, s75, 8
    s_lshl_b32 s72, s77, 14
    s_add_u32 s71, s71, s72
    v_lshlrev_b32 v2, 3, v2
    v_add_u32 v2, s71, v2
    v_lshrrev_b32 v3, 5, v1
    v_lshl_add_u32 v2, v3, 13, v2
    v_add_u32 v4, 4096, v2
    buffer_load_dwordx2 v[64:65], v2, s[40:43], 0 offen offset:0 sc1
    buffer_load_dwordx2 v[66:67], v2, s[40:43], 0 offen offset:1024 sc1
    buffer_load_dwordx2 v[68:69], v2, s[40:43], 0 offen offset:2048 sc1
    buffer_load_dwordx2 v[70:71], v2, s[40:43], 0 offen offset:3072 sc1
    buffer_load_dwordx2 v[72:73], v4, s[40:43], 0 offen offset:0 sc1
    buffer_load_dwordx2 v[74:75], v4, s[40:43], 0 offen offset:1024 sc1
    buffer_load_dwordx2 v[76:77], v4, s[40:43], 0 offen offset:2048 sc1
    buffer_load_dwordx2 v[78:79], v4, s[40:43], 0 offen offset:3072 sc1
    s_lshl_b32 s71, s75, 6
    s_add_u32 s71, s71, s62
    v_add_u32 v3, s71, v1
    v_lshlrev_b32 v3, 2, v3
    s_mov_b32 s72, 0
    buffer_load_dword v96, v3, s[52:55], s72 offen sc1
    s_mov_b32 s72, 14336
    buffer_load_dword v97, v3, s[52:55], s72 offen sc1
    s_mov_b32 s72, 28672
    buffer_load_dword v98, v3, s[52:55], s72 offen sc1
    s_mov_b32 s72, 43008
    buffer_load_dword v99, v3, s[52:55], s72 offen sc1
    s_mov_b32 s72, 57344
    buffer_load_dword v100, v3, s[52:55], s72 offen sc1
    s_mov_b32 s72, 71680
    buffer_load_dword v101, v3, s[52:55], s72 offen sc1
    s_mov_b32 s72, 86016
    buffer_load_dword v102, v3, s[52:55], s72 offen sc1
    s_mov_b32 s72, 100352
    buffer_load_dword v103, v3, s[52:55], s72 offen sc1
    s_mov_b32 s72, 114688
    buffer_load_dword v104, v3, s[52:55], s72 offen sc1
    s_mov_b32 s72, 129024
    buffer_load_dword v105, v3, s[52:55], s72 offen sc1
    s_mov_b32 s72, 143360
    buffer_load_dword v106, v3, s[52:55], s72 offen sc1
    s_mov_b32 s72, 157696
    buffer_load_dword v107, v3, s[52:55], s72 offen sc1
    s_mov_b32 s72, 172032
    buffer_load_dword v108, v3, s[52:55], s72 offen sc1
    s_mov_b32 s72, 186368
    buffer_load_dword v109, v3, s[52:55], s72 offen sc1
    s_mov_b32 s72, 200704
    buffer_load_dword v110, v3, s[52:55], s72 offen sc1
    s_mov_b32 s72, 215040
    buffer_load_dword v111, v3, s[52:55], s72 offen sc1
    s_add_u32 s40, s26, 0x2300000
    s_addc_u32 s41, s27, 0
    s_mov_b32 s42, 0x2000
    s_mov_b32 s43, 0x20000
    v_and_b32 v2, 31, v1
    s_lshl_b32 s71, s75, 5
    v_add_u32 v2, s71, v2
    v_lshlrev_b32 v113, 2, v2
    v_add_u32 v2, s61, v2
    v_lshlrev_b32 v2, 2, v2
    buffer_load_dword v112, v2, s[40:43], 0 offen sc1
    s_mov_b32 s56, s18
    s_mov_b32 s57, s19
    s_mov_b32 s58, 0x700000
    s_mov_b32 s59, 0x20000
    s_and_b32 s71, s79, 3
    s_cmp_eq_u32 s76, 0
    s_cselect_b32 s72, 32, 24
    s_mul_i32 s71, s71, s72
    s_add_u32 s71, s71, s80
    s_lshl_b32 s72, s76, 7
    s_add_u32 s71, s71, s72
    s_lshl_b32 s71, s71, 2
    s_add_u32 s71, s71, s75
    s_lshl_b32 s71, s71, 13
    v_lshlrev_b32 v126, 7, v1
    buffer_load_dword v127, v126, s[56:59], s71 offen
    s_waitcnt vmcnt(26)
    s_barrier
    s_waitcnt vmcnt(1)
    v_sub_f32 v112, 1.0, v112
    v_cvt_pk_bf16_f32 v112, v112, v112
    v_lshlrev_b32 v112, 16, v112
    v_add_u32 v113, 149568, v113
    ds_write_b32 v113, v112
    v_pk_add_f32 v[64:65], v[64:65], v[66:67]
    v_pk_add_f32 v[64:65], v[64:65], v[68:69]
    v_pk_add_f32 v[64:65], v[64:65], v[70:71]
    v_pk_add_f32 v[64:65], v[64:65], v[72:73]
    v_pk_add_f32 v[64:65], v[64:65], v[74:75]
    v_pk_add_f32 v[64:65], v[64:65], v[76:77]
    v_pk_add_f32 v[64:65], v[64:65], v[78:79]
    v_add_f32 v96, v96, v97
    v_add_f32 v96, v96, v98
    v_add_f32 v96, v96, v99
    v_add_f32 v96, v96, v100
    v_add_f32 v96, v96, v101
    v_add_f32 v96, v96, v102
    v_add_f32 v96, v96, v103
    v_add_f32 v96, v96, v104
    v_add_f32 v96, v96, v105
    v_add_f32 v96, v96, v106
    v_add_f32 v96, v96, v107
    v_add_f32 v96, v96, v108
    v_add_f32 v96, v96, v109
    v_add_f32 v96, v96, v110
    v_add_f32 v96, v96, v111
    v_mov_b32 v50, v64
    v_mov_b32 v51, v65
    v_mov_b32 v52, v96
    v_mov_b32 v55, 0
    v_mov_b32 v56, 0
    v_mov_b32 v53, 0
    s_nop 3
    v_add_f32 v50, v50, v55
    v_add_f32 v51, v51, v56
    v_add_f32 v52, v52, v53
    v_mov_b32 v3, v50
    v_mov_b32 v4, v50
    v_mov_b32 v5, v51
    v_mov_b32 v6, v51
    s_nop 1
    v_permlane32_swap_b32 v3, v4
    v_permlane32_swap_b32 v5, v6
    s_nop 1
    v_add_f32 v3, v3, v4
    v_add_f32 v5, v5, v6
    v_mul_f32 v3, 0x3a800000, v3
    v_mul_f32 v5, 0x3a800000, v5
    v_fma_f32 v5, -v3, v3, v5
    v_max_f32 v5, 0, v5
    v_cvt_pk_bf16_f32 v3, v3, v3
    v_lshlrev_b32 v3, 16, v3
    v_cvt_pk_bf16_f32 v5, v5, v5
    v_lshlrev_b32 v5, 16, v5
    v_add_f32 v5, 0x3727c5ac, v5
    v_cvt_pk_bf16_f32 v5, v5, v5
    v_lshlrev_b32 v5, 16, v5
    v_sqrt_f32 v5, v5
    s_nop 0
    v_cvt_pk_bf16_f32 v5, v5, v5
    v_lshlrev_b32 v5, 16, v5
    v_rcp_f32 v6, v5
    s_nop 0
    v_mul_f32 v7, v3, v6
    v_sub_f32 v7, 0, v7
    v_sub_f32 v4, 0, v3
    v_mov_b32 v68, v4
    v_mul_f32 v69, v6, v6
    v_mul_f32 v69, v69, v6
    v_mul_f32 v69, 0xbdd2d3e8, v69
    v_mul_f32 v70, 0xc0135761, v6
    v_mul_f32 v71, v6, v112
    v_max_f32 v71, 0x0da24260, v71
    v_rcp_f32 v71, v71
    v_and_b32 v3, 31, v1
    s_lshl_b32 s71, s75, 5
    v_add_u32 v3, s71, v3
    v_lshlrev_b32 v3, 4, v3
    v_add_u32 v3, 150080, v3
    ds_write_b128 v3, v[68:71]
    v_and_b32 v3, 31, v1
    s_lshl_b32 s71, s75, 5
    v_add_u32 v3, s71, v3
    v_lshlrev_b32 v3, 3, v3
    v_add_u32 v3, 147456, v3
    ds_write_b64 v3, v[6:7]
    s_lshl_b32 s71, s75, 6
    v_add_u32 v3, s71, v1
    v_lshlrev_b32 v3, 2, v3
    v_add_u32 v3, 148480, v3
    ds_write_b32 v3, v52
    s_waitcnt lgkmcnt(0)
    s_barrier
L_loader4:
    s_mov_b32 s48, s18
    s_mov_b32 s49, s19
    s_mov_b32 s50, 0x700000
    s_mov_b32 s51, 0x20000
    s_mul_i32 s69, s78, 524288
    s_lshl_b32 s85, s78, 9
    s_add_u32 m0, s70, 16384
    s_nop 0
    buffer_load_dwordx4 v204, s[48:51], s69 offen offset:0 lds
    buffer_load_dwordx4 v205, s[48:51], s69 offen offset:1024 lds
    buffer_load_dwordx4 v206, s[48:51], s69 offen offset:2048 lds
    buffer_load_dwordx4 v207, s[48:51], s69 offen offset:3072 lds
    s_add_u32 s69, s69, 131072
    s_add_u32 m0, s70, 49152
    s_nop 0
    buffer_load_dwordx4 v204, s[48:51], s69 offen offset:0 lds
    buffer_load_dwordx4 v205, s[48:51], s69 offen offset:1024 lds
    buffer_load_dwordx4 v206, s[48:51], s69 offen offset:2048 lds
    buffer_load_dwordx4 v207, s[48:51], s69 offen offset:3072 lds
    s_add_u32 s69, s69, 131072
    s_add_u32 m0, s70, 81920
    s_nop 0
    buffer_load_dwordx4 v204, s[48:51], s69 offen offset:0 lds
    buffer_load_dwordx4 v205, s[48:51], s69 offen offset:1024 lds
    buffer_load_dwordx4 v206, s[48:51], s69 offen offset:2048 lds
    buffer_load_dwordx4 v207, s[48:51], s69 offen offset:3072 lds
    s_add_u32 s69, s69, 131072
    s_add_u32 m0, s70, 114688
    s_nop 0
    buffer_load_dwordx4 v204, s[48:51], s69 offen offset:0 lds
    buffer_load_dwordx4 v205, s[48:51], s69 offen offset:1024 lds
    buffer_load_dwordx4 v206, s[48:51], s69 offen offset:2048 lds
    buffer_load_dwordx4 v207, s[48:51], s69 offen offset:3072 lds
    s_add_u32 s69, s69, 131072
    s_add_u32 s48, s26, 0x2700000
    s_addc_u32 s49, s27, 0
    s_mov_b32 s50, 0x8000
    s_mov_b32 s51, 0x20000
    v_mov_b32 v121, 0
    v_mov_b32 v122, 0
    s_lshl_b32 s71, s77, 7
    s_add_u32 s71, s71, 6144
    v_mov_b32 v121, s71
    s_mov_b32 s71, 2
    v_writelane_b32 v122, s71, 0
    buffer_load_dword v123, v121, s[48:51], 0 offen sc1
    s_waitcnt vmcnt(0)
    v_cmp_lt_u32 vcc, v123, v122
    s_nop 0
    s_cmp_eq_u64 vcc, 0
    s_cbranch_scc1 L_apolld_107
    s_add_u32 s48, s26, 0x2700000
    s_addc_u32 s49, s27, 0
    s_mov_b32 s50, 0x8000
    s_mov_b32 s51, 0x20000
    s_mov_b32 s72, 0x40000
L_apoll_106:
    buffer_load_dword v123, v121, s[48:51], 0 offen sc1
    s_waitcnt vmcnt(0)
    v_cmp_lt_u32 vcc, v123, v122
    s_sub_u32 s72, s72, 1
    s_cmp_eq_u32 s72, 0
    s_cbranch_scc1 L_apolld_107
    s_cmp_eq_u64 vcc, 0
    s_cbranch_scc1 L_apolld_107
    s_sleep 4
    s_branch L_apoll_106
L_apolld_107:
    s_cmp_eq_u32 s76, 0
    s_mov_b32 s78, 0x51743260
    s_cselect_b32 s78, 0x76543210, s78
    s_lshl_b32 s71, s63, 2
    s_lshr_b32 s78, s78, s71
    s_and_b32 s78, s78, 7
    s_lshl_b32 s62, s78, 7
    s_mov_b32 s28, s26
    s_mov_b32 s29, s27
    s_mov_b32 s30, 0x400000
    s_mov_b32 s31, 0x20000
    s_mov_b32 s32, s8
    s_mov_b32 s33, s9
    s_mov_b32 s34, 0x200000
    s_mov_b32 s35, 0x20000
    s_add_u32 s44, s26, 0x1000000
    s_addc_u32 s45, s27, 0
    s_mov_b32 s46, 0xe00000
    s_mov_b32 s47, 0x20000
    s_mov_b32 s36, s22
    s_mov_b32 s37, s23
    s_mov_b32 s38, 0x400000
    s_mov_b32 s39, 0x20000
    s_add_u32 s40, s26, 0x800000
    s_addc_u32 s41, s27, 0
    s_mov_b32 s42, 0x400000
    s_mov_b32 s43, 0x20000
    s_add_u32 s52, s26, 0x2300000
    s_addc_u32 s53, s27, 0
    s_mov_b32 s54, 0x2000
    s_mov_b32 s55, 0x20000
    s_mov_b32 s48, s18
    s_mov_b32 s49, s19
    s_mov_b32 s50, 0x700000
    s_mov_b32 s51, 0x20000
    s_and_b32 s71, s78, 3
    s_cmp_eq_u32 s71, 1
    s_cselect_b32 s67, 4, 4
    s_cselect_b32 s71, 6, 8
    s_bitcmp0_b32 s79, 0
    s_cselect_b32 s67, s71, s67
    s_mul_i32 s68, s67, s76
    s_sub_u32 s71, 16, s67
    s_cmp_eq_u32 s76, 0
    s_cselect_b32 s67, s67, s71
    s_lshl_b32 s68, s68, 7
    s_lshl_b32 s69, s68, 10
    s_cmp_eq_u32 s76, 0
    s_cselect_b32 s87, 28, 20
    s_mul_i32 s65, s76, 4096
    s_and_b32 s71, s78, 3
    s_cmp_eq_u32 s71, 1
    s_cselect_b32 s66, 3584, -1
    s_cselect_b32 s87, 28, s87
L_loader4b:
    s_barrier
    s_mov_b32 s84, s70
L_l8_108:
    s_mov_b32 m0, s84
    s_waitcnt vmcnt(16)
    s_barrier
    buffer_load_dwordx4 v200, s[28:31], s68 offen offset:0 sc1 lds
    buffer_load_dwordx4 v201, s[28:31], s68 offen offset:1024 sc1 lds
    buffer_load_dwordx4 v202, s[28:31], s68 offen offset:2048 sc1 lds
    buffer_load_dwordx4 v203, s[28:31], s68 offen offset:3072 sc1 lds
    s_add_u32 m0, s84, 16384
    s_add_u32 s68, s68, 128
    buffer_load_dwordx4 v204, s[32:35], s69 offen offset:0 lds
    s_add_u32 s84, s84, 32768
    s_and_b32 s84, s84, 0x1ffff
    buffer_load_dwordx4 v205, s[32:35], s69 offen offset:1024 lds
    buffer_load_dwordx4 v206, s[32:35], s69 offen offset:2048 lds
    s_sub_u32 s67, s67, 1
    buffer_load_dwordx4 v207, s[32:35], s69 offen offset:3072 lds
    s_lshl_b32 s69, s68, 10
    s_cmp_lg_u32 s67, 0
    s_cbranch_scc1 L_l8_108
    s_mov_b32 s67, s87
    s_mov_b32 s68, s65
    s_cmp_eq_u32 s68, s85
    s_cselect_b32 s71, 512, 0
    s_add_u32 s68, s68, s71
    s_lshl_b32 s69, s68, 10
L_l8_109:
    s_mov_b32 m0, s84
    s_waitcnt vmcnt(16)
    s_barrier
    buffer_load_dwordx4 v208, s[44:47], s68 offen offset:0 sc1 lds
    buffer_load_dwordx4 v209, s[44:47], s68 offen offset:1024 sc1 lds
    buffer_load_dwordx4 v210, s[44:47], s68 offen offset:2048 sc1 lds
    buffer_load_dwordx4 v211, s[44:47], s68 offen offset:3072 sc1 lds
    s_add_u32 m0, s84, 16384
    s_add_u32 s68, s68, 128
    buffer_load_dwordx4 v204, s[48:51], s69 offen offset:0 lds
    s_add_u32 s84, s84, 32768
    s_and_b32 s84, s84, 0x1ffff
    buffer_load_dwordx4 v205, s[48:51], s69 offen offset:1024 lds
    s_cmp_eq_u32 s68, s85
    s_cselect_b32 s71, 512, 0
    s_add_u32 s68, s68, s71
    buffer_load_dwordx4 v206, s[48:51], s69 offen offset:2048 lds
    s_sub_u32 s67, s67, 1
    s_cmp_eq_u32 s68, s66
    s_cselect_b32 s68, 6656, s68
    buffer_load_dwordx4 v207, s[48:51], s69 offen offset:3072 lds
    s_lshl_b32 s69, s68, 10
    s_cmp_lg_u32 s67, 0
    s_cbranch_scc1 L_l8_109
    s_waitcnt vmcnt(16)
    s_barrier
    s_bitcmp0_b32 s75, 0
    s_cselect_b32 s42, s42, 0
    s_lshl_b32 s68, s62, 1
    s_mov_b32 s71, s84
    s_add_u32 m0, s71, 0
    s_nop 0
    buffer_load_dwordx4 v200, s[40:43], s68 offen offset:0 sc1 lds
    buffer_load_dwordx4 v201, s[40:43], s68 offen offset:1024 sc1 lds
    buffer_load_dwordx4 v202, s[40:43], s68 offen offset:2048 sc1 lds
    buffer_load_dwordx4 v203, s[40:43], s68 offen offset:3072 sc1 lds
    s_add_u32 s68, s68, 128
    s_add_u32 m0, s71, 16384
    s_nop 0
    buffer_load_dwordx4 v200, s[40:43], s68 offen offset:0 sc1 lds
    buffer_load_dwordx4 v201, s[40:43], s68 offen offset:1024 sc1 lds
    buffer_load_dwordx4 v202, s[40:43], s68 offen offset:2048 sc1 lds
    buffer_load_dwordx4 v203, s[40:43], s68 offen offset:3072 sc1 lds
    s_add_u32 s68, s68, 128
    s_waitcnt vmcnt(16)
    s_barrier
    s_waitcnt vmcnt(8)
    s_barrier
    s_waitcnt vmcnt(0)
    s_barrier
    s_branch L_gated_mix__linear_attn_block__mixer_s_mlp__prompt_kernel_end
L_owg_loader4:
    s_cmp_eq_u32 s76, 0
    s_mov_b32 s78, 0x51743260
    s_cselect_b32 s78, 0x76543210, s78
    s_lshl_b32 s71, s63, 2
    s_lshr_b32 s78, s78, s71
    s_and_b32 s78, s78, 7
    s_lshl_b32 s62, s78, 7
    s_mov_b32 s28, s26
    s_mov_b32 s29, s27
    s_mov_b32 s30, 0x400000
    s_mov_b32 s31, 0x20000
    s_mov_b32 s32, s8
    s_mov_b32 s33, s9
    s_mov_b32 s34, 0x200000
    s_mov_b32 s35, 0x20000
    s_add_u32 s44, s26, 0x1000000
    s_addc_u32 s45, s27, 0
    s_mov_b32 s46, 0xe00000
    s_mov_b32 s47, 0x20000
    s_mov_b32 s36, s22
    s_mov_b32 s37, s23
    s_mov_b32 s38, 0x400000
    s_mov_b32 s39, 0x20000
    s_add_u32 s40, s26, 0x800000
    s_addc_u32 s41, s27, 0
    s_mov_b32 s42, 0x400000
    s_mov_b32 s43, 0x20000
    s_add_u32 s52, s26, 0x2300000
    s_addc_u32 s53, s27, 0
    s_mov_b32 s54, 0x2000
    s_mov_b32 s55, 0x20000
    v_lshrrev_b32 v5, 4, v1
    s_lshl_b32 s71, s75, 4
    v_add_u32 v3, s71, v5
    s_mov_b32 s72, 2048
    v_mul_lo_u32 v3, v3, s72
    v_and_b32 v4, 15, v1
    v_lshlrev_b32 v5, 2, v5
    v_xor_b32 v4, v4, v5
    v_lshl_add_u32 v3, v4, 4, v3
    s_lshl_b32 s71, s62, 1
    v_add_u32 v3, s71, v3
    v_add_u32 v204, 0x0, v3
    v_add_u32 v205, 0x1c00, v3
    v_xor_b32 v3, 32, v3
    v_add_u32 v206, 0x3800, v3
    v_add_u32 v207, 0x5400, v3
    v_lshrrev_b32 v3, 3, v1
    v_and_b32 v4, 7, v1
    v_lshrrev_b32 v5, 4, v1
    v_xor_b32 v4, v4, v5
    s_xor_b32 s71, s75, s76
    s_lshl_b32 s71, s71, 5
    s_add_u32 s71, s71, s61
    v_add_u32 v3, s71, v3
    s_mov_b32 s72, 2048
    v_mul_lo_u32 v3, v3, s72
    v_mov_b32 v5, v4
    v_lshl_add_u32 v5, v5, 4, v3
    v_add_u32 v200, 0x0, v5
    v_xor_b32 v5, 4, v4
    v_lshl_add_u32 v5, v5, 4, v3
    v_add_u32 v201, 0x3c00, v5
    v_mov_b32 v5, v4
    v_lshl_add_u32 v5, v5, 4, v3
    v_add_u32 v202, 0x7800, v5
    v_xor_b32 v5, 4, v4
    v_lshl_add_u32 v5, v5, 4, v3
    v_add_u32 v203, 0xb400, v5
    v_lshrrev_b32 v3, 3, v1
    v_and_b32 v4, 7, v1
    v_lshrrev_b32 v5, 4, v1
    v_xor_b32 v4, v4, v5
    s_xor_b32 s71, s75, s76
    s_lshl_b32 s71, s71, 5
    s_add_u32 s71, s71, s61
    v_add_u32 v3, s71, v3
    s_mov_b32 s72, 7168
    v_mul_lo_u32 v3, v3, s72
    v_mov_b32 v5, v4
    v_lshl_add_u32 v5, v5, 4, v3
    v_add_u32 v208, 0x0, v5
    v_xor_b32 v5, 4, v4
    v_lshl_add_u32 v5, v5, 4, v3
    v_add_u32 v209, 0xdc00, v5
    v_mov_b32 v5, v4
    v_lshl_add_u32 v5, v5, 4, v3
    v_add_u32 v210, 0x1b800, v5
    v_xor_b32 v5, 4, v4
    v_lshl_add_u32 v5, v5, 4, v3
    v_add_u32 v211, 0x29400, v5
    s_mov_b32 s48, s18
    s_mov_b32 s49, s19
    s_mov_b32 s50, 0x700000
    s_mov_b32 s51, 0x20000
    s_lshl_b32 s70, s75, 12
    s_and_b32 s71, s78, 3
    s_cmp_eq_u32 s71, 1
    s_cselect_b32 s67, 4, 4
    s_cselect_b32 s71, 6, 8
    s_bitcmp0_b32 s79, 0
    s_cselect_b32 s67, s71, s67
    s_mul_i32 s68, s67, s76
    s_sub_u32 s71, 16, s67
    s_cmp_eq_u32 s76, 0
    s_cselect_b32 s67, s67, s71
    s_lshl_b32 s68, s68, 7
    s_lshl_b32 s69, s68, 10
    s_add_u32 m0, s70, 16384
    s_nop 0
    buffer_load_dwordx4 v204, s[32:35], s69 offen offset:0 lds
    buffer_load_dwordx4 v205, s[32:35], s69 offen offset:1024 lds
    buffer_load_dwordx4 v206, s[32:35], s69 offen offset:2048 lds
    buffer_load_dwordx4 v207, s[32:35], s69 offen offset:3072 lds
    s_add_u32 s69, s69, 131072
    s_add_u32 m0, s70, 49152
    s_nop 0
    buffer_load_dwordx4 v204, s[32:35], s69 offen offset:0 lds
    buffer_load_dwordx4 v205, s[32:35], s69 offen offset:1024 lds
    buffer_load_dwordx4 v206, s[32:35], s69 offen offset:2048 lds
    buffer_load_dwordx4 v207, s[32:35], s69 offen offset:3072 lds
    s_add_u32 s69, s69, 131072
    s_add_u32 m0, s70, 81920
    s_nop 0
    buffer_load_dwordx4 v204, s[32:35], s69 offen offset:0 lds
    buffer_load_dwordx4 v205, s[32:35], s69 offen offset:1024 lds
    buffer_load_dwordx4 v206, s[32:35], s69 offen offset:2048 lds
    buffer_load_dwordx4 v207, s[32:35], s69 offen offset:3072 lds
    s_add_u32 s69, s69, 131072
    s_add_u32 m0, s70, 114688
    s_nop 0
    buffer_load_dwordx4 v204, s[32:35], s69 offen offset:0 lds
    buffer_load_dwordx4 v205, s[32:35], s69 offen offset:1024 lds
    buffer_load_dwordx4 v206, s[32:35], s69 offen offset:2048 lds
    buffer_load_dwordx4 v207, s[32:35], s69 offen offset:3072 lds
    s_add_u32 s69, s69, 131072
    v_mov_b32 v4, 149504
    s_cmp_lg_u32 s75, 0
    s_cbranch_scc1 L_lgo_110
    s_add_u32 s48, s26, 0x2700000
    s_addc_u32 s49, s27, 0
    s_mov_b32 s50, 0x8000
    s_mov_b32 s51, 0x20000
    s_lshl_b32 s71, s77, 7
    s_add_u32 s71, s71, 6144
    v_mov_b32 v2, s71
    s_mov_b32 s72, 0x40000
L_poll_113:
    buffer_load_dword v3, v2, s[48:51], 0 offen sc1
    s_waitcnt vmcnt(0)
    v_readfirstlane_b32 s71, v3
    s_sub_u32 s72, s72, 1
    s_cmp_eq_u32 s72, 0
    s_cbranch_scc1 L_polld_114
    s_cmp_ge_u32 s71, 2
    s_cbranch_scc1 L_polld_114
    s_sleep 4
    s_branch L_poll_113
L_polld_114:
    v_mov_b32 v3, 3
    ds_write_b32 v4, v3
    s_waitcnt lgkmcnt(0)
    s_branch L_lgd_111
L_lgo_110:
    s_mov_b32 s72, 0x400000
L_lgp_112:
    s_sleep 1
    ds_read_b32 v3, v4
    s_waitcnt lgkmcnt(0)
    v_readfirstlane_b32 s71, v3
    s_sub_u32 s72, s72, 1
    s_cmp_eq_u32 s72, 0
    s_cbranch_scc1 L_lgd_111
    s_cmp_lg_u32 s71, 3
    s_cbranch_scc1 L_lgp_112
L_lgd_111:
    s_mov_b32 s48, s18
    s_mov_b32 s49, s19
    s_mov_b32 s50, 0x700000
    s_mov_b32 s51, 0x20000
    s_add_u32 m0, s70, 0
    s_nop 0
    buffer_load_dwordx4 v200, s[28:31], s68 offen offset:0 sc1 lds
    buffer_load_dwordx4 v201, s[28:31], s68 offen offset:1024 sc1 lds
    buffer_load_dwordx4 v202, s[28:31], s68 offen offset:2048 sc1 lds
    buffer_load_dwordx4 v203, s[28:31], s68 offen offset:3072 sc1 lds
    s_add_u32 s68, s68, 128
    s_add_u32 m0, s70, 32768
    s_nop 0
    buffer_load_dwordx4 v200, s[28:31], s68 offen offset:0 sc1 lds
    buffer_load_dwordx4 v201, s[28:31], s68 offen offset:1024 sc1 lds
    buffer_load_dwordx4 v202, s[28:31], s68 offen offset:2048 sc1 lds
    buffer_load_dwordx4 v203, s[28:31], s68 offen offset:3072 sc1 lds
    s_add_u32 s68, s68, 128
    s_add_u32 m0, s70, 65536
    s_nop 0
    buffer_load_dwordx4 v200, s[28:31], s68 offen offset:0 sc1 lds
    buffer_load_dwordx4 v201, s[28:31], s68 offen offset:1024 sc1 lds
    buffer_load_dwordx4 v202, s[28:31], s68 offen offset:2048 sc1 lds
    buffer_load_dwordx4 v203, s[28:31], s68 offen offset:3072 sc1 lds
    s_add_u32 s68, s68, 128
    s_add_u32 m0, s70, 98304
    s_nop 0
    buffer_load_dwordx4 v200, s[28:31], s68 offen offset:0 sc1 lds
    buffer_load_dwordx4 v201, s[28:31], s68 offen offset:1024 sc1 lds
    buffer_load_dwordx4 v202, s[28:31], s68 offen offset:2048 sc1 lds
    buffer_load_dwordx4 v203, s[28:31], s68 offen offset:3072 sc1 lds
    s_add_u32 s68, s68, 128
    s_sub_u32 s67, s67, 4
    s_mov_b32 s87, 24
    s_mov_b32 s85, -1
    s_mov_b32 s66, -1
    s_mov_b32 s65, 3584
    s_waitcnt vmcnt(0)
    s_branch L_loader4b
L_gated_mix__linear_attn_block__mixer_s_mlp__prompt_kernel_end:
    s_endpgm
L_code_end:
.section .rodata,"a"
.p2align 6
.amdhsa_kernel gated_mix__linear_attn_block__mixer_s_mlp__prompt_kernel
  .amdhsa_next_free_vgpr 256
  .amdhsa_next_free_sgpr 102
  .amdhsa_accum_offset 256
  .amdhsa_group_segment_fixed_size 0
  .amdhsa_kernarg_size 96
  .amdhsa_user_sgpr_count 2
  .amdhsa_user_sgpr_kernarg_segment_ptr 1
  .amdhsa_system_sgpr_workgroup_id_x 1
.end_amdhsa_kernel
.text
```
